```python
import torch

def _softmax(x, axis=-1):
    return torch.softmax(x, dim=axis)
def _gelu(x):
    return torch.nn.functional.gelu(x, approximate="tanh")
def _silu(x):
    return torch.nn.functional.silu(x)
def _sigmoid(x):
    return torch.sigmoid(x)
def _layernorm(x, axis=-1, eps=1e-5):
    m = x.mean(dim=axis, keepdim=True)
    v = x.var(dim=axis, keepdim=True, unbiased=False)
    return (x - m) / torch.sqrt(v + eps)
def _scatter_add(tgt, idx, src, axis=0):
    return tgt.clone().index_add_(axis, idx, src)
def _segment_sum(src, seg, n):
    out = torch.zeros((n,) + src.shape[1:], dtype=src.dtype)
    return out.index_add_(0, seg, src)
def _pad(x, pw):
    flat = tuple(v for pair in reversed(pw) for v in pair)
    return torch.nn.functional.pad(x, flat)

kernel_name = 'interleave_layers__sliding_local_dilated__glu_gated_reglu__prompt'

def setup_inputs():

    _w = (lambda a: (lambda t: t.to(torch.bfloat16) if t.is_floating_point() else t)(torch.as_tensor(a)))
    def _A_setup():
        B, S, D = 1, 2048, 576
        return {
            "x": _w((lambda *s: torch.randn(*s, dtype=torch.bfloat16) * 0.05)(B, S, D)),
            "wqkv": _w((lambda *s: torch.randn(*s, dtype=torch.bfloat16) * 0.05)(D, 3 * D)),
            "wo": _w((lambda *s: torch.randn(*s, dtype=torch.bfloat16) * 0.05)(D, D)),
        }
    _A_in = _A_setup()

    def _B_setup():
        B, S, D, F = 1, 2048, 576, 4608
        return {
            "x": _w((lambda *s: torch.randn(*s, dtype=torch.bfloat16) * 0.05)(B, S, D)),
            "W_gate": _w((lambda *s: torch.randn(*s, dtype=torch.bfloat16) * 0.8)(D, F) * (2.0 / D) ** 0.5),
            "W_up": _w((lambda *s: torch.randn(*s, dtype=torch.bfloat16) * 0.8)(D, F) * (2.0 / D) ** 0.5),
            "W_down": _w((lambda *s: torch.randn(*s, dtype=torch.bfloat16) * 0.8)(F, D) * (1.0 / F) ** 0.5),
        }
    _B_in = _B_setup()

    return {
        "A_x": _A_in["x"],
        "A_wqkv": _A_in["wqkv"],
        "A_wo": _A_in["wo"],
        "B_x": _B_in["x"],
        "B_W_gate": _B_in["W_gate"],
        "B_W_up": _B_in["W_up"],
        "B_W_down": _B_in["W_down"],
    }

def reference(A_x, A_wqkv, A_wo, B_x, B_W_gate, B_W_up, B_W_down):
    def _A_ref(x, wqkv, wo):
        B, S, D = x.shape
        H = 32; Dh = D // H
        W, dil = 8, 2
        qkv = (lambda x, *d: x.permute(*d))((x @ wqkv).reshape(B, S, 3, H, Dh), 2, 0, 3, 1, 4)
        q, k, v = qkv[0], qkv[1], qkv[2]
        scale = Dh ** -0.5
        pos = torch.arange(S)
        off = torch.arange(W) * dil
        idx = pos[:, None] - off[None, :]
        mask = idx >= 0
        idx_c = torch.where(mask, idx, 0).reshape(-1)
        kg = k[:, :, idx_c, :].reshape(B, H, S, W, Dh)
        vg = v[:, :, idx_c, :].reshape(B, H, S, W, Dh)
        logits = torch.einsum("bhsd,bhswd->bhsw", q, kg) * scale
        logits = torch.where(mask[None, None, :, :], logits, -1e9)
        attn = _softmax(logits, axis=-1)
        o = torch.einsum("bhsw,bhswd->bhsd", attn, vg)
        return (lambda x, *d: x.permute(*d))(o, 0, 2, 1, 3).reshape(B, S, D) @ wo

    def _B_ref(x, W_gate, W_up, W_down):
        gate = torch.einsum("bsd,df->bsf", x, W_gate)
        up = torch.einsum("bsd,df->bsf", x, W_up)
        gate = gate * (lambda x, dt: x.to(dt))(gate > 0, gate.dtype)
        h = gate * up
        return torch.einsum("bsf,fd->bsd", h, W_down)

    x = A_x
    x = x + _A_ref(_layernorm(x, axis=-1), A_wqkv, A_wo)
    x = x + _B_ref(_layernorm(x, axis=-1), B_W_gate, B_W_up, B_W_down)
    x = x + _A_ref(_layernorm(x, axis=-1), A_wqkv, A_wo)
    x = x + _B_ref(_layernorm(x, axis=-1), B_W_gate, B_W_up, B_W_down)
    return x
```

```asm
; @launch grid=(256,1,1) block=(256,1,1) lds=163840
.amdgcn_target "amdgcn-amd-amdhsa--gfx950"
.text
.globl interleave_layers__sliding_local_dilated__glu_gated_reglu__prompt_kernel
.p2align 8
.type interleave_layers__sliding_local_dilated__glu_gated_reglu__prompt_kernel,@function
interleave_layers__sliding_local_dilated__glu_gated_reglu__prompt_kernel:
  s_cmp_ge_u32 s2, 256
  s_cbranch_scc1 m_exit
  s_load_dwordx4 s[36:39], s[0:1], 32
  s_load_dwordx4 s[40:43], s[0:1], 48
  s_load_dwordx2 s[24:25], s[0:1], 72
  s_load_dwordx4 s[88:91], s[0:1], 0
  s_load_dwordx2 s[92:93], s[0:1], 16
  s_load_dwordx2 s[94:95], s[0:1], 64
  s_memrealtime s[96:97]
  s_getpc_b64 s[48:49]
m_ct_e:
  s_sub_u32 s48, s48, m_ct_e-interleave_layers__sliding_local_dilated__glu_gated_reglu__prompt_kernel
  s_subb_u32 s49, s49, 0
  v_lshlrev_b32 v238, 7, v0
  v_add_u32 v239, 0x8000, v238
  v_min_u32 v239, m_cend-interleave_layers__sliding_local_dilated__glu_gated_reglu__prompt_kernel, v239
  v_mov_b32 v241, s49
  v_mov_b32 v243, s49
  v_add_co_u32 v242, vcc, s48, v239
  v_addc_co_u32 v243, vcc, 0, v243, vcc
  global_load_dword v239, v[242:243], off
  v_add_co_u32 v240, vcc, s48, v238
  v_addc_co_u32 v241, vcc, 0, v241, vcc
  global_load_dword v239, v[240:241], off
  v_lshrrev_b32 v1, 6, v0
  v_and_b32 v252, 63, v0
  v_readfirstlane_b32 s20, v1
  s_and_b32 s21, s2, 3
  s_lshl_b32 s21, s21, 2
  s_bfe_u32 s26, s2, 0x20003
  s_add_u32 s21, s21, s26
  s_bfe_u32 s22, s2, 0x10002
  s_lshl_b32 s22, s22, 3
  s_lshr_b32 s26, s2, 5
  s_add_u32 s22, s22, s26
  v_lshlrev_b32 v253, 4, v252
  v_add_u32 v254, 18432, v253
  s_mov_b32 s23, 0
  s_lshl_b32 s60, s22, 10
  s_add_u32 s60, s60, 0x17c1000
  s_mov_b32 s61, 0
  s_waitcnt lgkmcnt(0)
  s_mov_b32 s4, s24
  s_and_b32 s5, s25, 0xffff
  s_mov_b32 s6, 0x3000000
  s_mov_b32 s7, 0x20000
  s_mov_b32 s59, 0
  s_mov_b32 s16, s94
  s_and_b32 s17, s95, 0xffff
  s_mov_b32 s18, 0x100
  s_mov_b32 s19, 0x20000
  s_lshl_b32 s24, s2, 2
  s_add_u32 s24, s24, s20
  s_cmp_lg_u32 s24, 3
  s_cbranch_scc1 m_Z_1
  s_or_b32 s96, s96, 1
  v_mov_b32 v8, s96
  v_mov_b32 v9, 0
  s_mov_b64 exec, 1
  buffer_store_dword v8, v9, s[16:19], 0 offen sc1
  s_mov_b64 exec, -1
m_Z_1:
  v_and_b32 v1, 7, v252
  v_lshrrev_b32 v2, 3, v252
  s_cmp_eq_u32 s20, 0
  s_movk_i32 s24, 0x876
  s_cselect_b32 s24, 0x310, s24
  s_cmp_eq_u32 s20, 1
  s_cselect_b32 s24, 0x425, s24
  v_lshlrev_b32 v6, 4, v1
  v_lshl_add_u32 v6, v2, 8, v6
  s_bfe_u32 s44, s24, 0x40000
  s_lshl_b32 s44, s44, 3
  s_lshl_b32 s25, s44, 8
  v_add_u32 v3, s25, v6
  s_bfe_u32 s45, s24, 0x40004
  s_lshl_b32 s45, s45, 3
  s_lshl_b32 s25, s45, 8
  v_add_u32 v4, s25, v6
  s_bfe_u32 s46, s24, 0x40008
  s_lshl_b32 s46, s46, 3
  s_lshl_b32 s25, s46, 8
  v_add_u32 v203, s25, v6
  s_lshl_b32 s25, s22, 4
  s_add_u32 s25, s25, s21
  s_lshr_b32 s26, s25, 1
  s_mul_i32 s26, s26, 18432
  s_and_b32 s27, s25, 1
  s_lshl_b32 s27, s27, 7
  s_add_u32 s26, s26, s27
  s_mov_b32 s8, s90
  s_and_b32 s9, s91, 0xffff
  s_mov_b32 s10, 0x1e6000
  s_mov_b32 s11, 0x20000
  s_mov_b32 s12, s92
  s_and_b32 s13, s93, 0xffff
  s_mov_b32 s14, 0xa2000
  s_mov_b32 s15, 0x20000
  v_and_b32 v80, 15, v252
  v_lshrrev_b32 v81, 4, v252
  v_bfe_u32 v82, v80, 1, 1
  v_bfe_u32 v83, v80, 2, 1
  v_mul_u32_u24 v84, 576, v82
  v_mul_u32_u24 v83, 18, v83
  v_add_u32 v84, v84, v83
  v_add_u32 v84, 576, v84
  v_mul_u32_u24 v83, 18, v82
  v_cmp_gt_u32 vcc, 8, v80
  s_nop 1
  v_cndmask_b32 v84, v83, v84, vcc
  v_and_b32 v83, 1, v80
  v_add3_u32 v84, v84, v83, 16
  v_mov_b32 v83, 0x1000000
  v_cmp_gt_u32 vcc, 12, v80
  s_nop 1
  v_cndmask_b32 v84, v83, v84, vcc
  v_mul_u32_u24 v85, 13824, v81
  s_lshl_b32 s48, s22, 3
  s_lshl_b32 s49, s20, 1
  s_add_u32 s48, s48, s49
  s_mul_i32 s49, s48, 9363
  s_lshr_b32 s49, s49, 16
  s_mul_i32 s50, s49, 7
  s_sub_u32 s50, s48, s50
  s_lshr_b32 s51, s50, 1
  s_add_u32 s51, s51, 1
  s_cmp_eq_u32 s51, 3
  s_cselect_b32 s51, 0, s51
  s_mul_i32 s51, s51, 576
  s_and_b32 s52, s50, 1
  s_mul_i32 s52, s52, 18
  s_add_u32 s51, s51, s52
  v_add_u32 v86, s51, v80
  s_cmp_eq_u32 s50, 6
  s_cselect_b64 vcc, -1, 0
  v_cndmask_b32 v86, v86, v84, vcc
  v_lshl_add_u32 v87, v86, 1, v85
  s_mul_i32 s51, s49, 110592
  s_mul_i32 s52, s21, 72
  s_add_u32 s51, s51, s52
  s_mul_i32 s52, s21, 128
  s_add_u32 s52, s52, s48
  s_lshl_b32 s52, s52, 10
  s_add_u32 s52, s52, 0x1901000
  s_cmp_lt_u32 s48, 126
  s_cselect_b32 s66, s52, 0x7f000000
  s_add_u32 s52, s51, 0
  buffer_load_ushort v96, v87, s[8:11], s52 offen
  s_add_u32 s52, s51, 3456
  buffer_load_ushort v97, v87, s[8:11], s52 offen
  s_add_u32 s52, s51, 6912
  buffer_load_ushort v98, v87, s[8:11], s52 offen
  s_add_u32 s52, s51, 10368
  buffer_load_ushort v99, v87, s[8:11], s52 offen
  s_add_u32 s52, s51, 55296
  buffer_load_ushort v100, v87, s[8:11], s52 offen
  s_add_u32 s52, s51, 58752
  buffer_load_ushort v101, v87, s[8:11], s52 offen
  s_add_u32 s52, s51, 62208
  buffer_load_ushort v102, v87, s[8:11], s52 offen
  s_add_u32 s52, s51, 65664
  buffer_load_ushort v103, v87, s[8:11], s52 offen
  s_lshl_b32 s48, s22, 3
  s_lshl_b32 s49, s20, 1
  s_add_u32 s48, s48, s49
  s_add_u32 s48, s48, 1
  s_mul_i32 s49, s48, 9363
  s_lshr_b32 s49, s49, 16
  s_mul_i32 s50, s49, 7
  s_sub_u32 s50, s48, s50
  s_lshr_b32 s51, s50, 1
  s_add_u32 s51, s51, 1
  s_cmp_eq_u32 s51, 3
  s_cselect_b32 s51, 0, s51
  s_mul_i32 s51, s51, 576
  s_and_b32 s52, s50, 1
  s_mul_i32 s52, s52, 18
  s_add_u32 s51, s51, s52
  v_add_u32 v86, s51, v80
  s_cmp_eq_u32 s50, 6
  s_cselect_b64 vcc, -1, 0
  v_cndmask_b32 v86, v86, v84, vcc
  v_lshl_add_u32 v88, v86, 1, v85
  s_mul_i32 s51, s49, 110592
  s_mul_i32 s52, s21, 72
  s_add_u32 s51, s51, s52
  s_mul_i32 s52, s21, 128
  s_add_u32 s52, s52, s48
  s_lshl_b32 s52, s52, 10
  s_add_u32 s52, s52, 0x1901000
  s_cmp_lt_u32 s48, 126
  s_cselect_b32 s67, s52, 0x7f000000
  s_add_u32 s52, s51, 0
  buffer_load_ushort v104, v88, s[8:11], s52 offen
  s_add_u32 s52, s51, 3456
  buffer_load_ushort v105, v88, s[8:11], s52 offen
  s_add_u32 s52, s51, 6912
  buffer_load_ushort v106, v88, s[8:11], s52 offen
  s_add_u32 s52, s51, 10368
  buffer_load_ushort v107, v88, s[8:11], s52 offen
  s_add_u32 s52, s51, 55296
  buffer_load_ushort v108, v88, s[8:11], s52 offen
  s_add_u32 s52, s51, 58752
  buffer_load_ushort v109, v88, s[8:11], s52 offen
  s_add_u32 s52, s51, 62208
  buffer_load_ushort v110, v88, s[8:11], s52 offen
  s_add_u32 s52, s51, 65664
  buffer_load_ushort v111, v88, s[8:11], s52 offen
  s_lshl_b32 s48, s22, 2
  s_add_u32 s48, s48, s20
  s_lshr_b32 s49, s21, 3
  s_mul_i32 s49, s49, 54
  s_add_u32 s49, s49, s48
  s_and_b32 s50, s21, 7
  s_lshr_b32 s51, s50, 2
  s_sub_u32 s50, s50, s51
  s_mul_i32 s51, s49, 10923
  s_lshr_b32 s51, s51, 16
  s_mul_i32 s52, s51, 6
  s_sub_u32 s52, s49, s52
  s_lshl_b32 s51, s51, 2
  v_add_u32 v86, s51, v81
  v_lshrrev_b32 v89, 1, v86
  v_mul_u32_u24 v89, 18, v89
  v_and_b32 v90, 1, v86
  v_lshl_add_u32 v89, v90, 3, v89
  v_mul_u32_u24 v90, 72, v86
  v_subrev_u32 v90, 4592, v90
  v_cmp_le_u32 vcc, 64, v86
  v_mov_b32 v91, 2304
  v_mov_b32 v92, 20736
  v_cndmask_b32 v89, v89, v90, vcc
  v_cndmask_b32 v91, v91, v92, vcc
  v_mul_u32_u24 v89, 1152, v89
  v_lshl_add_u32 v89, v80, 1, v89
  s_mul_i32 s53, s50, 6
  s_add_u32 s53, s53, s52
  s_lshl_b32 s53, s53, 5
  s_mul_i32 s50, s50, 108
  s_add_u32 s50, s50, s49
  s_lshl_b32 s50, s50, 10
  s_add_u32 s50, s50, 0x1b01000
  s_and_b32 s51, s21, 3
  s_cmp_eq_u32 s51, 3
  s_cselect_b32 s48, 99, s48
  s_cmp_lt_u32 s48, 54
  s_cselect_b32 s68, s50, 0x7f000000
  s_cselect_b32 s53, s53, 0x7f000000
  buffer_load_ushort v112, v89, s[12:15], s53 offen
  buffer_load_ushort v113, v89, s[12:15], s53 offen offset:1152
  v_add_u32 v89, v89, v91
  buffer_load_ushort v114, v89, s[12:15], s53 offen
  buffer_load_ushort v115, v89, s[12:15], s53 offen offset:1152
  v_add_u32 v89, v89, v91
  buffer_load_ushort v116, v89, s[12:15], s53 offen
  buffer_load_ushort v117, v89, s[12:15], s53 offen offset:1152
  v_add_u32 v89, v89, v91
  buffer_load_ushort v118, v89, s[12:15], s53 offen
  buffer_load_ushort v119, v89, s[12:15], s53 offen offset:1152
  s_cmp_eq_u32 s20, 3
  s_cbranch_scc1 m_Z_6
  s_mov_b32 s8, s88
  s_and_b32 s9, s89, 0xffff
  s_mov_b32 s10, 0x240000
  s_mov_b32 s11, 0x20000
  v_lshrrev_b32 v5, 2, v2
  v_lshlrev_b32 v5, 6, v5
  v_and_b32 v6, 3, v2
  v_lshl_add_u32 v5, v6, 3, v5
  v_mul_u32_u24 v6, 1152, v1
  v_add_u32 v5, v5, v6
  s_mul_i32 s28, s25, 9216
  s_lshl_b32 s29, s44, 4
  s_add_u32 s29, s29, s28
  buffer_load_dwordx2 v[8:9], v5, s[8:11], s29 offen
  buffer_load_dwordx2 v[10:11], v5, s[8:11], s29 offen offset:32
  s_lshl_b32 s29, s45, 4
  s_add_u32 s29, s29, s28
  buffer_load_dwordx2 v[12:13], v5, s[8:11], s29 offen
  buffer_load_dwordx2 v[14:15], v5, s[8:11], s29 offen offset:32
  s_lshl_b32 s29, s46, 4
  s_add_u32 s29, s29, s28
  buffer_load_dwordx2 v[16:17], v5, s[8:11], s29 offen
  buffer_load_dwordx2 v[18:19], v5, s[8:11], s29 offen offset:32
  s_mov_b32 s31, 0x3ae38e39
  s_cmp_eq_u32 s22, 15
  s_cbranch_scc1 m_Z_8
  s_waitcnt vmcnt(6)
  v_lshl_or_b32 v204, v97, 16, v96
  v_lshl_or_b32 v205, v99, 16, v98
  v_lshl_or_b32 v206, v101, 16, v100
  v_lshl_or_b32 v207, v103, 16, v102
  buffer_store_dwordx4 v[204:207], v253, s[4:7], s66 offen sc1
  v_lshl_or_b32 v208, v105, 16, v104
  v_lshl_or_b32 v209, v107, 16, v106
  v_lshl_or_b32 v210, v109, 16, v108
  v_lshl_or_b32 v211, v111, 16, v110
  buffer_store_dwordx4 v[208:211], v253, s[4:7], s67 offen sc1
  v_lshl_or_b32 v212, v113, 16, v112
  v_lshl_or_b32 v213, v115, 16, v114
  v_lshl_or_b32 v214, v117, 16, v116
  v_lshl_or_b32 v215, v119, 16, v118
  buffer_store_dwordx4 v[212:215], v253, s[4:7], s68 offen sc1
  s_waitcnt vmcnt(3)
  s_branch m_ln
m_Z_8:
  v_lshrrev_b32 v93, 2, v252
  v_min_u32 v93, 11, v93
  v_mul_u32_u24 v94, 1152, v93
  v_and_b32 v95, 3, v252
  v_lshl_add_u32 v94, v95, 4, v94
  s_mul_i32 s69, s21, 36
  s_mul_i32 s30, s20, 12
  s_add_u32 s69, s69, s30
  s_mul_i32 s29, s69, 1152
  buffer_load_dwordx4 v[120:123], v94, s[12:15], s29 offen offset:0
  buffer_load_dwordx4 v[124:127], v94, s[12:15], s29 offen offset:64
  buffer_load_dwordx4 v[128:131], v94, s[12:15], s29 offen offset:128
  buffer_load_dwordx4 v[132:135], v94, s[12:15], s29 offen offset:192
  buffer_load_dwordx4 v[136:139], v94, s[12:15], s29 offen offset:256
  buffer_load_dwordx4 v[140:143], v94, s[12:15], s29 offen offset:320
  buffer_load_dwordx4 v[144:147], v94, s[12:15], s29 offen offset:384
  buffer_load_dwordx4 v[148:151], v94, s[12:15], s29 offen offset:448
  buffer_load_dwordx4 v[152:155], v94, s[12:15], s29 offen offset:512
  buffer_load_dwordx4 v[156:159], v94, s[12:15], s29 offen offset:576
  buffer_load_dwordx4 v[160:163], v94, s[12:15], s29 offen offset:640
  buffer_load_dwordx4 v[164:167], v94, s[12:15], s29 offen offset:704
  buffer_load_dwordx4 v[168:171], v94, s[12:15], s29 offen offset:768
  buffer_load_dwordx4 v[172:175], v94, s[12:15], s29 offen offset:832
  buffer_load_dwordx4 v[176:179], v94, s[12:15], s29 offen offset:896
  buffer_load_dwordx4 v[180:183], v94, s[12:15], s29 offen offset:960
  buffer_load_dwordx4 v[184:187], v94, s[12:15], s29 offen offset:1024
  buffer_load_dwordx4 v[188:191], v94, s[12:15], s29 offen offset:1088
  s_waitcnt vmcnt(24)
  v_lshl_or_b32 v204, v97, 16, v96
  v_lshl_or_b32 v205, v99, 16, v98
  v_lshl_or_b32 v206, v101, 16, v100
  v_lshl_or_b32 v207, v103, 16, v102
  buffer_store_dwordx4 v[204:207], v253, s[4:7], s66 offen sc1
  v_lshl_or_b32 v208, v105, 16, v104
  v_lshl_or_b32 v209, v107, 16, v106
  v_lshl_or_b32 v210, v109, 16, v108
  v_lshl_or_b32 v211, v111, 16, v110
  buffer_store_dwordx4 v[208:211], v253, s[4:7], s67 offen sc1
  v_lshl_or_b32 v212, v113, 16, v112
  v_lshl_or_b32 v213, v115, 16, v114
  v_lshl_or_b32 v214, v117, 16, v116
  v_lshl_or_b32 v215, v119, 16, v118
  buffer_store_dwordx4 v[212:215], v253, s[4:7], s68 offen sc1
  s_waitcnt vmcnt(21)
  s_branch m_ln
m_zret:
  s_cmp_eq_u32 s20, 1
  s_cselect_b32 s28, s28, 0x7f000000
  s_mov_b64 exec, 0xff
  buffer_store_dword v34, v36, s[4:7], s28 offen sc1
  s_mov_b64 exec, -1
  v_mov_b32 v13, 160512
  ds_read_b32 v13, v13
  s_cmp_lg_u32 s22, 15
  s_cbranch_scc1 m_Z_4
  s_mov_b32 s32, 0x3f803f80
  v_mov_b32 v8, 0
  v_mov_b32 v9, 0
  v_dot2_f32_bf16 v8, v120, s32, v8
  v_dot2_f32_bf16 v9, v121, s32, v9
  v_dot2_f32_bf16 v8, v122, s32, v8
  v_dot2_f32_bf16 v9, v123, s32, v9
  v_dot2_f32_bf16 v8, v124, s32, v8
  v_dot2_f32_bf16 v9, v125, s32, v9
  v_dot2_f32_bf16 v8, v126, s32, v8
  v_dot2_f32_bf16 v9, v127, s32, v9
  v_dot2_f32_bf16 v8, v128, s32, v8
  v_dot2_f32_bf16 v9, v129, s32, v9
  v_dot2_f32_bf16 v8, v130, s32, v8
  v_dot2_f32_bf16 v9, v131, s32, v9
  v_dot2_f32_bf16 v8, v132, s32, v8
  v_dot2_f32_bf16 v9, v133, s32, v9
  v_dot2_f32_bf16 v8, v134, s32, v8
  v_dot2_f32_bf16 v9, v135, s32, v9
  v_dot2_f32_bf16 v8, v136, s32, v8
  v_dot2_f32_bf16 v9, v137, s32, v9
  v_dot2_f32_bf16 v8, v138, s32, v8
  v_dot2_f32_bf16 v9, v139, s32, v9
  v_dot2_f32_bf16 v8, v140, s32, v8
  v_dot2_f32_bf16 v9, v141, s32, v9
  v_dot2_f32_bf16 v8, v142, s32, v8
  v_dot2_f32_bf16 v9, v143, s32, v9
  v_dot2_f32_bf16 v8, v144, s32, v8
  v_dot2_f32_bf16 v9, v145, s32, v9
  v_dot2_f32_bf16 v8, v146, s32, v8
  v_dot2_f32_bf16 v9, v147, s32, v9
  v_dot2_f32_bf16 v8, v148, s32, v8
  v_dot2_f32_bf16 v9, v149, s32, v9
  v_dot2_f32_bf16 v8, v150, s32, v8
  v_dot2_f32_bf16 v9, v151, s32, v9
  v_dot2_f32_bf16 v8, v152, s32, v8
  v_dot2_f32_bf16 v9, v153, s32, v9
  v_dot2_f32_bf16 v8, v154, s32, v8
  v_dot2_f32_bf16 v9, v155, s32, v9
  v_dot2_f32_bf16 v8, v156, s32, v8
  v_dot2_f32_bf16 v9, v157, s32, v9
  v_dot2_f32_bf16 v8, v158, s32, v8
  v_dot2_f32_bf16 v9, v159, s32, v9
  v_dot2_f32_bf16 v8, v160, s32, v8
  v_dot2_f32_bf16 v9, v161, s32, v9
  v_dot2_f32_bf16 v8, v162, s32, v8
  v_dot2_f32_bf16 v9, v163, s32, v9
  v_dot2_f32_bf16 v8, v164, s32, v8
  v_dot2_f32_bf16 v9, v165, s32, v9
  v_dot2_f32_bf16 v8, v166, s32, v8
  v_dot2_f32_bf16 v9, v167, s32, v9
  v_dot2_f32_bf16 v8, v168, s32, v8
  v_dot2_f32_bf16 v9, v169, s32, v9
  v_dot2_f32_bf16 v8, v170, s32, v8
  v_dot2_f32_bf16 v9, v171, s32, v9
  v_dot2_f32_bf16 v8, v172, s32, v8
  v_dot2_f32_bf16 v9, v173, s32, v9
  v_dot2_f32_bf16 v8, v174, s32, v8
  v_dot2_f32_bf16 v9, v175, s32, v9
  v_dot2_f32_bf16 v8, v176, s32, v8
  v_dot2_f32_bf16 v9, v177, s32, v9
  v_dot2_f32_bf16 v8, v178, s32, v8
  v_dot2_f32_bf16 v9, v179, s32, v9
  v_dot2_f32_bf16 v8, v180, s32, v8
  v_dot2_f32_bf16 v9, v181, s32, v9
  v_dot2_f32_bf16 v8, v182, s32, v8
  v_dot2_f32_bf16 v9, v183, s32, v9
  v_dot2_f32_bf16 v8, v184, s32, v8
  v_dot2_f32_bf16 v9, v185, s32, v9
  v_dot2_f32_bf16 v8, v186, s32, v8
  v_dot2_f32_bf16 v9, v187, s32, v9
  v_dot2_f32_bf16 v8, v188, s32, v8
  v_dot2_f32_bf16 v9, v189, s32, v9
  v_dot2_f32_bf16 v8, v190, s32, v8
  v_dot2_f32_bf16 v9, v191, s32, v9
  s_nop 4
  v_add_f32 v8, v8, v9
  s_nop 1
  v_add_f32_dpp v8, v8, v8 quad_perm:[1,0,3,2] row_mask:0xf bank_mask:0xf
  s_nop 1
  v_add_f32_dpp v8, v8, v8 quad_perm:[2,3,0,1] row_mask:0xf bank_mask:0xf
  v_mul_f32 v8, s31, v8
  v_lshlrev_b32 v9, 2, v93
  s_lshl_b32 s69, s21, 8
  s_mul_i32 s30, s20, 48
  s_add_u32 s69, s69, s30
  s_add_u32 s69, s69, 0x17c0000
  s_mov_b32 exec_lo, 0x11111111
  s_mov_b32 exec_hi, 0x1111
  buffer_store_dword v8, v9, s[4:7], s69 offen sc1
  s_mov_b64 exec, -1
m_Z_4:
  s_lshl_b32 s48, s22, 8
  s_lshl_b32 s49, s21, 8
  s_add_u32 s49, s49, 4096
  s_xor_b32 s50, s49, 0x800
  s_sub_u32 s51, s48, 32
  v_mov_b32 v10, s48
  v_mov_b32 v11, s49
  v_cmp_eq_u32 vcc, 1, v81
  v_mov_b32 v12, s50
  v_cndmask_b32 v10, v10, v11, vcc
  v_cmp_eq_u32 vcc, 2, v81
  v_mov_b32 v11, s51
  v_cndmask_b32 v10, v10, v12, vcc
  v_cmp_eq_u32 vcc, 3, v81
  s_lshl_b32 s52, s21, 4
  v_cndmask_b32 v10, v10, v11, vcc
  v_lshl_add_u32 v10, v80, 4, v10
  s_add_u32 s48, s48, s52
  s_lshl_b32 s52, s22, 4
  s_add_u32 s49, s49, s52
  v_mov_b32 v11, s48
  v_mov_b32 v12, s49
  v_cmp_eq_u32 vcc, 0, v252
  s_mov_b32 s62, 0x17e1000
  v_cndmask_b32 v11, v12, v11, vcc
  s_cmp_eq_u32 s22, 0
  s_cselect_b32 s65, 0, 3
  s_lshl_b32 s65, s65, 16
  s_or_b32 s65, s65, 0xffff
  s_mov_b32 s64, -1
  s_waitcnt vmcnt(0) lgkmcnt(0)
  v_readfirstlane_b32 s97, v13
  s_barrier
  s_cmp_lg_u32 s20, 0
  s_cbranch_scc1 m_Z_7
  s_mov_b64 exec, 3
  buffer_store_dword v13, v11, s[4:7], s62 offen sc1
  s_mov_b64 exec, s[64:65]
  s_mov_b32 s63, 0
m_Z_9:
  buffer_load_dword v9, v10, s[4:7], s62 offen sc1
  s_add_u32 s63, s63, 1
  s_waitcnt vmcnt(0)
  v_cmp_eq_u32 vcc, s97, v9
  s_cmp_eq_u64 vcc, s[64:65]
  s_cbranch_scc1 m_Z_10
  s_sleep 1
  s_cmp_lt_u32 s63, 0x30d40
  s_cbranch_scc1 m_Z_9
m_Z_10:
  s_mov_b64 exec, -1
  s_branch m_Z_7
m_Z_6:
  v_lshlrev_b32 v8, 7, v252
  s_lshl_b32 s48, s2, 9
  s_add_u32 s48, s48, 0x17c1000
  s_lshl_b32 s49, s2, 10
  s_add_u32 s49, s49, 0x18c0e00
  s_min_u32 s50, s2, 95
  s_lshl_b32 s50, s50, 7
  s_add_u32 s50, s50, 0x17e0a00
  v_add_u32 v9, s48, v8
  v_add_u32 v10, s49, v8
  v_cmp_gt_u32 vcc, 4, v252
  v_add_u32 v11, s50, v8
  v_cndmask_b32 v9, v10, v9, vcc
  v_cmp_gt_u32 vcc, 12, v252
  s_mov_b64 exec, 0x1fff
  v_cndmask_b32 v9, v11, v9, vcc
  buffer_load_dword v10, v9, s[4:7], 0 offen sc1
  s_mov_b64 exec, -1
  s_waitcnt vmcnt(1)
  v_lshl_or_b32 v204, v97, 16, v96
  v_lshl_or_b32 v205, v99, 16, v98
  v_lshl_or_b32 v206, v101, 16, v100
  v_lshl_or_b32 v207, v103, 16, v102
  buffer_store_dwordx4 v[204:207], v253, s[4:7], s66 offen sc1
  v_lshl_or_b32 v208, v105, 16, v104
  v_lshl_or_b32 v209, v107, 16, v106
  v_lshl_or_b32 v210, v109, 16, v108
  v_lshl_or_b32 v211, v111, 16, v110
  buffer_store_dwordx4 v[208:211], v253, s[4:7], s67 offen sc1
  v_lshl_or_b32 v212, v113, 16, v112
  v_lshl_or_b32 v213, v115, 16, v114
  v_lshl_or_b32 v214, v117, 16, v116
  v_lshl_or_b32 v215, v119, 16, v118
  buffer_store_dwordx4 v[212:215], v253, s[4:7], s68 offen sc1
  v_mov_b32 v9, 0
  s_mov_b32 s63, 0
m_Z_11:
  buffer_load_dword v8, v9, s[16:19], 0 offen sc1
  s_add_u32 s63, s63, 1
  s_waitcnt vmcnt(0)
  v_readfirstlane_b32 s97, v8
  s_cmp_lg_u32 s97, 0
  s_cbranch_scc1 m_Z_12
  s_cmp_lt_u32 s63, 0x30d40
  s_cbranch_scc1 m_Z_11
m_Z_12:
  v_mov_b32 v9, 160512
  ds_write_b32 v9, v8
  s_lshl_b32 s62, s21, 8
  s_add_u32 s62, s62, 0x17e3000
  s_lshl_b32 s48, s22, 4
  v_mov_b32 v11, s48
  s_mov_b64 s[64:65], 0xffff
  s_waitcnt lgkmcnt(0)
  s_barrier
  s_mov_b64 exec, 1
  buffer_store_dword v8, v11, s[4:7], s62 offen sc1
  s_mov_b64 exec, -1
  s_barrier
  s_mov_b64 exec, s[64:65]
  s_mov_b32 s63, 0
m_Z_13:
  buffer_load_dword v9, v253, s[4:7], s62 offen sc1
  s_add_u32 s63, s63, 1
  s_waitcnt vmcnt(0)
  v_cmp_eq_u32 vcc, s97, v9
  s_cmp_eq_u64 vcc, s[64:65]
  s_cbranch_scc1 m_Z_14
  s_sleep 1
  s_cmp_lt_u32 s63, 0x30d40
  s_cbranch_scc1 m_Z_13
m_Z_14:
  s_mov_b64 exec, -1
  s_lshl_b32 s25, s21, 17
  s_add_u32 s25, s25, 0x1901000
  s_mov_b32 m0, 0
  s_mov_b32 s63, 0
m_pfZ_15:
  buffer_load_dwordx4 v253, s[4:7], s25 offen offset:0 sc1 lds
  buffer_load_dwordx4 v253, s[4:7], s25 offen offset:1024 sc1 lds
  buffer_load_dwordx4 v253, s[4:7], s25 offen offset:2048 sc1 lds
  buffer_load_dwordx4 v253, s[4:7], s25 offen offset:3072 sc1 lds
  s_add_u32 m0, m0, 4096
  s_add_u32 s25, s25, 4096
  s_add_u32 s63, s63, 1
  s_cmp_lt_u32 s63, 24
  s_cbranch_scc1 m_pfZ_15
m_Z_7:
  s_barrier
  s_mul_i32 s24, s20, 8192
  s_add_u32 s24, s24, 98304
  s_lshl_b32 s25, s21, 17
  s_add_u32 s25, s25, s24
  s_add_u32 s25, s25, 0x1901000
  s_mov_b32 m0, s24
  s_mov_b32 s63, 0
m_pfZ_16:
  buffer_load_dwordx4 v253, s[4:7], s25 offen offset:0 sc1 lds
  buffer_load_dwordx4 v253, s[4:7], s25 offen offset:1024 sc1 lds
  buffer_load_dwordx4 v253, s[4:7], s25 offen offset:2048 sc1 lds
  buffer_load_dwordx4 v253, s[4:7], s25 offen offset:3072 sc1 lds
  s_add_u32 m0, m0, 4096
  s_add_u32 s25, s25, 4096
  s_add_u32 s63, s63, 1
  s_cmp_lt_u32 s63, 2
  s_cbranch_scc1 m_pfZ_16
  s_mov_b32 s59, 0xbe0000
m_layer:
  s_lshl_b32 s24, s20, 10
  s_lshl_b32 s27, s22, 3
  s_max_u32 s28, s27, 1
  s_sub_u32 s28, s28, 1
  s_mul_i32 s28, s28, 18432
  s_add_u32 s28, s28, s23
  s_mul_i32 s29, s20, 5120
  s_add_u32 s28, s28, s29
  s_add_u32 s29, s29, 129024
  s_lshl_b32 s30, s20, 1
  s_add_u32 s30, s30, s27
  s_mul_i32 s31, s30, 18432
  s_add_u32 s31, s31, s23
  s_mov_b32 s32, s31
  v_lshrrev_b32 v2, 5, v252
  v_mul_u32_u24 v233, 72, v2
  s_mul_i32 s33, s21, 256
  s_add_u32 s33, s33, 0x17c0000
  v_add_u32 v218, 0x0, v253
  v_add_u32 v221, s24, v218
  v_add_u32 v219, 0xc000, v253
  v_add_u32 v222, s24, v219
  v_add_u32 v220, 0x18000, v253
  v_add_u32 v223, s24, v220
  s_cmp_eq_u32 s23, 0
  s_cbranch_scc1 m_A_nosync_18
  s_lshl_b32 s34, s20, 6
  s_cmp_lg_u32 s20, 0
  s_cbranch_scc1 m_wf_skip_21
  v_lshlrev_b32 v250, 2, v252
  s_add_u32 s62, s60, 0xffffbc00
  s_movk_i32 s63, 256
  v_lshrrev_b32 v251, 2, v252
  v_lshlrev_b32 v251, 2, v251
  v_add_u32 v251, 224, v251
  v_add_u32 v250, s63, v250
  s_mov_b32 vcc_lo, 0x08880888
  s_mov_b32 vcc_hi, 0
  s_cmp_eq_u32 s22, 0
  s_cselect_b32 s64, 0, 0x08880888
  v_cndmask_b32 v250, v250, v251, vcc
  s_or_b32 s64, s64, 0x77777777
  v_lshlrev_b32 v250, 2, v250
  s_mov_b32 s65, 0x77777777
  s_mov_b64 exec, s[64:65]
  s_mov_b32 s63, 0
m_wf_loop_19:
  buffer_load_dword v246, v250, s[4:7], s62 offen sc1
  s_waitcnt vmcnt(0)
  v_cmp_eq_u32 vcc, s97, v246
  s_cmp_eq_u64 vcc, s[64:65]
  s_cbranch_scc1 m_wf_done_20
  s_add_u32 s63, s63, 1
  s_cmp_lt_u32 s63, 0x30d40
  s_cbranch_scc1 m_wf_loop_19
m_wf_done_20:
  s_mov_b64 exec, -1
m_wf_skip_21:
  s_barrier
m_A_nosync_18:
  buffer_load_dwordx4 a[0:3], v253, s[4:7], s32 offen offset:0 sc1
  buffer_load_dwordx4 a[72:75], v254, s[4:7], s32 offen offset:0 sc1
  buffer_load_dwordx4 a[4:7], v253, s[4:7], s32 offen offset:1024 sc1
  buffer_load_dwordx4 a[76:79], v254, s[4:7], s32 offen offset:1024 sc1
  buffer_load_dwordx4 a[8:11], v253, s[4:7], s32 offen offset:2048 sc1
  buffer_load_dwordx4 a[80:83], v254, s[4:7], s32 offen offset:2048 sc1
  buffer_load_dwordx4 a[12:15], v253, s[4:7], s32 offen offset:3072 sc1
  buffer_load_dwordx4 a[84:87], v254, s[4:7], s32 offen offset:3072 sc1
  s_add_u32 s32, s32, 4096
  buffer_load_dwordx4 a[16:19], v253, s[4:7], s32 offen offset:0 sc1
  buffer_load_dwordx4 a[88:91], v254, s[4:7], s32 offen offset:0 sc1
  buffer_load_dwordx4 a[20:23], v253, s[4:7], s32 offen offset:1024 sc1
  buffer_load_dwordx4 a[92:95], v254, s[4:7], s32 offen offset:1024 sc1
  s_waitcnt vmcnt(12)
  s_barrier
  s_lshl_b32 s34, s22, 2
  s_and_b32 s35, s21, 3
  s_add_u32 s34, s34, s35
  s_lshl_b32 s34, s34, 2
  s_add_u32 s34, s34, s20
  s_mul_i32 s34, s34, 41
  v_min_u32 v234, 40, v252
  v_add_u32 v234, s34, v234
  v_min_u32 v234, 0x287f, v234
  v_mul_u32_u24 v235, 3641, v234
  v_lshrrev_b32 v235, 16, v235
  v_lshlrev_b32 v234, 7, v234
  v_mul_u32_u24 v235, 6912, v235
  v_add_u32 v234, v235, v234
  s_lshr_b32 s35, s21, 2
  s_mul_i32 s35, s35, 2304
  s_cmp_eq_u32 s23, 0
  s_cselect_b32 s35, s35, 0x7f000000
  s_mov_b32 s8, s36
  s_and_b32 s9, s37, 0xffff
  s_mov_b32 s10, 0x510000
  s_mov_b32 s11, 0x20000
  s_mov_b32 s12, s38
  s_and_b32 s13, s39, 0xffff
  s_mov_b32 s14, 0x510000
  s_mov_b32 s15, 0x20000
  ds_read_b128 a[144:147], v218 offset:0
  ds_read_b128 a[148:151], v218 offset:1024
  ds_read_b128 a[152:155], v218 offset:2048
  ds_read_b128 a[156:159], v218 offset:3072
  ds_read_b128 a[160:163], v218 offset:4096
  ds_read_b128 a[164:167], v218 offset:5120
  ds_read_b128 a[168:171], v218 offset:6144
  ds_read_b128 a[172:175], v218 offset:7168
  s_waitcnt vmcnt(10)
  s_waitcnt lgkmcnt(6)
  v_mfma_f32_16x16x32_bf16 v[0:3], a[144:147], a[0:3], 0
  ds_read_b128 a[176:179], v218 offset:8192
  v_mfma_f32_16x16x32_bf16 v[28:31], a[144:147], a[72:75], 0
  buffer_load_dwordx4 a[24:27], v253, s[4:7], s32 offen offset:2048 sc1
  v_mfma_f32_16x16x32_bf16 v[4:7], a[148:151], a[0:3], 0
  ds_read_b128 a[180:183], v218 offset:9216
  v_mfma_f32_16x16x32_bf16 v[32:35], a[148:151], a[72:75], 0
  s_waitcnt lgkmcnt(6)
  v_mfma_f32_16x16x32_bf16 v[8:11], a[152:155], a[0:3], 0
  ds_read_b128 a[184:187], v218 offset:10240
  v_mfma_f32_16x16x32_bf16 v[36:39], a[152:155], a[72:75], 0
  buffer_load_dwordx4 a[96:99], v254, s[4:7], s32 offen offset:2048 sc1
  v_mfma_f32_16x16x32_bf16 v[12:15], a[156:159], a[0:3], 0
  ds_read_b128 a[188:191], v218 offset:11264
  v_mfma_f32_16x16x32_bf16 v[40:43], a[156:159], a[72:75], 0
  s_waitcnt lgkmcnt(6)
  v_mfma_f32_16x16x32_bf16 v[16:19], a[160:163], a[0:3], 0
  ds_read_b128 a[144:147], v218 offset:12288
  v_mfma_f32_16x16x32_bf16 v[44:47], a[160:163], a[72:75], 0
  buffer_load_dwordx4 a[28:31], v253, s[4:7], s32 offen offset:3072 sc1
  v_mfma_f32_16x16x32_bf16 v[20:23], a[164:167], a[0:3], 0
  ds_read_b128 a[148:151], v218 offset:13312
  v_mfma_f32_16x16x32_bf16 v[48:51], a[164:167], a[72:75], 0
  s_waitcnt lgkmcnt(6)
  v_mfma_f32_16x16x32_bf16 v[24:27], a[168:171], a[0:3], 0
  ds_read_b128 a[152:155], v218 offset:14336
  v_mfma_f32_16x16x32_bf16 v[52:55], a[168:171], a[72:75], 0
  buffer_load_dwordx4 a[100:103], v254, s[4:7], s32 offen offset:3072 sc1
  s_waitcnt vmcnt(12)
  v_mfma_f32_16x16x32_bf16 v[0:3], a[172:175], a[4:7], v[0:3]
  ds_read_b128 a[156:159], v218 offset:15360
  v_mfma_f32_16x16x32_bf16 v[28:31], a[172:175], a[76:79], v[28:31]
  s_waitcnt lgkmcnt(6)
  v_mfma_f32_16x16x32_bf16 v[4:7], a[176:179], a[4:7], v[4:7]
  ds_read_b128 a[160:163], v218 offset:16384
  v_mfma_f32_16x16x32_bf16 v[32:35], a[176:179], a[76:79], v[32:35]
  s_add_u32 s32, s32, 4096
  buffer_load_dwordx4 a[32:35], v253, s[4:7], s32 offen offset:0 sc1
  v_mfma_f32_16x16x32_bf16 v[8:11], a[180:183], a[4:7], v[8:11]
  ds_read_b128 a[164:167], v218 offset:17408
  v_mfma_f32_16x16x32_bf16 v[36:39], a[180:183], a[76:79], v[36:39]
  s_waitcnt lgkmcnt(6)
  v_mfma_f32_16x16x32_bf16 v[12:15], a[184:187], a[4:7], v[12:15]
  ds_read_b128 a[168:171], v218 offset:18432
  v_mfma_f32_16x16x32_bf16 v[40:43], a[184:187], a[76:79], v[40:43]
  buffer_load_dwordx4 a[104:107], v254, s[4:7], s32 offen offset:0 sc1
  v_mfma_f32_16x16x32_bf16 v[16:19], a[188:191], a[4:7], v[16:19]
  ds_read_b128 a[172:175], v218 offset:19456
  v_mfma_f32_16x16x32_bf16 v[44:47], a[188:191], a[76:79], v[44:47]
  s_waitcnt lgkmcnt(6)
  v_mfma_f32_16x16x32_bf16 v[20:23], a[144:147], a[4:7], v[20:23]
  ds_read_b128 a[176:179], v218 offset:20480
  v_mfma_f32_16x16x32_bf16 v[48:51], a[144:147], a[76:79], v[48:51]
  buffer_load_dwordx4 a[36:39], v253, s[4:7], s32 offen offset:1024 sc1
  v_mfma_f32_16x16x32_bf16 v[24:27], a[148:151], a[4:7], v[24:27]
  ds_read_b128 a[180:183], v218 offset:21504
  v_mfma_f32_16x16x32_bf16 v[52:55], a[148:151], a[76:79], v[52:55]
  s_waitcnt vmcnt(13)
  s_waitcnt lgkmcnt(6)
  v_mfma_f32_16x16x32_bf16 v[0:3], a[152:155], a[8:11], v[0:3]
  ds_read_b128 a[184:187], v218 offset:22528
  v_mfma_f32_16x16x32_bf16 v[28:31], a[152:155], a[80:83], v[28:31]
  buffer_load_dwordx4 a[108:111], v254, s[4:7], s32 offen offset:1024 sc1
  v_mfma_f32_16x16x32_bf16 v[4:7], a[156:159], a[8:11], v[4:7]
  ds_read_b128 a[188:191], v218 offset:23552
  v_mfma_f32_16x16x32_bf16 v[32:35], a[156:159], a[80:83], v[32:35]
  s_waitcnt lgkmcnt(6)
  v_mfma_f32_16x16x32_bf16 v[8:11], a[160:163], a[8:11], v[8:11]
  ds_read_b128 a[144:147], v218 offset:24576
  v_mfma_f32_16x16x32_bf16 v[36:39], a[160:163], a[80:83], v[36:39]
  buffer_load_dwordx4 a[40:43], v253, s[4:7], s32 offen offset:2048 sc1
  v_mfma_f32_16x16x32_bf16 v[12:15], a[164:167], a[8:11], v[12:15]
  ds_read_b128 a[148:151], v218 offset:25600
  v_mfma_f32_16x16x32_bf16 v[40:43], a[164:167], a[80:83], v[40:43]
  s_waitcnt lgkmcnt(6)
  v_mfma_f32_16x16x32_bf16 v[16:19], a[168:171], a[8:11], v[16:19]
  ds_read_b128 a[152:155], v218 offset:26624
  v_mfma_f32_16x16x32_bf16 v[44:47], a[168:171], a[80:83], v[44:47]
  buffer_load_dwordx4 a[112:115], v254, s[4:7], s32 offen offset:2048 sc1
  v_mfma_f32_16x16x32_bf16 v[20:23], a[172:175], a[8:11], v[20:23]
  ds_read_b128 a[156:159], v218 offset:27648
  v_mfma_f32_16x16x32_bf16 v[48:51], a[172:175], a[80:83], v[48:51]
  s_waitcnt lgkmcnt(6)
  v_mfma_f32_16x16x32_bf16 v[24:27], a[176:179], a[8:11], v[24:27]
  ds_read_b128 a[160:163], v218 offset:28672
  v_mfma_f32_16x16x32_bf16 v[52:55], a[176:179], a[80:83], v[52:55]
  buffer_load_dwordx4 a[44:47], v253, s[4:7], s32 offen offset:3072 sc1
  s_waitcnt vmcnt(15)
  v_mfma_f32_16x16x32_bf16 v[0:3], a[180:183], a[12:15], v[0:3]
  ds_read_b128 a[164:167], v218 offset:29696
  v_mfma_f32_16x16x32_bf16 v[28:31], a[180:183], a[84:87], v[28:31]
  s_waitcnt lgkmcnt(6)
  v_mfma_f32_16x16x32_bf16 v[4:7], a[184:187], a[12:15], v[4:7]
  ds_read_b128 a[168:171], v218 offset:30720
  v_mfma_f32_16x16x32_bf16 v[32:35], a[184:187], a[84:87], v[32:35]
  buffer_load_dwordx4 a[116:119], v254, s[4:7], s32 offen offset:3072 sc1
  v_mfma_f32_16x16x32_bf16 v[8:11], a[188:191], a[12:15], v[8:11]
  ds_read_b128 a[172:175], v218 offset:31744
  v_mfma_f32_16x16x32_bf16 v[36:39], a[188:191], a[84:87], v[36:39]
  s_waitcnt lgkmcnt(6)
  v_mfma_f32_16x16x32_bf16 v[12:15], a[144:147], a[12:15], v[12:15]
  ds_read_b128 a[176:179], v218 offset:32768
  v_mfma_f32_16x16x32_bf16 v[40:43], a[144:147], a[84:87], v[40:43]
  s_add_u32 s32, s32, 4096
  buffer_load_dwordx4 a[48:51], v253, s[4:7], s32 offen offset:0 sc1
  v_mfma_f32_16x16x32_bf16 v[16:19], a[148:151], a[12:15], v[16:19]
  ds_read_b128 a[180:183], v218 offset:33792
  v_mfma_f32_16x16x32_bf16 v[44:47], a[148:151], a[84:87], v[44:47]
  s_waitcnt lgkmcnt(6)
  v_mfma_f32_16x16x32_bf16 v[20:23], a[152:155], a[12:15], v[20:23]
  ds_read_b128 a[184:187], v218 offset:34816
  v_mfma_f32_16x16x32_bf16 v[48:51], a[152:155], a[84:87], v[48:51]
  buffer_load_dwordx4 a[120:123], v254, s[4:7], s32 offen offset:0 sc1
  v_mfma_f32_16x16x32_bf16 v[24:27], a[156:159], a[12:15], v[24:27]
  ds_read_b128 a[188:191], v218 offset:35840
  v_mfma_f32_16x16x32_bf16 v[52:55], a[156:159], a[84:87], v[52:55]
  s_waitcnt vmcnt(16)
  s_waitcnt lgkmcnt(6)
  v_mfma_f32_16x16x32_bf16 v[0:3], a[160:163], a[16:19], v[0:3]
  ds_read_b128 a[144:147], v218 offset:36864
  v_mfma_f32_16x16x32_bf16 v[28:31], a[160:163], a[88:91], v[28:31]
  buffer_load_dwordx4 a[52:55], v253, s[4:7], s32 offen offset:1024 sc1
  v_mfma_f32_16x16x32_bf16 v[4:7], a[164:167], a[16:19], v[4:7]
  ds_read_b128 a[148:151], v218 offset:37888
  v_mfma_f32_16x16x32_bf16 v[32:35], a[164:167], a[88:91], v[32:35]
  s_waitcnt lgkmcnt(6)
  v_mfma_f32_16x16x32_bf16 v[8:11], a[168:171], a[16:19], v[8:11]
  ds_read_b128 a[152:155], v218 offset:38912
  v_mfma_f32_16x16x32_bf16 v[36:39], a[168:171], a[88:91], v[36:39]
  buffer_load_dwordx4 a[124:127], v254, s[4:7], s32 offen offset:1024 sc1
  v_mfma_f32_16x16x32_bf16 v[12:15], a[172:175], a[16:19], v[12:15]
  ds_read_b128 a[156:159], v218 offset:39936
  v_mfma_f32_16x16x32_bf16 v[40:43], a[172:175], a[88:91], v[40:43]
  s_waitcnt lgkmcnt(6)
  v_mfma_f32_16x16x32_bf16 v[16:19], a[176:179], a[16:19], v[16:19]
  ds_read_b128 a[160:163], v218 offset:40960
  v_mfma_f32_16x16x32_bf16 v[44:47], a[176:179], a[88:91], v[44:47]
  buffer_load_dwordx4 a[56:59], v253, s[4:7], s32 offen offset:2048 sc1
  v_mfma_f32_16x16x32_bf16 v[20:23], a[180:183], a[16:19], v[20:23]
  ds_read_b128 a[164:167], v218 offset:41984
  v_mfma_f32_16x16x32_bf16 v[48:51], a[180:183], a[88:91], v[48:51]
  s_waitcnt lgkmcnt(6)
  v_mfma_f32_16x16x32_bf16 v[24:27], a[184:187], a[16:19], v[24:27]
  ds_read_b128 a[168:171], v218 offset:43008
  v_mfma_f32_16x16x32_bf16 v[52:55], a[184:187], a[88:91], v[52:55]
  buffer_load_dwordx4 a[128:131], v254, s[4:7], s32 offen offset:2048 sc1
  s_waitcnt vmcnt(18)
  v_mfma_f32_16x16x32_bf16 v[0:3], a[188:191], a[20:23], v[0:3]
  ds_read_b128 a[172:175], v218 offset:44032
  v_mfma_f32_16x16x32_bf16 v[28:31], a[188:191], a[92:95], v[28:31]
  s_waitcnt lgkmcnt(6)
  v_mfma_f32_16x16x32_bf16 v[4:7], a[144:147], a[20:23], v[4:7]
  ds_read_b128 a[176:179], v218 offset:45056
  v_mfma_f32_16x16x32_bf16 v[32:35], a[144:147], a[92:95], v[32:35]
  buffer_load_dwordx4 a[60:63], v253, s[4:7], s32 offen offset:3072 sc1
  v_mfma_f32_16x16x32_bf16 v[8:11], a[148:151], a[20:23], v[8:11]
  ds_read_b128 a[180:183], v218 offset:46080
  v_mfma_f32_16x16x32_bf16 v[36:39], a[148:151], a[92:95], v[36:39]
  s_waitcnt lgkmcnt(6)
  v_mfma_f32_16x16x32_bf16 v[12:15], a[152:155], a[20:23], v[12:15]
  ds_read_b128 a[184:187], v218 offset:47104
  v_mfma_f32_16x16x32_bf16 v[40:43], a[152:155], a[92:95], v[40:43]
  buffer_load_dwordx4 a[132:135], v254, s[4:7], s32 offen offset:3072 sc1
  v_mfma_f32_16x16x32_bf16 v[16:19], a[156:159], a[20:23], v[16:19]
  ds_read_b128 a[188:191], v218 offset:48128
  v_mfma_f32_16x16x32_bf16 v[44:47], a[156:159], a[92:95], v[44:47]
  s_waitcnt lgkmcnt(6)
  v_mfma_f32_16x16x32_bf16 v[20:23], a[160:163], a[20:23], v[20:23]
  ds_read_b128 a[144:147], v219 offset:0
  v_mfma_f32_16x16x32_bf16 v[48:51], a[160:163], a[92:95], v[48:51]
  s_add_u32 s32, s32, 4096
  buffer_load_dwordx4 a[64:67], v253, s[4:7], s32 offen offset:0 sc1
  v_mfma_f32_16x16x32_bf16 v[24:27], a[164:167], a[20:23], v[24:27]
  ds_read_b128 a[148:151], v219 offset:1024
  v_mfma_f32_16x16x32_bf16 v[52:55], a[164:167], a[92:95], v[52:55]
  s_waitcnt vmcnt(19)
  s_waitcnt lgkmcnt(6)
  v_mfma_f32_16x16x32_bf16 v[0:3], a[168:171], a[24:27], v[0:3]
  ds_read_b128 a[152:155], v219 offset:2048
  v_mfma_f32_16x16x32_bf16 v[28:31], a[168:171], a[96:99], v[28:31]
  buffer_load_dwordx4 a[136:139], v254, s[4:7], s32 offen offset:0 sc1
  v_mfma_f32_16x16x32_bf16 v[4:7], a[172:175], a[24:27], v[4:7]
  ds_read_b128 a[156:159], v219 offset:3072
  v_mfma_f32_16x16x32_bf16 v[32:35], a[172:175], a[96:99], v[32:35]
  s_waitcnt lgkmcnt(6)
  v_mfma_f32_16x16x32_bf16 v[8:11], a[176:179], a[24:27], v[8:11]
  ds_read_b128 a[160:163], v219 offset:4096
  v_mfma_f32_16x16x32_bf16 v[36:39], a[176:179], a[96:99], v[36:39]
  buffer_load_dwordx4 a[68:71], v253, s[4:7], s32 offen offset:1024 sc1
  v_mfma_f32_16x16x32_bf16 v[12:15], a[180:183], a[24:27], v[12:15]
  ds_read_b128 a[164:167], v219 offset:5120
  v_mfma_f32_16x16x32_bf16 v[40:43], a[180:183], a[96:99], v[40:43]
  s_waitcnt lgkmcnt(6)
  v_mfma_f32_16x16x32_bf16 v[16:19], a[184:187], a[24:27], v[16:19]
  ds_read_b128 a[168:171], v219 offset:6144
  v_mfma_f32_16x16x32_bf16 v[44:47], a[184:187], a[96:99], v[44:47]
  buffer_load_dwordx4 a[140:143], v254, s[4:7], s32 offen offset:1024 sc1
  v_mfma_f32_16x16x32_bf16 v[20:23], a[188:191], a[24:27], v[20:23]
  ds_read_b128 a[172:175], v219 offset:7168
  v_mfma_f32_16x16x32_bf16 v[48:51], a[188:191], a[96:99], v[48:51]
  s_waitcnt lgkmcnt(6)
  v_mfma_f32_16x16x32_bf16 v[24:27], a[144:147], a[24:27], v[24:27]
  ds_read_b128 a[176:179], v219 offset:8192
  v_mfma_f32_16x16x32_bf16 v[52:55], a[144:147], a[96:99], v[52:55]
  s_mov_b32 m0, s29
  s_waitcnt vmcnt(20)
  v_mfma_f32_16x16x32_bf16 v[0:3], a[148:151], a[28:31], v[0:3]
  ds_read_b128 a[180:183], v219 offset:9216
  v_mfma_f32_16x16x32_bf16 v[28:31], a[148:151], a[100:103], v[28:31]
  s_waitcnt lgkmcnt(6)
  v_mfma_f32_16x16x32_bf16 v[4:7], a[152:155], a[28:31], v[4:7]
  ds_read_b128 a[184:187], v219 offset:10240
  v_mfma_f32_16x16x32_bf16 v[32:35], a[152:155], a[100:103], v[32:35]
  buffer_load_dwordx4 v253, s[4:7], s28 offen offset:0 sc1 lds
  v_mfma_f32_16x16x32_bf16 v[8:11], a[156:159], a[28:31], v[8:11]
  ds_read_b128 a[188:191], v219 offset:11264
  v_mfma_f32_16x16x32_bf16 v[36:39], a[156:159], a[100:103], v[36:39]
  s_waitcnt lgkmcnt(6)
  v_mfma_f32_16x16x32_bf16 v[12:15], a[160:163], a[28:31], v[12:15]
  ds_read_b128 a[144:147], v219 offset:12288
  v_mfma_f32_16x16x32_bf16 v[40:43], a[160:163], a[100:103], v[40:43]
  buffer_load_dwordx4 v253, s[4:7], s28 offen offset:1024 sc1 lds
  v_mfma_f32_16x16x32_bf16 v[16:19], a[164:167], a[28:31], v[16:19]
  ds_read_b128 a[148:151], v219 offset:13312
  v_mfma_f32_16x16x32_bf16 v[44:47], a[164:167], a[100:103], v[44:47]
  s_waitcnt lgkmcnt(6)
  v_mfma_f32_16x16x32_bf16 v[20:23], a[168:171], a[28:31], v[20:23]
  ds_read_b128 a[152:155], v219 offset:14336
  v_mfma_f32_16x16x32_bf16 v[48:51], a[168:171], a[100:103], v[48:51]
  buffer_load_dwordx4 v253, s[4:7], s28 offen offset:2048 sc1 lds
  v_mfma_f32_16x16x32_bf16 v[24:27], a[172:175], a[28:31], v[24:27]
  ds_read_b128 a[156:159], v219 offset:15360
  v_mfma_f32_16x16x32_bf16 v[52:55], a[172:175], a[100:103], v[52:55]
  s_waitcnt vmcnt(21)
  s_waitcnt lgkmcnt(6)
  v_mfma_f32_16x16x32_bf16 v[0:3], a[176:179], a[32:35], v[0:3]
  ds_read_b128 a[160:163], v219 offset:16384
  v_mfma_f32_16x16x32_bf16 v[28:31], a[176:179], a[104:107], v[28:31]
  buffer_load_dwordx4 v253, s[4:7], s28 offen offset:3072 sc1 lds
  v_mfma_f32_16x16x32_bf16 v[4:7], a[180:183], a[32:35], v[4:7]
  ds_read_b128 a[164:167], v219 offset:17408
  v_mfma_f32_16x16x32_bf16 v[32:35], a[180:183], a[104:107], v[32:35]
  s_waitcnt lgkmcnt(6)
  v_mfma_f32_16x16x32_bf16 v[8:11], a[184:187], a[32:35], v[8:11]
  ds_read_b128 a[168:171], v219 offset:18432
  v_mfma_f32_16x16x32_bf16 v[36:39], a[184:187], a[104:107], v[36:39]
  s_add_u32 m0, m0, 4096
  s_add_u32 s28, s28, 4096
  v_mfma_f32_16x16x32_bf16 v[12:15], a[188:191], a[32:35], v[12:15]
  ds_read_b128 a[172:175], v219 offset:19456
  v_mfma_f32_16x16x32_bf16 v[40:43], a[188:191], a[104:107], v[40:43]
  s_waitcnt lgkmcnt(6)
  v_mfma_f32_16x16x32_bf16 v[16:19], a[144:147], a[32:35], v[16:19]
  ds_read_b128 a[176:179], v219 offset:20480
  v_mfma_f32_16x16x32_bf16 v[44:47], a[144:147], a[104:107], v[44:47]
  buffer_load_dwordx4 v253, s[4:7], s28 offen sc1 lds
  v_mfma_f32_16x16x32_bf16 v[20:23], a[148:151], a[32:35], v[20:23]
  ds_read_b128 a[180:183], v219 offset:21504
  v_mfma_f32_16x16x32_bf16 v[48:51], a[148:151], a[104:107], v[48:51]
  s_waitcnt lgkmcnt(6)
  v_mfma_f32_16x16x32_bf16 v[24:27], a[152:155], a[32:35], v[24:27]
  ds_read_b128 a[184:187], v219 offset:22528
  v_mfma_f32_16x16x32_bf16 v[52:55], a[152:155], a[104:107], v[52:55]
  buffer_load_dwordx4 v[196:199], v233, s[4:7], s33 offen offset:0 sc1
  s_waitcnt vmcnt(22)
  v_mfma_f32_16x16x32_bf16 v[0:3], a[156:159], a[36:39], v[0:3]
  ds_read_b128 a[188:191], v219 offset:23552
  v_mfma_f32_16x16x32_bf16 v[28:31], a[156:159], a[108:111], v[28:31]
  s_waitcnt lgkmcnt(6)
  v_mfma_f32_16x16x32_bf16 v[4:7], a[160:163], a[36:39], v[4:7]
  ds_read_b128 a[144:147], v219 offset:24576
  v_mfma_f32_16x16x32_bf16 v[32:35], a[160:163], a[108:111], v[32:35]
  buffer_load_dwordx4 v[200:203], v233, s[4:7], s33 offen offset:16 sc1
  v_mfma_f32_16x16x32_bf16 v[8:11], a[164:167], a[36:39], v[8:11]
  ds_read_b128 a[148:151], v219 offset:25600
  v_mfma_f32_16x16x32_bf16 v[36:39], a[164:167], a[108:111], v[36:39]
  s_waitcnt lgkmcnt(6)
  v_mfma_f32_16x16x32_bf16 v[12:15], a[168:171], a[36:39], v[12:15]
  ds_read_b128 a[152:155], v219 offset:26624
  v_mfma_f32_16x16x32_bf16 v[40:43], a[168:171], a[108:111], v[40:43]
  buffer_load_dwordx4 v[204:207], v233, s[4:7], s33 offen offset:32 sc1
  v_mfma_f32_16x16x32_bf16 v[16:19], a[172:175], a[36:39], v[16:19]
  ds_read_b128 a[156:159], v219 offset:27648
  v_mfma_f32_16x16x32_bf16 v[44:47], a[172:175], a[108:111], v[44:47]
  s_waitcnt lgkmcnt(6)
  v_mfma_f32_16x16x32_bf16 v[20:23], a[176:179], a[36:39], v[20:23]
  ds_read_b128 a[160:163], v219 offset:28672
  v_mfma_f32_16x16x32_bf16 v[48:51], a[176:179], a[108:111], v[48:51]
  buffer_load_dwordx4 v[208:211], v233, s[4:7], s33 offen offset:48 sc1
  v_mfma_f32_16x16x32_bf16 v[24:27], a[180:183], a[36:39], v[24:27]
  ds_read_b128 a[164:167], v219 offset:29696
  v_mfma_f32_16x16x32_bf16 v[52:55], a[180:183], a[108:111], v[52:55]
  s_waitcnt vmcnt(23)
  s_waitcnt lgkmcnt(6)
  v_mfma_f32_16x16x32_bf16 v[0:3], a[184:187], a[40:43], v[0:3]
  ds_read_b128 a[168:171], v219 offset:30720
  v_mfma_f32_16x16x32_bf16 v[28:31], a[184:187], a[112:115], v[28:31]
  buffer_load_dwordx2 v[212:213], v233, s[4:7], s33 offen offset:64 sc1
  v_mfma_f32_16x16x32_bf16 v[4:7], a[188:191], a[40:43], v[4:7]
  ds_read_b128 a[172:175], v219 offset:31744
  v_mfma_f32_16x16x32_bf16 v[32:35], a[188:191], a[112:115], v[32:35]
  s_waitcnt lgkmcnt(6)
  v_mfma_f32_16x16x32_bf16 v[8:11], a[144:147], a[40:43], v[8:11]
  ds_read_b128 a[176:179], v219 offset:32768
  v_mfma_f32_16x16x32_bf16 v[36:39], a[144:147], a[112:115], v[36:39]
  buffer_load_dword v235, v234, s[8:11], s35 offen
  v_mfma_f32_16x16x32_bf16 v[12:15], a[148:151], a[40:43], v[12:15]
  ds_read_b128 a[180:183], v219 offset:33792
  v_mfma_f32_16x16x32_bf16 v[40:43], a[148:151], a[112:115], v[40:43]
  s_waitcnt lgkmcnt(6)
  v_mfma_f32_16x16x32_bf16 v[16:19], a[152:155], a[40:43], v[16:19]
  ds_read_b128 a[184:187], v219 offset:34816
  v_mfma_f32_16x16x32_bf16 v[44:47], a[152:155], a[112:115], v[44:47]
  buffer_load_dword v235, v234, s[12:15], s35 offen
  v_mfma_f32_16x16x32_bf16 v[20:23], a[156:159], a[40:43], v[20:23]
  ds_read_b128 a[188:191], v219 offset:35840
  v_mfma_f32_16x16x32_bf16 v[48:51], a[156:159], a[112:115], v[48:51]
  s_waitcnt lgkmcnt(6)
  v_mfma_f32_16x16x32_bf16 v[24:27], a[160:163], a[40:43], v[24:27]
  ds_read_b128 a[144:147], v219 offset:36864
  v_mfma_f32_16x16x32_bf16 v[52:55], a[160:163], a[112:115], v[52:55]
  s_waitcnt vmcnt(24)
  v_mfma_f32_16x16x32_bf16 v[0:3], a[164:167], a[44:47], v[0:3]
  ds_read_b128 a[148:151], v219 offset:37888
  v_mfma_f32_16x16x32_bf16 v[28:31], a[164:167], a[116:119], v[28:31]
  s_waitcnt lgkmcnt(6)
  v_mfma_f32_16x16x32_bf16 v[4:7], a[168:171], a[44:47], v[4:7]
  ds_read_b128 a[152:155], v219 offset:38912
  v_mfma_f32_16x16x32_bf16 v[32:35], a[168:171], a[116:119], v[32:35]
  v_mfma_f32_16x16x32_bf16 v[8:11], a[172:175], a[44:47], v[8:11]
  ds_read_b128 a[156:159], v219 offset:39936
  v_mfma_f32_16x16x32_bf16 v[36:39], a[172:175], a[116:119], v[36:39]
  s_waitcnt lgkmcnt(6)
  v_mfma_f32_16x16x32_bf16 v[12:15], a[176:179], a[44:47], v[12:15]
  ds_read_b128 a[160:163], v219 offset:40960
  v_mfma_f32_16x16x32_bf16 v[40:43], a[176:179], a[116:119], v[40:43]
  v_mfma_f32_16x16x32_bf16 v[16:19], a[180:183], a[44:47], v[16:19]
  ds_read_b128 a[164:167], v219 offset:41984
  v_mfma_f32_16x16x32_bf16 v[44:47], a[180:183], a[116:119], v[44:47]
  s_waitcnt lgkmcnt(6)
  v_mfma_f32_16x16x32_bf16 v[20:23], a[184:187], a[44:47], v[20:23]
  ds_read_b128 a[168:171], v219 offset:43008
  v_mfma_f32_16x16x32_bf16 v[48:51], a[184:187], a[116:119], v[48:51]
  v_mfma_f32_16x16x32_bf16 v[24:27], a[188:191], a[44:47], v[24:27]
  ds_read_b128 a[172:175], v219 offset:44032
  v_mfma_f32_16x16x32_bf16 v[52:55], a[188:191], a[116:119], v[52:55]
  s_waitcnt vmcnt(22)
  s_waitcnt lgkmcnt(6)
  v_mfma_f32_16x16x32_bf16 v[0:3], a[144:147], a[48:51], v[0:3]
  ds_read_b128 a[176:179], v219 offset:45056
  v_mfma_f32_16x16x32_bf16 v[28:31], a[144:147], a[120:123], v[28:31]
  v_mfma_f32_16x16x32_bf16 v[4:7], a[148:151], a[48:51], v[4:7]
  ds_read_b128 a[180:183], v219 offset:46080
  v_mfma_f32_16x16x32_bf16 v[32:35], a[148:151], a[120:123], v[32:35]
  s_waitcnt lgkmcnt(6)
  v_mfma_f32_16x16x32_bf16 v[8:11], a[152:155], a[48:51], v[8:11]
  ds_read_b128 a[184:187], v219 offset:47104
  v_mfma_f32_16x16x32_bf16 v[36:39], a[152:155], a[120:123], v[36:39]
  v_mfma_f32_16x16x32_bf16 v[12:15], a[156:159], a[48:51], v[12:15]
  ds_read_b128 a[188:191], v219 offset:48128
  v_mfma_f32_16x16x32_bf16 v[40:43], a[156:159], a[120:123], v[40:43]
  s_waitcnt lgkmcnt(6)
  v_mfma_f32_16x16x32_bf16 v[16:19], a[160:163], a[48:51], v[16:19]
  ds_read_b128 a[144:147], v220 offset:0
  v_mfma_f32_16x16x32_bf16 v[44:47], a[160:163], a[120:123], v[44:47]
  v_mfma_f32_16x16x32_bf16 v[20:23], a[164:167], a[48:51], v[20:23]
  ds_read_b128 a[148:151], v220 offset:1024
  v_mfma_f32_16x16x32_bf16 v[48:51], a[164:167], a[120:123], v[48:51]
  s_waitcnt lgkmcnt(6)
  v_mfma_f32_16x16x32_bf16 v[24:27], a[168:171], a[48:51], v[24:27]
  ds_read_b128 a[152:155], v220 offset:2048
  v_mfma_f32_16x16x32_bf16 v[52:55], a[168:171], a[120:123], v[52:55]
  s_waitcnt vmcnt(20)
  v_mfma_f32_16x16x32_bf16 v[0:3], a[172:175], a[52:55], v[0:3]
  ds_read_b128 a[156:159], v220 offset:3072
  v_mfma_f32_16x16x32_bf16 v[28:31], a[172:175], a[124:127], v[28:31]
  s_waitcnt lgkmcnt(6)
  v_mfma_f32_16x16x32_bf16 v[4:7], a[176:179], a[52:55], v[4:7]
  ds_read_b128 a[160:163], v220 offset:4096
  v_mfma_f32_16x16x32_bf16 v[32:35], a[176:179], a[124:127], v[32:35]
  v_mfma_f32_16x16x32_bf16 v[8:11], a[180:183], a[52:55], v[8:11]
  ds_read_b128 a[164:167], v220 offset:5120
  v_mfma_f32_16x16x32_bf16 v[36:39], a[180:183], a[124:127], v[36:39]
  s_waitcnt lgkmcnt(6)
  v_mfma_f32_16x16x32_bf16 v[12:15], a[184:187], a[52:55], v[12:15]
  ds_read_b128 a[168:171], v220 offset:6144
  v_mfma_f32_16x16x32_bf16 v[40:43], a[184:187], a[124:127], v[40:43]
  v_mfma_f32_16x16x32_bf16 v[16:19], a[188:191], a[52:55], v[16:19]
  ds_read_b128 a[172:175], v220 offset:7168
  v_mfma_f32_16x16x32_bf16 v[44:47], a[188:191], a[124:127], v[44:47]
  s_waitcnt lgkmcnt(6)
  v_mfma_f32_16x16x32_bf16 v[20:23], a[144:147], a[52:55], v[20:23]
  ds_read_b128 a[176:179], v220 offset:8192
  v_mfma_f32_16x16x32_bf16 v[48:51], a[144:147], a[124:127], v[48:51]
  v_mfma_f32_16x16x32_bf16 v[24:27], a[148:151], a[52:55], v[24:27]
  ds_read_b128 a[180:183], v220 offset:9216
  v_mfma_f32_16x16x32_bf16 v[52:55], a[148:151], a[124:127], v[52:55]
  s_waitcnt vmcnt(18)
  s_waitcnt lgkmcnt(6)
  v_mfma_f32_16x16x32_bf16 v[0:3], a[152:155], a[56:59], v[0:3]
  ds_read_b128 a[184:187], v220 offset:10240
  v_mfma_f32_16x16x32_bf16 v[28:31], a[152:155], a[128:131], v[28:31]
  v_mfma_f32_16x16x32_bf16 v[4:7], a[156:159], a[56:59], v[4:7]
  ds_read_b128 a[188:191], v220 offset:11264
  v_mfma_f32_16x16x32_bf16 v[32:35], a[156:159], a[128:131], v[32:35]
  s_waitcnt lgkmcnt(6)
  v_mfma_f32_16x16x32_bf16 v[8:11], a[160:163], a[56:59], v[8:11]
  ds_read_b128 a[144:147], v220 offset:12288
  v_mfma_f32_16x16x32_bf16 v[36:39], a[160:163], a[128:131], v[36:39]
  v_mfma_f32_16x16x32_bf16 v[12:15], a[164:167], a[56:59], v[12:15]
  ds_read_b128 a[148:151], v220 offset:13312
  v_mfma_f32_16x16x32_bf16 v[40:43], a[164:167], a[128:131], v[40:43]
  s_waitcnt lgkmcnt(6)
  v_mfma_f32_16x16x32_bf16 v[16:19], a[168:171], a[56:59], v[16:19]
  ds_read_b128 a[152:155], v220 offset:14336
  v_mfma_f32_16x16x32_bf16 v[44:47], a[168:171], a[128:131], v[44:47]
  v_mfma_f32_16x16x32_bf16 v[20:23], a[172:175], a[56:59], v[20:23]
  ds_read_b128 a[156:159], v220 offset:15360
  v_mfma_f32_16x16x32_bf16 v[48:51], a[172:175], a[128:131], v[48:51]
  s_waitcnt lgkmcnt(6)
  v_mfma_f32_16x16x32_bf16 v[24:27], a[176:179], a[56:59], v[24:27]
  ds_read_b128 a[160:163], v220 offset:16384
  v_mfma_f32_16x16x32_bf16 v[52:55], a[176:179], a[128:131], v[52:55]
  s_waitcnt vmcnt(16)
  v_mfma_f32_16x16x32_bf16 v[0:3], a[180:183], a[60:63], v[0:3]
  ds_read_b128 a[164:167], v220 offset:17408
  v_mfma_f32_16x16x32_bf16 v[28:31], a[180:183], a[132:135], v[28:31]
  s_waitcnt lgkmcnt(6)
  v_mfma_f32_16x16x32_bf16 v[4:7], a[184:187], a[60:63], v[4:7]
  ds_read_b128 a[168:171], v220 offset:18432
  v_mfma_f32_16x16x32_bf16 v[32:35], a[184:187], a[132:135], v[32:35]
  v_mfma_f32_16x16x32_bf16 v[8:11], a[188:191], a[60:63], v[8:11]
  ds_read_b128 a[172:175], v220 offset:19456
  v_mfma_f32_16x16x32_bf16 v[36:39], a[188:191], a[132:135], v[36:39]
  s_waitcnt lgkmcnt(6)
  v_mfma_f32_16x16x32_bf16 v[12:15], a[144:147], a[60:63], v[12:15]
  ds_read_b128 a[176:179], v220 offset:20480
  v_mfma_f32_16x16x32_bf16 v[40:43], a[144:147], a[132:135], v[40:43]
  v_mfma_f32_16x16x32_bf16 v[16:19], a[148:151], a[60:63], v[16:19]
  ds_read_b128 a[180:183], v220 offset:21504
  v_mfma_f32_16x16x32_bf16 v[44:47], a[148:151], a[132:135], v[44:47]
  s_waitcnt lgkmcnt(6)
  v_mfma_f32_16x16x32_bf16 v[20:23], a[152:155], a[60:63], v[20:23]
  ds_read_b128 a[184:187], v220 offset:22528
  v_mfma_f32_16x16x32_bf16 v[48:51], a[152:155], a[132:135], v[48:51]
  v_mfma_f32_16x16x32_bf16 v[24:27], a[156:159], a[60:63], v[24:27]
  ds_read_b128 a[188:191], v220 offset:23552
  v_mfma_f32_16x16x32_bf16 v[52:55], a[156:159], a[132:135], v[52:55]
  s_waitcnt vmcnt(14)
  s_waitcnt lgkmcnt(6)
  v_mfma_f32_16x16x32_bf16 v[0:3], a[160:163], a[64:67], v[0:3]
  ds_read_b128 a[144:147], v220 offset:24576
  v_mfma_f32_16x16x32_bf16 v[28:31], a[160:163], a[136:139], v[28:31]
  v_mfma_f32_16x16x32_bf16 v[4:7], a[164:167], a[64:67], v[4:7]
  ds_read_b128 a[148:151], v220 offset:25600
  v_mfma_f32_16x16x32_bf16 v[32:35], a[164:167], a[136:139], v[32:35]
  s_waitcnt lgkmcnt(6)
  v_mfma_f32_16x16x32_bf16 v[8:11], a[168:171], a[64:67], v[8:11]
  ds_read_b128 a[152:155], v220 offset:26624
  v_mfma_f32_16x16x32_bf16 v[36:39], a[168:171], a[136:139], v[36:39]
  v_mfma_f32_16x16x32_bf16 v[12:15], a[172:175], a[64:67], v[12:15]
  ds_read_b128 a[156:159], v220 offset:27648
  v_mfma_f32_16x16x32_bf16 v[40:43], a[172:175], a[136:139], v[40:43]
  s_waitcnt lgkmcnt(6)
  v_mfma_f32_16x16x32_bf16 v[16:19], a[176:179], a[64:67], v[16:19]
  ds_read_b128 a[160:163], v220 offset:28672
  v_mfma_f32_16x16x32_bf16 v[44:47], a[176:179], a[136:139], v[44:47]
  v_mfma_f32_16x16x32_bf16 v[20:23], a[180:183], a[64:67], v[20:23]
  ds_read_b128 a[164:167], v220 offset:29696
  v_mfma_f32_16x16x32_bf16 v[48:51], a[180:183], a[136:139], v[48:51]
  s_waitcnt vmcnt(7)
  s_barrier
  s_waitcnt lgkmcnt(6)
  v_mfma_f32_16x16x32_bf16 v[24:27], a[184:187], a[64:67], v[24:27]
  ds_read_b128 a[168:171], v220 offset:30720
  v_mfma_f32_16x16x32_bf16 v[52:55], a[184:187], a[136:139], v[52:55]
  s_waitcnt vmcnt(12)
  v_mfma_f32_16x16x32_bf16 v[0:3], a[188:191], a[68:71], v[0:3]
  ds_read_b128 a[172:175], v218 offset:6144
  v_mfma_f32_16x16x32_bf16 v[28:31], a[188:191], a[140:143], v[28:31]
  s_waitcnt lgkmcnt(6)
  v_mfma_f32_16x16x32_bf16 v[4:7], a[144:147], a[68:71], v[4:7]
  ds_read_b128 a[176:179], v221 offset:0
  v_mfma_f32_16x16x32_bf16 v[32:35], a[144:147], a[140:143], v[32:35]
  v_mfma_f32_16x16x32_bf16 v[8:11], a[148:151], a[68:71], v[8:11]
  ds_read_b128 a[180:183], v220 offset:31744
  v_mfma_f32_16x16x32_bf16 v[36:39], a[148:151], a[140:143], v[36:39]
  s_waitcnt lgkmcnt(6)
  v_mfma_f32_16x16x32_bf16 v[12:15], a[152:155], a[68:71], v[12:15]
  ds_read_b128 a[184:187], v218 offset:13312
  v_mfma_f32_16x16x32_bf16 v[40:43], a[152:155], a[140:143], v[40:43]
  v_mfma_f32_16x16x32_bf16 v[16:19], a[156:159], a[68:71], v[16:19]
  ds_read_b128 a[188:191], v221 offset:7168
  v_mfma_f32_16x16x32_bf16 v[44:47], a[156:159], a[140:143], v[44:47]
  s_waitcnt lgkmcnt(6)
  v_mfma_f32_16x16x32_bf16 v[20:23], a[160:163], a[68:71], v[20:23]
  ds_read_b128 a[144:147], v220 offset:32768
  v_mfma_f32_16x16x32_bf16 v[48:51], a[160:163], a[140:143], v[48:51]
  v_mfma_f32_16x16x32_bf16 v[24:27], a[164:167], a[68:71], v[24:27]
  ds_read_b128 a[148:151], v218 offset:20480
  v_mfma_f32_16x16x32_bf16 v[52:55], a[164:167], a[140:143], v[52:55]
  s_waitcnt lgkmcnt(5)
  v_mfma_f32_16x16x32_bf16 v[60:63], a[172:175], a[168:171], 0
  ds_read_b128 a[152:155], v221 offset:14336
  ds_read_b128 a[156:159], v220 offset:33792
  v_mfma_f32_16x16x32_bf16 v[56:59], a[176:179], a[168:171], 0
  ds_read_b128 a[160:163], v218 offset:27648
  s_waitcnt lgkmcnt(5)
  v_mfma_f32_16x16x32_bf16 v[60:63], a[184:187], a[180:183], v[60:63]
  ds_read_b128 a[164:167], v221 offset:21504
  ds_read_b128 a[168:171], v220 offset:34816
  v_mfma_f32_16x16x32_bf16 v[56:59], a[188:191], a[180:183], v[56:59]
  ds_read_b128 a[172:175], v218 offset:34816
  s_waitcnt lgkmcnt(5)
  v_mfma_f32_16x16x32_bf16 v[60:63], a[148:151], a[144:147], v[60:63]
  ds_read_b128 a[176:179], v221 offset:28672
  ds_read_b128 a[180:183], v220 offset:35840
  v_mfma_f32_16x16x32_bf16 v[56:59], a[152:155], a[144:147], v[56:59]
  ds_read_b128 a[184:187], v218 offset:41984
  s_waitcnt lgkmcnt(5)
  v_mfma_f32_16x16x32_bf16 v[60:63], a[160:163], a[156:159], v[60:63]
  ds_read_b128 a[188:191], v221 offset:35840
  ds_read_b128 a[144:147], v220 offset:36864
  v_mfma_f32_16x16x32_bf16 v[56:59], a[164:167], a[156:159], v[56:59]
  ds_read_b128 a[148:151], v219 offset:0
  s_waitcnt lgkmcnt(5)
  v_mfma_f32_16x16x32_bf16 v[60:63], a[172:175], a[168:171], v[60:63]
  ds_read_b128 a[152:155], v221 offset:43008
  ds_read_b128 a[156:159], v220 offset:37888
  v_mfma_f32_16x16x32_bf16 v[56:59], a[176:179], a[168:171], v[56:59]
  ds_read_b128 a[160:163], v219 offset:7168
  s_waitcnt lgkmcnt(5)
  v_mfma_f32_16x16x32_bf16 v[60:63], a[184:187], a[180:183], v[60:63]
  ds_read_b128 a[164:167], v222 offset:1024
  ds_read_b128 a[168:171], v220 offset:38912
  v_mfma_f32_16x16x32_bf16 v[56:59], a[188:191], a[180:183], v[56:59]
  ds_read_b128 a[172:175], v219 offset:14336
  s_waitcnt lgkmcnt(5)
  v_mfma_f32_16x16x32_bf16 v[60:63], a[148:151], a[144:147], v[60:63]
  ds_read_b128 a[176:179], v222 offset:8192
  ds_read_b128 a[180:183], v220 offset:39936
  v_mfma_f32_16x16x32_bf16 v[56:59], a[152:155], a[144:147], v[56:59]
  ds_read_b128 a[184:187], v219 offset:21504
  s_waitcnt lgkmcnt(5)
  v_mfma_f32_16x16x32_bf16 v[60:63], a[160:163], a[156:159], v[60:63]
  ds_read_b128 a[188:191], v222 offset:15360
  ds_read_b128 a[144:147], v220 offset:40960
  v_mfma_f32_16x16x32_bf16 v[56:59], a[164:167], a[156:159], v[56:59]
  ds_read_b128 a[148:151], v219 offset:28672
  s_waitcnt lgkmcnt(5)
  v_mfma_f32_16x16x32_bf16 v[60:63], a[172:175], a[168:171], v[60:63]
  ds_read_b128 a[152:155], v222 offset:22528
  ds_read_b128 a[156:159], v220 offset:41984
  v_mfma_f32_16x16x32_bf16 v[56:59], a[176:179], a[168:171], v[56:59]
  ds_read_b128 a[160:163], v219 offset:35840
  s_waitcnt lgkmcnt(5)
  v_mfma_f32_16x16x32_bf16 v[60:63], a[184:187], a[180:183], v[60:63]
  ds_read_b128 a[164:167], v222 offset:29696
  ds_read_b128 a[168:171], v220 offset:43008
  v_mfma_f32_16x16x32_bf16 v[56:59], a[188:191], a[180:183], v[56:59]
  ds_read_b128 a[172:175], v219 offset:43008
  s_waitcnt lgkmcnt(5)
  v_mfma_f32_16x16x32_bf16 v[60:63], a[148:151], a[144:147], v[60:63]
  ds_read_b128 a[176:179], v222 offset:36864
  ds_read_b128 a[180:183], v220 offset:44032
  v_mfma_f32_16x16x32_bf16 v[56:59], a[152:155], a[144:147], v[56:59]
  ds_read_b128 a[184:187], v220 offset:1024
  s_waitcnt lgkmcnt(5)
  v_mfma_f32_16x16x32_bf16 v[60:63], a[160:163], a[156:159], v[60:63]
  ds_read_b128 a[188:191], v222 offset:44032
  ds_read_b128 a[144:147], v220 offset:45056
  v_mfma_f32_16x16x32_bf16 v[56:59], a[164:167], a[156:159], v[56:59]
  ds_read_b128 a[148:151], v220 offset:8192
  s_waitcnt lgkmcnt(5)
  v_mfma_f32_16x16x32_bf16 v[60:63], a[172:175], a[168:171], v[60:63]
  ds_read_b128 a[152:155], v223 offset:2048
  ds_read_b128 a[156:159], v220 offset:46080
  v_mfma_f32_16x16x32_bf16 v[56:59], a[176:179], a[168:171], v[56:59]
  ds_read_b128 a[160:163], v220 offset:15360
  s_waitcnt lgkmcnt(5)
  v_mfma_f32_16x16x32_bf16 v[60:63], a[184:187], a[180:183], v[60:63]
  ds_read_b128 a[164:167], v223 offset:9216
  ds_read_b128 a[168:171], v220 offset:47104
  v_mfma_f32_16x16x32_bf16 v[56:59], a[188:191], a[180:183], v[56:59]
  ds_read_b128 a[172:175], v220 offset:22528
  s_waitcnt lgkmcnt(5)
  v_mfma_f32_16x16x32_bf16 v[60:63], a[148:151], a[144:147], v[60:63]
  ds_read_b128 a[176:179], v223 offset:16384
  ds_read_b128 a[180:183], v220 offset:48128
  v_mfma_f32_16x16x32_bf16 v[56:59], a[152:155], a[144:147], v[56:59]
  ds_read_b128 a[184:187], v220 offset:29696
  s_waitcnt lgkmcnt(5)
  v_mfma_f32_16x16x32_bf16 v[60:63], a[160:163], a[156:159], v[60:63]
  ds_read_b128 a[188:191], v223 offset:23552
  v_mfma_f32_16x16x32_bf16 v[56:59], a[164:167], a[156:159], v[56:59]
  s_waitcnt lgkmcnt(3)
  v_mfma_f32_16x16x32_bf16 v[60:63], a[172:175], a[168:171], v[60:63]
  v_mfma_f32_16x16x32_bf16 v[56:59], a[176:179], a[168:171], v[56:59]
  s_waitcnt lgkmcnt(0)
  v_mfma_f32_16x16x32_bf16 v[60:63], a[184:187], a[180:183], v[60:63]
  v_mfma_f32_16x16x32_bf16 v[56:59], a[188:191], a[180:183], v[56:59]
  s_lshr_b32 s46, s21, 2
  s_sub_u32 s46, s21, s46
  s_cmp_ge_u32 s46, 6
  s_cselect_b32 s66, 6, 0
  s_cselect_b32 s67, 4, 0
  s_sub_u32 s66, s46, s66
  s_add_u32 s67, s67, s27
  s_add_u32 s67, s67, s20
  s_mul_i32 s46, s66, 110592
  s_mul_i32 s47, s20, 27648
  s_add_u32 s46, s46, s47
  s_add_u32 s46, s46, 0x1b01000
  s_and_b32 s75, s21, 3
  s_cmp_eq_u32 s75, 3
  s_cselect_b32 s46, 0x7f000000, s46
  s_mov_b32 m0, s47
  v_and_b32 v64, 15, v252
  v_lshrrev_b32 v65, 4, v252
  v_mul_u32_u24 v64, 336, v64
  v_add_u32 v64, 111616, v64
  v_lshl_add_u32 v66, v65, 3, v64
  v_lshl_add_u32 v67, v65, 4, v64
  s_mul_i32 s34, s20, 10752
  s_add_u32 s34, s34, 5376
  v_add_u32 v68, s34, v66
  v_add_u32 v69, s34, v67
  s_barrier
  ds_write_b128 v69, v[8:11] offset:128
  ds_write_b128 v69, v[12:15] offset:192
  ds_write_b128 v69, v[24:27] offset:256
  v_cvt_pk_bf16_f32 v0, v0, v1
  v_cvt_pk_bf16_f32 v1, v2, v3
  ds_write_b64 v68, v[0:1] offset:0
  v_cvt_pk_bf16_f32 v4, v4, v5
  v_cvt_pk_bf16_f32 v5, v6, v7
  ds_write_b64 v68, v[4:5] offset:32
  v_cvt_pk_bf16_f32 v16, v16, v17
  v_cvt_pk_bf16_f32 v17, v18, v19
  ds_write_b64 v68, v[16:17] offset:64
  v_cvt_pk_bf16_f32 v20, v20, v21
  v_cvt_pk_bf16_f32 v21, v22, v23
  ds_write_b64 v68, v[20:21] offset:96
  ds_write_b128 v69, v[36:39] offset:5504
  ds_write_b128 v69, v[40:43] offset:5568
  ds_write_b128 v69, v[52:55] offset:5632
  v_cvt_pk_bf16_f32 v28, v28, v29
  v_cvt_pk_bf16_f32 v29, v30, v31
  ds_write_b64 v68, v[28:29] offset:5376
  v_cvt_pk_bf16_f32 v32, v32, v33
  v_cvt_pk_bf16_f32 v33, v34, v35
  ds_write_b64 v68, v[32:33] offset:5408
  v_cvt_pk_bf16_f32 v44, v44, v45
  v_cvt_pk_bf16_f32 v45, v46, v47
  ds_write_b64 v68, v[44:45] offset:5440
  v_cvt_pk_bf16_f32 v48, v48, v49
  v_cvt_pk_bf16_f32 v49, v50, v51
  ds_write_b64 v68, v[48:49] offset:5472
  ds_write_b128 v67, v[60:63] offset:256
  s_cmp_ge_u32 s20, 2
  s_cbranch_scc1 m_A_17_hv
  s_lshl_b32 s35, s20, 5
  v_add_u32 v66, s35, v66
  v_cvt_pk_bf16_f32 v56, v56, v57
  v_cvt_pk_bf16_f32 v57, v58, v59
  ds_write_b64 v66, v[56:57]
  s_branch m_A_17_hd
m_A_17_hv:
  s_lshl_b32 s35, s20, 6
  v_add_u32 v67, s35, v67
  ds_write_b128 v67, v[56:59]
m_A_17_hd:
  v_and_b32 v64, 31, v252
  v_lshrrev_b32 v65, 5, v252
  v_mul_u32_u24 v66, 336, v64
  s_add_u32 s34, s34, 106912
  v_add_u32 v66, s34, v66
  buffer_load_dwordx4 v253, s[4:7], s46 offen offset:0 sc1 lds
  v_lshl_add_u32 v225, v65, 5, v66
  v_lshl_add_u32 v226, v65, 6, v66
  v_lshl_add_u32 v227, v65, 4, v66
  v_lshl_add_u32 v228, v65, 3, v66
  s_lshl_b32 s35, s30, 4
  buffer_load_dwordx4 v253, s[4:7], s46 offen offset:1024 sc1 lds
  v_add_u32 v229, s35, v64
  v_lshrrev_b32 v66, 4, v64
  v_mul_u32_u24 v66, 18432, v66
  v_and_b32 v67, 15, v64
  v_lshl_add_u32 v66, v67, 4, v66
  buffer_load_dwordx4 v253, s[4:7], s46 offen offset:2048 sc1 lds
  v_lshl_add_u32 v230, v65, 9, v66
  v_lshrrev_b32 v66, 4, v64
  v_lshlrev_b32 v66, 12, v66
  v_lshl_add_u32 v232, v67, 4, v66
  s_lshl_b32 s48, s21, 10
  buffer_load_dwordx4 v253, s[4:7], s46 offen offset:3072 sc1 lds
  s_add_u32 m0, m0, 4096
  s_add_u32 s46, s46, 4096
  s_add_u32 s48, s48, s31
  s_add_u32 s48, s48, 0x480000
  s_lshl_b32 s51, s21, 8
  s_lshl_b32 s49, s30, 12
  s_add_u32 s51, s51, s49
  buffer_load_dwordx4 v253, s[4:7], s46 offen offset:0 sc1 lds
  s_add_u32 s51, s51, s23
  s_add_u32 s51, s51, 0xb52000
  s_waitcnt lgkmcnt(0)
  s_barrier
  ds_read_b128 v[160:163], v225 offset:4768
  ds_read_b128 v[164:167], v225 offset:4784
  ds_read_b64 v[168:169], v228 offset:4992
  ds_read_b128 v[0:3], v225 offset:4704
  ds_read_b128 v[4:7], v225 offset:4720
  ds_read_b128 v[64:67], v227 offset:4960
  ds_read_b128 v[8:11], v225 offset:4032
  ds_read_b128 v[12:15], v225 offset:4048
  ds_read_b128 v[68:71], v227 offset:4288
  ds_read_b128 v[16:19], v225 offset:3360
  ds_read_b128 v[20:23], v225 offset:3376
  ds_read_b128 v[72:75], v227 offset:3616
  ds_read_b128 v[24:27], v225 offset:2688
  ds_read_b128 v[28:31], v225 offset:2704
  ds_read_b128 v[76:79], v227 offset:2944
  v_mov_b32 v179, 0xff7fffff
  s_waitcnt lgkmcnt(9)
  ds_read_b128 v[32:35], v225 offset:2016
  ds_read_b128 v[36:39], v225 offset:2032
  ds_read_b128 v[80:83], v227 offset:2272
  v_mul_f32 v170, v168, v64
  v_fmac_f32 v170, v169, v65
  v_dot2_f32_bf16 v170, v160, v0, v170
  buffer_load_dwordx4 v253, s[4:7], s46 offen offset:1024 sc1 lds
  v_dot2_f32_bf16 v170, v161, v1, v170
  v_dot2_f32_bf16 v170, v162, v2, v170
  v_dot2_f32_bf16 v170, v163, v3, v170
  v_dot2_f32_bf16 v170, v164, v4, v170
  v_dot2_f32_bf16 v170, v165, v5, v170
  buffer_load_dwordx4 v253, s[4:7], s46 offen offset:2048 sc1 lds
  v_dot2_f32_bf16 v170, v166, v6, v170
  v_dot2_f32_bf16 v170, v167, v7, v170
  s_waitcnt lgkmcnt(9)
  ds_read_b128 v[40:43], v225 offset:1344
  ds_read_b128 v[44:47], v225 offset:1360
  ds_read_b128 v[84:87], v227 offset:1600
  v_mul_f32 v171, v168, v68
  v_fmac_f32 v171, v169, v69
  v_dot2_f32_bf16 v171, v160, v8, v171
  buffer_load_dwordx4 v253, s[4:7], s46 offen offset:3072 sc1 lds
  s_add_u32 m0, m0, 4096
  s_add_u32 s46, s46, 4096
  v_dot2_f32_bf16 v171, v161, v9, v171
  v_dot2_f32_bf16 v171, v162, v10, v171
  v_dot2_f32_bf16 v171, v163, v11, v171
  v_dot2_f32_bf16 v171, v164, v12, v171
  v_dot2_f32_bf16 v171, v165, v13, v171
  buffer_load_dwordx4 v253, s[4:7], s46 offen offset:0 sc1 lds
  v_dot2_f32_bf16 v171, v166, v14, v171
  v_dot2_f32_bf16 v171, v167, v15, v171
  v_cmp_le_u32 vcc, 2, v229
  s_nop 1
  v_cndmask_b32 v171, v179, v171, vcc
  s_waitcnt lgkmcnt(9)
  ds_read_b128 v[48:51], v225 offset:672
  ds_read_b128 v[52:55], v225 offset:688
  ds_read_b128 v[88:91], v227 offset:928
  v_mul_f32 v172, v168, v72
  v_fmac_f32 v172, v169, v73
  v_dot2_f32_bf16 v172, v160, v16, v172
  buffer_load_dwordx4 v253, s[4:7], s46 offen offset:1024 sc1 lds
  v_dot2_f32_bf16 v172, v161, v17, v172
  v_dot2_f32_bf16 v172, v162, v18, v172
  v_dot2_f32_bf16 v172, v163, v19, v172
  v_dot2_f32_bf16 v172, v164, v20, v172
  v_dot2_f32_bf16 v172, v165, v21, v172
  buffer_load_dwordx4 v253, s[4:7], s46 offen offset:2048 sc1 lds
  v_dot2_f32_bf16 v172, v166, v22, v172
  v_dot2_f32_bf16 v172, v167, v23, v172
  v_cmp_le_u32 vcc, 4, v229
  s_nop 1
  v_cndmask_b32 v172, v179, v172, vcc
  s_waitcnt lgkmcnt(9)
  ds_read_b128 v[56:59], v225 offset:0
  ds_read_b128 v[60:63], v225 offset:16
  ds_read_b128 v[92:95], v227 offset:256
  v_mul_f32 v173, v168, v76
  v_fmac_f32 v173, v169, v77
  v_dot2_f32_bf16 v173, v160, v24, v173
  buffer_load_dwordx4 v253, s[4:7], s46 offen offset:3072 sc1 lds
  s_add_u32 m0, m0, 4096
  s_add_u32 s46, s46, 4096
  v_dot2_f32_bf16 v173, v161, v25, v173
  v_dot2_f32_bf16 v173, v162, v26, v173
  v_dot2_f32_bf16 v173, v163, v27, v173
  v_dot2_f32_bf16 v173, v164, v28, v173
  v_dot2_f32_bf16 v173, v165, v29, v173
  buffer_load_dwordx4 v253, s[4:7], s46 offen offset:0 sc1 lds
  v_dot2_f32_bf16 v173, v166, v30, v173
  v_dot2_f32_bf16 v173, v167, v31, v173
  v_cmp_le_u32 vcc, 6, v229
  s_nop 1
  v_cndmask_b32 v173, v179, v173, vcc
  s_waitcnt lgkmcnt(9)
  ds_read_b128 v[96:99], v226 offset:4832
  ds_read_b128 v[100:103], v226 offset:4848
  ds_read_b128 v[104:107], v226 offset:4864
  ds_read_b128 v[108:111], v226 offset:4880
  v_mul_f32 v174, v168, v80
  v_fmac_f32 v174, v169, v81
  v_dot2_f32_bf16 v174, v160, v32, v174
  buffer_load_dwordx4 v253, s[4:7], s46 offen offset:1024 sc1 lds
  v_dot2_f32_bf16 v174, v161, v33, v174
  v_dot2_f32_bf16 v174, v162, v34, v174
  v_dot2_f32_bf16 v174, v163, v35, v174
  v_dot2_f32_bf16 v174, v164, v36, v174
  v_dot2_f32_bf16 v174, v165, v37, v174
  buffer_load_dwordx4 v253, s[4:7], s46 offen offset:2048 sc1 lds
  v_dot2_f32_bf16 v174, v166, v38, v174
  v_dot2_f32_bf16 v174, v167, v39, v174
  v_cmp_le_u32 vcc, 8, v229
  s_nop 1
  v_cndmask_b32 v174, v179, v174, vcc
  s_waitcnt lgkmcnt(10)
  ds_read_b128 v[112:115], v226 offset:4160
  ds_read_b128 v[116:119], v226 offset:4176
  ds_read_b128 v[120:123], v226 offset:4192
  ds_read_b128 v[124:127], v226 offset:4208
  v_mul_f32 v175, v168, v84
  v_fmac_f32 v175, v169, v85
  v_dot2_f32_bf16 v175, v160, v40, v175
  buffer_load_dwordx4 v253, s[4:7], s46 offen offset:3072 sc1 lds
  s_add_u32 m0, m0, 4096
  s_add_u32 s46, s46, 4096
  v_dot2_f32_bf16 v175, v161, v41, v175
  v_dot2_f32_bf16 v175, v162, v42, v175
  v_dot2_f32_bf16 v175, v163, v43, v175
  v_dot2_f32_bf16 v175, v164, v44, v175
  v_dot2_f32_bf16 v175, v165, v45, v175
  buffer_load_dwordx4 v253, s[4:7], s46 offen offset:0 sc1 lds
  v_dot2_f32_bf16 v175, v166, v46, v175
  v_dot2_f32_bf16 v175, v167, v47, v175
  v_cmp_le_u32 vcc, 10, v229
  s_nop 1
  v_cndmask_b32 v175, v179, v175, vcc
  s_waitcnt lgkmcnt(11)
  ds_read_b128 v[128:131], v226 offset:3488
  ds_read_b128 v[132:135], v226 offset:3504
  ds_read_b128 v[136:139], v226 offset:3520
  ds_read_b128 v[140:143], v226 offset:3536
  v_mul_f32 v176, v168, v88
  v_fmac_f32 v176, v169, v89
  v_dot2_f32_bf16 v176, v160, v48, v176
  buffer_load_dwordx4 v253, s[4:7], s46 offen offset:1024 sc1 lds
  v_dot2_f32_bf16 v176, v161, v49, v176
  v_dot2_f32_bf16 v176, v162, v50, v176
  v_dot2_f32_bf16 v176, v163, v51, v176
  v_dot2_f32_bf16 v176, v164, v52, v176
  v_dot2_f32_bf16 v176, v165, v53, v176
  buffer_load_dwordx4 v253, s[4:7], s46 offen offset:2048 sc1 lds
  v_dot2_f32_bf16 v176, v166, v54, v176
  v_dot2_f32_bf16 v176, v167, v55, v176
  v_cmp_le_u32 vcc, 12, v229
  s_nop 1
  v_cndmask_b32 v176, v179, v176, vcc
  s_waitcnt lgkmcnt(12)
  ds_read_b128 v[144:147], v226 offset:2816
  ds_read_b128 v[148:151], v226 offset:2832
  ds_read_b128 v[152:155], v226 offset:2848
  ds_read_b128 v[156:159], v226 offset:2864
  v_mul_f32 v177, v168, v92
  v_fmac_f32 v177, v169, v93
  v_dot2_f32_bf16 v177, v160, v56, v177
  buffer_load_dwordx4 v253, s[4:7], s46 offen offset:3072 sc1 lds
  s_add_u32 m0, m0, 4096
  s_add_u32 s46, s46, 4096
  v_dot2_f32_bf16 v177, v161, v57, v177
  v_dot2_f32_bf16 v177, v162, v58, v177
  v_dot2_f32_bf16 v177, v163, v59, v177
  v_dot2_f32_bf16 v177, v164, v60, v177
  v_dot2_f32_bf16 v177, v165, v61, v177
  buffer_load_dwordx4 v253, s[4:7], s46 offen offset:0 sc1 lds
  v_dot2_f32_bf16 v177, v166, v62, v177
  v_dot2_f32_bf16 v177, v167, v63, v177
  v_cmp_le_u32 vcc, 14, v229
  s_nop 1
  v_cndmask_b32 v177, v179, v177, vcc
  ds_read_b128 v[0:3], v226 offset:2144
  ds_read_b128 v[4:7], v226 offset:2160
  ds_read_b128 v[8:11], v226 offset:2176
  ds_read_b128 v[12:15], v226 offset:2192
  ds_read_b128 v[16:19], v226 offset:1472
  ds_read_b128 v[20:23], v226 offset:1488
  ds_read_b128 v[24:27], v226 offset:1504
  ds_read_b128 v[28:31], v226 offset:1520
  ds_read_b128 v[32:35], v226 offset:800
  ds_read_b128 v[36:39], v226 offset:816
  ds_read_b128 v[40:43], v226 offset:832
  ds_read_b128 v[44:47], v226 offset:848
  ds_read_b128 v[48:51], v226 offset:128
  ds_read_b128 v[52:55], v226 offset:144
  ds_read_b128 v[56:59], v226 offset:160
  ds_read_b128 v[60:63], v226 offset:176
  v_max3_f32 v178, v170, v171, v172
  v_max3_f32 v178, v178, v173, v174
  v_max3_f32 v178, v178, v175, v176
  buffer_load_dwordx4 v253, s[4:7], s46 offen offset:1024 sc1 lds
  v_max_f32 v178, v178, v177
  s_mov_b32 s52, 0x3eae1a93
  v_sub_f32 v170, v170, v178
  v_sub_f32 v171, v171, v178
  v_sub_f32 v172, v172, v178
  v_sub_f32 v173, v173, v178
  buffer_load_dwordx4 v253, s[4:7], s46 offen offset:2048 sc1 lds
  v_sub_f32 v174, v174, v178
  v_sub_f32 v175, v175, v178
  v_sub_f32 v176, v176, v178
  v_sub_f32 v177, v177, v178
  v_mul_f32 v170, s52, v170
  buffer_load_dwordx4 v253, s[4:7], s46 offen offset:3072 sc1 lds
  s_add_u32 m0, m0, 4096
  s_add_u32 s46, s46, 4096
  v_mul_f32 v171, s52, v171
  v_mul_f32 v172, s52, v172
  v_mul_f32 v173, s52, v173
  v_mul_f32 v174, s52, v174
  v_mul_f32 v175, s52, v175
  buffer_load_dwordx4 v253, s[4:7], s46 offen offset:0 sc1 lds
  v_mul_f32 v176, s52, v176
  v_mul_f32 v177, s52, v177
  v_exp_f32 v170, v170
  v_exp_f32 v171, v171
  v_exp_f32 v172, v172
  buffer_load_dwordx4 v253, s[4:7], s46 offen offset:1024 sc1 lds
  v_exp_f32 v173, v173
  v_exp_f32 v174, v174
  v_exp_f32 v175, v175
  v_exp_f32 v176, v176
  v_exp_f32 v177, v177
  buffer_load_dwordx4 v253, s[4:7], s46 offen offset:2048 sc1 lds
  v_add_f32 v160, v170, v171
  v_add_f32 v160, v160, v172
  v_add_f32 v160, v160, v173
  v_add_f32 v160, v160, v174
  v_add_f32 v160, v160, v175
  v_add_f32 v160, v160, v176
  v_add_f32 v160, v160, v177
  v_rcp_f32 v160, v160
  s_nop 0
  v_mul_f32 v170, v170, v160
  v_mul_f32 v171, v171, v160
  v_mul_f32 v172, v172, v160
  v_mul_f32 v173, v173, v160
  v_mul_f32 v174, v174, v160
  v_mul_f32 v175, v175, v160
  v_mul_f32 v176, v176, v160
  v_mul_f32 v177, v177, v160
  s_waitcnt lgkmcnt(15)
  v_pk_mul_f32 v[178:179], v[96:97], v[170:171] op_sel:[0,0] op_sel_hi:[1,0]
  v_pk_mul_f32 v[180:181], v[98:99], v[170:171] op_sel:[0,0] op_sel_hi:[1,0]
  v_pk_mul_f32 v[182:183], v[100:101], v[170:171] op_sel:[0,0] op_sel_hi:[1,0]
  v_pk_mul_f32 v[184:185], v[102:103], v[170:171] op_sel:[0,0] op_sel_hi:[1,0]
  v_pk_mul_f32 v[186:187], v[104:105], v[170:171] op_sel:[0,0] op_sel_hi:[1,0]
  v_pk_mul_f32 v[188:189], v[106:107], v[170:171] op_sel:[0,0] op_sel_hi:[1,0]
  v_pk_mul_f32 v[190:191], v[108:109], v[170:171] op_sel:[0,0] op_sel_hi:[1,0]
  v_pk_mul_f32 v[192:193], v[110:111], v[170:171] op_sel:[0,0] op_sel_hi:[1,0]
  v_pk_mul_f32 v[194:195], v[66:67], v[170:171] op_sel:[0,0] op_sel_hi:[1,0]
  s_waitcnt lgkmcnt(15)
  v_pk_fma_f32 v[178:179], v[112:113], v[170:171], v[178:179] op_sel:[0,1,0] op_sel_hi:[1,1,1]
  v_pk_fma_f32 v[180:181], v[114:115], v[170:171], v[180:181] op_sel:[0,1,0] op_sel_hi:[1,1,1]
  v_pk_fma_f32 v[182:183], v[116:117], v[170:171], v[182:183] op_sel:[0,1,0] op_sel_hi:[1,1,1]
  v_pk_fma_f32 v[184:185], v[118:119], v[170:171], v[184:185] op_sel:[0,1,0] op_sel_hi:[1,1,1]
  v_pk_fma_f32 v[186:187], v[120:121], v[170:171], v[186:187] op_sel:[0,1,0] op_sel_hi:[1,1,1]
  v_pk_fma_f32 v[188:189], v[122:123], v[170:171], v[188:189] op_sel:[0,1,0] op_sel_hi:[1,1,1]
  v_pk_fma_f32 v[190:191], v[124:125], v[170:171], v[190:191] op_sel:[0,1,0] op_sel_hi:[1,1,1]
  v_pk_fma_f32 v[192:193], v[126:127], v[170:171], v[192:193] op_sel:[0,1,0] op_sel_hi:[1,1,1]
  v_pk_fma_f32 v[194:195], v[70:71], v[170:171], v[194:195] op_sel:[0,1,0] op_sel_hi:[1,1,1]
  s_waitcnt lgkmcnt(15)
  v_pk_fma_f32 v[178:179], v[128:129], v[172:173], v[178:179] op_sel:[0,0,0] op_sel_hi:[1,0,1]
  v_pk_fma_f32 v[180:181], v[130:131], v[172:173], v[180:181] op_sel:[0,0,0] op_sel_hi:[1,0,1]
  v_pk_fma_f32 v[182:183], v[132:133], v[172:173], v[182:183] op_sel:[0,0,0] op_sel_hi:[1,0,1]
  v_pk_fma_f32 v[184:185], v[134:135], v[172:173], v[184:185] op_sel:[0,0,0] op_sel_hi:[1,0,1]
  v_pk_fma_f32 v[186:187], v[136:137], v[172:173], v[186:187] op_sel:[0,0,0] op_sel_hi:[1,0,1]
  v_pk_fma_f32 v[188:189], v[138:139], v[172:173], v[188:189] op_sel:[0,0,0] op_sel_hi:[1,0,1]
  v_pk_fma_f32 v[190:191], v[140:141], v[172:173], v[190:191] op_sel:[0,0,0] op_sel_hi:[1,0,1]
  v_pk_fma_f32 v[192:193], v[142:143], v[172:173], v[192:193] op_sel:[0,0,0] op_sel_hi:[1,0,1]
  v_pk_fma_f32 v[194:195], v[74:75], v[172:173], v[194:195] op_sel:[0,0,0] op_sel_hi:[1,0,1]
  s_waitcnt lgkmcnt(15)
  v_pk_fma_f32 v[178:179], v[144:145], v[172:173], v[178:179] op_sel:[0,1,0] op_sel_hi:[1,1,1]
  v_pk_fma_f32 v[180:181], v[146:147], v[172:173], v[180:181] op_sel:[0,1,0] op_sel_hi:[1,1,1]
  v_pk_fma_f32 v[182:183], v[148:149], v[172:173], v[182:183] op_sel:[0,1,0] op_sel_hi:[1,1,1]
  v_pk_fma_f32 v[184:185], v[150:151], v[172:173], v[184:185] op_sel:[0,1,0] op_sel_hi:[1,1,1]
  v_pk_fma_f32 v[186:187], v[152:153], v[172:173], v[186:187] op_sel:[0,1,0] op_sel_hi:[1,1,1]
  v_pk_fma_f32 v[188:189], v[154:155], v[172:173], v[188:189] op_sel:[0,1,0] op_sel_hi:[1,1,1]
  v_pk_fma_f32 v[190:191], v[156:157], v[172:173], v[190:191] op_sel:[0,1,0] op_sel_hi:[1,1,1]
  v_pk_fma_f32 v[192:193], v[158:159], v[172:173], v[192:193] op_sel:[0,1,0] op_sel_hi:[1,1,1]
  v_pk_fma_f32 v[194:195], v[78:79], v[172:173], v[194:195] op_sel:[0,1,0] op_sel_hi:[1,1,1]
  s_waitcnt lgkmcnt(12)
  v_pk_fma_f32 v[178:179], v[0:1], v[174:175], v[178:179] op_sel:[0,0,0] op_sel_hi:[1,0,1]
  v_pk_fma_f32 v[180:181], v[2:3], v[174:175], v[180:181] op_sel:[0,0,0] op_sel_hi:[1,0,1]
  v_pk_fma_f32 v[182:183], v[4:5], v[174:175], v[182:183] op_sel:[0,0,0] op_sel_hi:[1,0,1]
  v_pk_fma_f32 v[184:185], v[6:7], v[174:175], v[184:185] op_sel:[0,0,0] op_sel_hi:[1,0,1]
  v_pk_fma_f32 v[186:187], v[8:9], v[174:175], v[186:187] op_sel:[0,0,0] op_sel_hi:[1,0,1]
  v_pk_fma_f32 v[188:189], v[10:11], v[174:175], v[188:189] op_sel:[0,0,0] op_sel_hi:[1,0,1]
  v_pk_fma_f32 v[190:191], v[12:13], v[174:175], v[190:191] op_sel:[0,0,0] op_sel_hi:[1,0,1]
  v_pk_fma_f32 v[192:193], v[14:15], v[174:175], v[192:193] op_sel:[0,0,0] op_sel_hi:[1,0,1]
  v_pk_fma_f32 v[194:195], v[82:83], v[174:175], v[194:195] op_sel:[0,0,0] op_sel_hi:[1,0,1]
  s_waitcnt lgkmcnt(8)
  v_pk_fma_f32 v[178:179], v[16:17], v[174:175], v[178:179] op_sel:[0,1,0] op_sel_hi:[1,1,1]
  v_pk_fma_f32 v[180:181], v[18:19], v[174:175], v[180:181] op_sel:[0,1,0] op_sel_hi:[1,1,1]
  v_pk_fma_f32 v[182:183], v[20:21], v[174:175], v[182:183] op_sel:[0,1,0] op_sel_hi:[1,1,1]
  v_pk_fma_f32 v[184:185], v[22:23], v[174:175], v[184:185] op_sel:[0,1,0] op_sel_hi:[1,1,1]
  v_pk_fma_f32 v[186:187], v[24:25], v[174:175], v[186:187] op_sel:[0,1,0] op_sel_hi:[1,1,1]
  v_pk_fma_f32 v[188:189], v[26:27], v[174:175], v[188:189] op_sel:[0,1,0] op_sel_hi:[1,1,1]
  v_pk_fma_f32 v[190:191], v[28:29], v[174:175], v[190:191] op_sel:[0,1,0] op_sel_hi:[1,1,1]
  v_pk_fma_f32 v[192:193], v[30:31], v[174:175], v[192:193] op_sel:[0,1,0] op_sel_hi:[1,1,1]
  v_pk_fma_f32 v[194:195], v[86:87], v[174:175], v[194:195] op_sel:[0,1,0] op_sel_hi:[1,1,1]
  s_waitcnt lgkmcnt(4)
  v_pk_fma_f32 v[178:179], v[32:33], v[176:177], v[178:179] op_sel:[0,0,0] op_sel_hi:[1,0,1]
  v_pk_fma_f32 v[180:181], v[34:35], v[176:177], v[180:181] op_sel:[0,0,0] op_sel_hi:[1,0,1]
  v_pk_fma_f32 v[182:183], v[36:37], v[176:177], v[182:183] op_sel:[0,0,0] op_sel_hi:[1,0,1]
  v_pk_fma_f32 v[184:185], v[38:39], v[176:177], v[184:185] op_sel:[0,0,0] op_sel_hi:[1,0,1]
  v_pk_fma_f32 v[186:187], v[40:41], v[176:177], v[186:187] op_sel:[0,0,0] op_sel_hi:[1,0,1]
  v_pk_fma_f32 v[188:189], v[42:43], v[176:177], v[188:189] op_sel:[0,0,0] op_sel_hi:[1,0,1]
  v_pk_fma_f32 v[190:191], v[44:45], v[176:177], v[190:191] op_sel:[0,0,0] op_sel_hi:[1,0,1]
  v_pk_fma_f32 v[192:193], v[46:47], v[176:177], v[192:193] op_sel:[0,0,0] op_sel_hi:[1,0,1]
  v_pk_fma_f32 v[194:195], v[90:91], v[176:177], v[194:195] op_sel:[0,0,0] op_sel_hi:[1,0,1]
  s_waitcnt lgkmcnt(0)
  v_pk_fma_f32 v[178:179], v[48:49], v[176:177], v[178:179] op_sel:[0,1,0] op_sel_hi:[1,1,1]
  v_pk_fma_f32 v[180:181], v[50:51], v[176:177], v[180:181] op_sel:[0,1,0] op_sel_hi:[1,1,1]
  v_pk_fma_f32 v[182:183], v[52:53], v[176:177], v[182:183] op_sel:[0,1,0] op_sel_hi:[1,1,1]
  v_pk_fma_f32 v[184:185], v[54:55], v[176:177], v[184:185] op_sel:[0,1,0] op_sel_hi:[1,1,1]
  v_pk_fma_f32 v[186:187], v[56:57], v[176:177], v[186:187] op_sel:[0,1,0] op_sel_hi:[1,1,1]
  v_pk_fma_f32 v[188:189], v[58:59], v[176:177], v[188:189] op_sel:[0,1,0] op_sel_hi:[1,1,1]
  v_pk_fma_f32 v[190:191], v[60:61], v[176:177], v[190:191] op_sel:[0,1,0] op_sel_hi:[1,1,1]
  v_pk_fma_f32 v[192:193], v[62:63], v[176:177], v[192:193] op_sel:[0,1,0] op_sel_hi:[1,1,1]
  v_pk_fma_f32 v[194:195], v[94:95], v[176:177], v[194:195] op_sel:[0,1,0] op_sel_hi:[1,1,1]
  v_cvt_pk_bf16_f32 v96, v178, v179
  v_cvt_pk_bf16_f32 v97, v180, v181
  v_cvt_pk_bf16_f32 v98, v182, v183
  v_cvt_pk_bf16_f32 v99, v184, v185
  v_cvt_pk_bf16_f32 v100, v186, v187
  v_cvt_pk_bf16_f32 v101, v188, v189
  v_cvt_pk_bf16_f32 v102, v190, v191
  v_cvt_pk_bf16_f32 v103, v192, v193
  v_cvt_pk_bf16_f32 v104, v194, v195
  buffer_store_dwordx4 v[96:99], v230, s[4:7], s48 offen sc1
  buffer_store_dwordx4 v[100:103], v230, s[4:7], s48 offen offset:256 sc1
  s_waitcnt vmcnt(31)
  v_mul_f32 v106, v178, v196
  v_mul_f32 v107, v179, v197
  v_fmac_f32 v106, v180, v198
  v_fmac_f32 v107, v181, v199
  v_fmac_f32 v106, v182, v200
  v_fmac_f32 v107, v183, v201
  v_fmac_f32 v106, v184, v202
  v_fmac_f32 v107, v185, v203
  v_fmac_f32 v106, v186, v204
  v_fmac_f32 v107, v187, v205
  v_fmac_f32 v106, v188, v206
  v_fmac_f32 v107, v189, v207
  v_fmac_f32 v106, v190, v208
  v_fmac_f32 v107, v191, v209
  v_fmac_f32 v106, v192, v210
  v_fmac_f32 v107, v193, v211
  v_fmac_f32 v106, v194, v212
  v_fmac_f32 v107, v195, v213
  v_mov_b32 v105, v104
  v_add_f32 v106, v106, v107
  s_nop 0
  v_permlane32_swap_b32 v104, v105
  v_mov_b32 v107, v106
  s_nop 1
  v_permlane32_swap_b32 v106, v107
  s_nop 1
  v_add_f32 v106, v106, v107
  s_mov_b64 exec, 0xffffffff
  buffer_store_dwordx4 v[104:107], v232, s[4:7], s51 offen sc1
  s_mov_b64 exec, -1
  s_mul_i32 s24, s20, 9216
  v_mov_b32 v2, v252
  v_lshrrev_b32 v3, 3, v2
  v_and_b32 v4, 7, v2
  v_bfe_u32 v5, v2, 4, 2
  v_lshlrev_b32 v5, 1, v5
  v_xor_b32 v4, v4, v5
  v_and_b32 v6, 3, v4
  v_lshlrev_b32 v4, 4, v4
  v_lshlrev_b32 v6, 4, v6
  s_movk_i32 s49, 9216
  v_mad_u32_u24 v176, v3, s49, v4
  v_mad_u32_u24 v200, v3, s49, v6
  s_movk_i32 s49, 1152
  v_mad_u32_u24 v180, v3, s49, v4
  v_mad_u32_u24 v236, v3, s49, v6
  v_add_u32 v177, 0x11c00, v176
  v_add_u32 v201, 0x11c00, v200
  v_add_u32 v181, 0x2000, v180
  v_add_u32 v178, 0x23800, v176
  v_add_u32 v202, 0x23800, v200
  v_add_u32 v182, 0x4000, v180
  v_add_u32 v179, 0x35400, v176
  v_add_u32 v203, 0x35400, v200
  v_add_u32 v183, 0x6000, v180
  v_lshrrev_b32 v3, 2, v2
  v_and_b32 v4, 3, v2
  v_lshlrev_b32 v4, 3, v4
  v_lshl_add_u32 v4, v3, 7, v4
  v_bfe_u32 v5, v2, 3, 2
  v_lshl_add_u32 v186, v5, 5, v4
  v_xor_b32 v187, 32, v186
  v_xor_b32 v188, 64, v186
  v_xor_b32 v189, 96, v186
  v_add_u32 v190, 0xc000, v186
  v_add_u32 v191, 0xc000, v187
  v_add_u32 v192, 0xc000, v188
  v_add_u32 v193, 0xc000, v189
  v_add_u32 v194, 0x18000, v186
  v_add_u32 v195, 0x18000, v187
  v_add_u32 v196, 0x18000, v188
  v_add_u32 v197, 0x18000, v189
  s_mul_i32 s25, s21, 576
  s_mul_i32 s49, s20, 663552
  s_add_u32 s25, s25, s49
  s_mul_i32 s46, s21, 331776
  s_xor_b32 s83, s21, 1
  s_mul_i32 s78, s83, 331776
  s_mul_i32 s49, s20, 82944
  s_add_u32 s46, s46, s49
  s_add_u32 s78, s78, s49
  s_cmp_eq_u32 s20, 0
  s_cselect_b32 s52, 8, -1
  s_cselect_b32 s53, -8, 1
  s_mul_i32 s52, s52, 36864
  s_mul_i32 s53, s53, 36864
  s_bitcmp0_b32 s21, 0
  s_cselect_b32 s50, 512, 0
  s_cselect_b32 s54, 0, 64
  s_cselect_b32 s47, s53, 36864
  s_cselect_b32 s79, 36864, s53
  s_cselect_b32 s53, s52, 640
  s_cselect_b32 s55, 0, 640
  s_cselect_b32 s52, 0, s52
  s_cselect_b32 s82, 9, 1
  s_cselect_b32 s34, 1, 2
  s_lshl_b32 s82, s82, 11
  s_lshl_b32 s34, s34, 11
  s_add_u32 s50, s50, s25
  s_add_u32 s25, s25, s54
  s_mov_b32 s26, s25
  s_add_u32 s46, s46, s53
  s_add_u32 s78, s78, s52
  s_add_u32 s78, s78, s55
  s_lshl_b32 s49, s22, 6
  s_add_u32 s49, s49, s20
  s_lshl_b32 s52, s21, 2
  s_lshl_b32 s53, s83, 2
  s_add_u32 s76, s49, s52
  s_add_u32 s77, s49, s53
  s_mul_i32 s76, s76, 20480
  s_mul_i32 s77, s77, 20480
  s_add_u32 s76, s76, 0x1c00000
  s_add_u32 s77, s77, 0x1c00000
  s_add_u32 s34, s34, s77
  s_add_u32 s82, s82, s77
  s_add_u32 s77, s77, 2048
  s_cmp_eq_u32 s23, 0
  s_cselect_b32 s54, 0, 1024
  s_add_u32 s49, s49, s54
  s_add_u32 s49, s49, 0x31820
  s_add_u32 s80, s49, s52
  s_add_u32 s81, s49, s53
  s_lshl_b32 s80, s80, 7
  s_lshl_b32 s81, s81, 7
  v_cmp_eq_u32 vcc, 0, v252
  v_bfrev_b32 v240, 1
  v_cndmask_b32 v240, v240, 0, vcc
  v_mov_b32 v242, s97
  s_mov_b32 s27, 0x48000
  s_mov_b32 s28, 0x48000
  s_mov_b32 s29, 0x1f8000
  s_mov_b32 s30, 0xffce8080
  s_lshl_b32 s49, s22, 2
  s_add_u32 s49, s49, s20
  s_mul_i32 s49, s49, 36864
  s_add_u32 s51, s49, 0x900000
  s_add_u32 s51, s51, s23
  s_mov_b32 s33, 0
  s_mov_b32 s32, -1
  s_mov_b32 s56, 0x0f0f0f0f
  s_mov_b32 s57, 0xf0f0f0f0
  s_bitcmp0_b32 s21, 0
  s_cselect_b32 s52, 8, -1
  s_mul_i32 s52, s52, 64
  v_add_u32 v236, s52, v236
  v_mov_b32 v2, s46
  v_mov_b32 v3, s78
  v_mov_b32 v4, s47
  v_mov_b32 v5, s79
  v_cndmask_b32 v2, v3, v2, s[56:57]
  v_cndmask_b32 v4, v5, v4, s[56:57]
  v_add_u32 v236, v236, v2
  v_add_u32 v237, v236, v4
  s_mov_b32 s8, s36
  s_and_b32 s9, s37, 0xffff
  s_mov_b32 s10, 0x510000
  s_mov_b32 s11, 0x20000
  s_mov_b32 s12, s38
  s_and_b32 s13, s39, 0xffff
  s_mov_b32 s14, 0x510000
  s_mov_b32 s15, 0x20000
  s_mul_i32 s68, s67, 18432
  s_add_u32 s68, s68, s23
  s_add_u32 s69, s68, 0x480000
  s_mul_i32 s70, s66, 3072
  s_add_u32 s68, s68, s70
  v_and_b32 v4, 15, v252
  v_lshrrev_b32 v5, 4, v252
  v_lshlrev_b32 v6, 4, v4
  v_lshl_add_u32 v6, v5, 9, v6
  v_lshlrev_b32 v7, 2, v4
  s_lshl_b32 s70, s67, 12
  s_add_u32 s70, s70, s23
  s_add_u32 s70, s70, 0xb52000
  s_lshl_b32 s71, s67, 6
  s_add_u32 s71, s71, s23
  s_add_u32 s71, s71, 0xb40000
  s_add_u32 s72, s68, 0x240000
  s_lshl_b32 s73, s20, 6
  s_lshl_b32 s74, s21, 2
  s_add_u32 s73, s73, s74
  s_lshl_b32 s62, s73, 2
  s_add_u32 s62, s62, s60
  v_mov_b32 v250, s97
  v_mov_b32 v251, 0
  s_waitcnt vmcnt(0)
  s_mov_b64 exec, 1
  buffer_store_dword v250, v251, s[4:7], s62 offen sc1
  s_mov_b64 exec, -1
  s_barrier
  s_cmp_eq_u32 s75, 3
  s_cbranch_scc1 m_B_idle_23
  v_add_u32 v13, 0xd800, v253
  ds_read_b128 a[72:75], v253 offset:0
  ds_read_b128 a[76:79], v253 offset:1024
  ds_read_b128 a[80:83], v253 offset:2048
  ds_read_b128 a[84:87], v253 offset:3072
  ds_read_b128 a[88:91], v253 offset:4096
  ds_read_b128 a[92:95], v253 offset:5120
  ds_read_b128 a[96:99], v253 offset:6144
  s_bfe_u32 s73, s67, 0x20001
  s_lshl_b32 s73, s73, 6
  s_and_b32 s74, s73, 0x80
  s_cmp_lg_u32 s20, 0
  s_cbranch_scc1 m_wf_skip_27
  v_lshlrev_b32 v250, 2, v252
  s_add_u32 s62, s60, 0xfffffc00
  s_add_u32 s63, s74, 256
  v_add_u32 v250, s63, v250
  s_mov_b32 s64, 0xffffffff
  v_lshlrev_b32 v250, 2, v250
  s_mov_b32 s65, 0x0
  s_mov_b64 exec, s[64:65]
  s_mov_b32 s63, 0
m_wf_loop_25:
  buffer_load_dword v246, v250, s[4:7], s62 offen sc1
  s_waitcnt vmcnt(0)
  v_cmp_eq_u32 vcc, s97, v246
  s_cmp_eq_u64 vcc, s[64:65]
  s_cbranch_scc1 m_wf_done_26
  s_add_u32 s63, s63, 1
  s_cmp_lt_u32 s63, 0x30d40
  s_cbranch_scc1 m_wf_loop_25
m_wf_done_26:
  s_mov_b64 exec, -1
m_wf_skip_27:
  s_barrier
  buffer_load_dwordx4 a[0:3], v253, s[4:7], s69 offen offset:0 sc1
  buffer_load_dwordx4 a[4:7], v253, s[4:7], s69 offen offset:1024 sc1
  buffer_load_dwordx4 a[8:11], v253, s[4:7], s69 offen offset:2048 sc1
  buffer_load_dwordx4 a[12:15], v253, s[4:7], s69 offen offset:3072 sc1
  s_add_u32 s69, s69, 4096
  buffer_load_dwordx4 a[16:19], v253, s[4:7], s69 offen offset:0 sc1
  buffer_load_dwordx4 a[20:23], v253, s[4:7], s69 offen offset:1024 sc1
  buffer_load_dwordx4 a[24:27], v253, s[4:7], s69 offen offset:2048 sc1
  buffer_load_dwordx4 a[28:31], v253, s[4:7], s69 offen offset:3072 sc1
  s_add_u32 s69, s69, 4096
  buffer_load_dwordx4 a[32:35], v253, s[4:7], s69 offen offset:0 sc1
  buffer_load_dwordx4 a[36:39], v253, s[4:7], s69 offen offset:1024 sc1
  buffer_load_dwordx4 a[40:43], v253, s[4:7], s69 offen offset:2048 sc1
  buffer_load_dwordx4 a[44:47], v253, s[4:7], s69 offen offset:3072 sc1
  s_add_u32 s69, s69, 4096
  buffer_load_dwordx4 a[48:51], v253, s[4:7], s69 offen offset:0 sc1
  buffer_load_dwordx4 a[52:55], v253, s[4:7], s69 offen offset:1024 sc1
  buffer_load_dwordx4 a[56:59], v253, s[4:7], s69 offen offset:2048 sc1
  buffer_load_dwordx4 a[60:63], v253, s[4:7], s69 offen offset:3072 sc1
  buffer_load_dwordx4 v[68:71], v6, s[4:7], s70 offen offset:0 sc1
  buffer_load_dwordx4 v[72:75], v6, s[4:7], s70 offen offset:256 sc1
  buffer_load_dwordx4 v[76:79], v6, s[4:7], s70 offen offset:2048 sc1
  buffer_load_dwordx4 v[80:83], v6, s[4:7], s70 offen offset:2304 sc1
  buffer_load_dwordx4 v[56:59], v253, s[4:7], s72 offen offset:0 sc1
  buffer_load_dwordx4 v[60:63], v253, s[4:7], s72 offen offset:1024 sc1
  buffer_load_dwordx4 v[64:67], v253, s[4:7], s72 offen offset:2048 sc1
  buffer_load_dword v12, v7, s[4:7], s71 offen sc1
  s_waitcnt vmcnt(23)
  s_waitcnt lgkmcnt(5)
  v_mfma_f32_16x16x32_bf16 v[32:35], a[72:75], a[0:3], 0
  ds_read_b128 a[100:103], v253 offset:7168
  v_mfma_f32_16x16x32_bf16 v[36:39], a[76:79], a[0:3], 0
  ds_read_b128 a[72:75], v253 offset:8192
  s_waitcnt lgkmcnt(5)
  v_mfma_f32_16x16x32_bf16 v[40:43], a[80:83], a[0:3], 0
  ds_read_b128 a[76:79], v253 offset:9216
  v_mfma_f32_16x16x32_bf16 v[44:47], a[84:87], a[0:3], 0
  ds_read_b128 a[80:83], v253 offset:10240
  s_waitcnt lgkmcnt(5)
  v_mfma_f32_16x16x32_bf16 v[48:51], a[88:91], a[0:3], 0
  ds_read_b128 a[84:87], v253 offset:11264
  v_mfma_f32_16x16x32_bf16 v[52:55], a[92:95], a[0:3], 0
  ds_read_b128 a[88:91], v253 offset:12288
  s_add_u32 s55, s50, 0x0
  s_add_u32 m0, s24, 0x1b000
  s_mov_b64 exec, s[56:57]
  buffer_load_dwordx4 v200, s[8:11], s55 offen offset:0 lds
  buffer_load_dwordx4 v201, s[8:11], s55 offen offset:1024 lds
  buffer_load_dwordx4 v202, s[8:11], s55 offen offset:2048 lds
  buffer_load_dwordx4 v203, s[8:11], s55 offen offset:3072 lds
  s_not_b64 exec, s[56:57]
  buffer_load_dwordx4 v200, s[12:15], s55 offen offset:0 lds
  buffer_load_dwordx4 v201, s[12:15], s55 offen offset:1024 lds
  buffer_load_dwordx4 v202, s[12:15], s55 offen offset:2048 lds
  buffer_load_dwordx4 v203, s[12:15], s55 offen offset:3072 lds
  s_mov_b64 exec, -1
  s_waitcnt vmcnt(30)
  s_waitcnt lgkmcnt(5)
  v_mfma_f32_16x16x32_bf16 v[32:35], a[96:99], a[4:7], v[32:35]
  ds_read_b128 a[92:95], v253 offset:13312
  v_mfma_f32_16x16x32_bf16 v[36:39], a[100:103], a[4:7], v[36:39]
  ds_read_b128 a[96:99], v253 offset:14336
  s_waitcnt lgkmcnt(5)
  v_mfma_f32_16x16x32_bf16 v[40:43], a[72:75], a[4:7], v[40:43]
  ds_read_b128 a[100:103], v253 offset:15360
  v_mfma_f32_16x16x32_bf16 v[44:47], a[76:79], a[4:7], v[44:47]
  ds_read_b128 a[72:75], v253 offset:16384
  s_waitcnt lgkmcnt(5)
  v_mfma_f32_16x16x32_bf16 v[48:51], a[80:83], a[4:7], v[48:51]
  ds_read_b128 a[76:79], v253 offset:17408
  v_mfma_f32_16x16x32_bf16 v[52:55], a[84:87], a[4:7], v[52:55]
  ds_read_b128 a[80:83], v253 offset:18432
  s_add_u32 s55, s50, 0x48000
  s_add_u32 m0, s24, 0x1c000
  s_mov_b64 exec, s[56:57]
  buffer_load_dwordx4 v200, s[8:11], s55 offen offset:0 lds
  buffer_load_dwordx4 v201, s[8:11], s55 offen offset:1024 lds
  buffer_load_dwordx4 v202, s[8:11], s55 offen offset:2048 lds
  buffer_load_dwordx4 v203, s[8:11], s55 offen offset:3072 lds
  s_not_b64 exec, s[56:57]
  buffer_load_dwordx4 v200, s[12:15], s55 offen offset:0 lds
  buffer_load_dwordx4 v201, s[12:15], s55 offen offset:1024 lds
  buffer_load_dwordx4 v202, s[12:15], s55 offen offset:2048 lds
  buffer_load_dwordx4 v203, s[12:15], s55 offen offset:3072 lds
  s_mov_b64 exec, -1
  s_waitcnt vmcnt(37)
  s_waitcnt lgkmcnt(5)
  v_mfma_f32_16x16x32_bf16 v[32:35], a[88:91], a[8:11], v[32:35]
  ds_read_b128 a[84:87], v253 offset:19456
  v_mfma_f32_16x16x32_bf16 v[36:39], a[92:95], a[8:11], v[36:39]
  ds_read_b128 a[88:91], v253 offset:20480
  s_waitcnt lgkmcnt(5)
  v_mfma_f32_16x16x32_bf16 v[40:43], a[96:99], a[8:11], v[40:43]
  ds_read_b128 a[92:95], v253 offset:21504
  v_mfma_f32_16x16x32_bf16 v[44:47], a[100:103], a[8:11], v[44:47]
  ds_read_b128 a[96:99], v253 offset:22528
  s_waitcnt lgkmcnt(5)
  v_mfma_f32_16x16x32_bf16 v[48:51], a[72:75], a[8:11], v[48:51]
  ds_read_b128 a[100:103], v253 offset:23552
  v_mfma_f32_16x16x32_bf16 v[52:55], a[76:79], a[8:11], v[52:55]
  ds_read_b128 a[72:75], v253 offset:24576
  s_add_u32 s55, s50, 0x90000
  s_add_u32 m0, s24, 0x1d000
  s_mov_b64 exec, s[56:57]
  buffer_load_dwordx4 v200, s[8:11], s55 offen offset:0 lds
  s_not_b64 exec, s[56:57]
  buffer_load_dwordx4 v200, s[12:15], s55 offen offset:0 lds
  s_mov_b64 exec, -1
  s_waitcnt vmcnt(38)
  s_waitcnt lgkmcnt(5)
  v_mfma_f32_16x16x32_bf16 v[32:35], a[80:83], a[12:15], v[32:35]
  ds_read_b128 a[76:79], v253 offset:25600
  v_mfma_f32_16x16x32_bf16 v[36:39], a[84:87], a[12:15], v[36:39]
  ds_read_b128 a[80:83], v253 offset:26624
  s_waitcnt lgkmcnt(5)
  v_mfma_f32_16x16x32_bf16 v[40:43], a[88:91], a[12:15], v[40:43]
  ds_read_b128 a[84:87], v253 offset:27648
  v_mfma_f32_16x16x32_bf16 v[44:47], a[92:95], a[12:15], v[44:47]
  ds_read_b128 a[88:91], v253 offset:28672
  s_waitcnt lgkmcnt(5)
  v_mfma_f32_16x16x32_bf16 v[48:51], a[96:99], a[12:15], v[48:51]
  ds_read_b128 a[92:95], v253 offset:29696
  v_mfma_f32_16x16x32_bf16 v[52:55], a[100:103], a[12:15], v[52:55]
  ds_read_b128 a[96:99], v253 offset:30720
  s_waitcnt vmcnt(37)
  s_waitcnt lgkmcnt(5)
  v_mfma_f32_16x16x32_bf16 v[32:35], a[72:75], a[16:19], v[32:35]
  ds_read_b128 a[100:103], v253 offset:31744
  v_mfma_f32_16x16x32_bf16 v[36:39], a[76:79], a[16:19], v[36:39]
  ds_read_b128 a[72:75], v253 offset:32768
  s_waitcnt lgkmcnt(5)
  v_mfma_f32_16x16x32_bf16 v[40:43], a[80:83], a[16:19], v[40:43]
  ds_read_b128 a[76:79], v253 offset:33792
  v_mfma_f32_16x16x32_bf16 v[44:47], a[84:87], a[16:19], v[44:47]
  ds_read_b128 a[80:83], v253 offset:34816
  s_waitcnt lgkmcnt(5)
  v_mfma_f32_16x16x32_bf16 v[48:51], a[88:91], a[16:19], v[48:51]
  ds_read_b128 a[84:87], v253 offset:35840
  v_mfma_f32_16x16x32_bf16 v[52:55], a[92:95], a[16:19], v[52:55]
  ds_read_b128 a[88:91], v253 offset:36864
  s_waitcnt vmcnt(36)
  s_waitcnt lgkmcnt(5)
  v_mfma_f32_16x16x32_bf16 v[32:35], a[96:99], a[20:23], v[32:35]
  ds_read_b128 a[92:95], v253 offset:37888
  v_mfma_f32_16x16x32_bf16 v[36:39], a[100:103], a[20:23], v[36:39]
  ds_read_b128 a[96:99], v253 offset:38912
  s_waitcnt lgkmcnt(5)
  v_mfma_f32_16x16x32_bf16 v[40:43], a[72:75], a[20:23], v[40:43]
  ds_read_b128 a[100:103], v253 offset:39936
  v_mfma_f32_16x16x32_bf16 v[44:47], a[76:79], a[20:23], v[44:47]
  ds_read_b128 a[72:75], v253 offset:40960
  s_waitcnt lgkmcnt(5)
  v_mfma_f32_16x16x32_bf16 v[48:51], a[80:83], a[20:23], v[48:51]
  ds_read_b128 a[76:79], v253 offset:41984
  v_mfma_f32_16x16x32_bf16 v[52:55], a[84:87], a[20:23], v[52:55]
  ds_read_b128 a[80:83], v253 offset:43008
  s_waitcnt vmcnt(35)
  s_waitcnt lgkmcnt(5)
  v_mfma_f32_16x16x32_bf16 v[32:35], a[88:91], a[24:27], v[32:35]
  ds_read_b128 a[84:87], v253 offset:44032
  v_mfma_f32_16x16x32_bf16 v[36:39], a[92:95], a[24:27], v[36:39]
  ds_read_b128 a[88:91], v253 offset:45056
  s_waitcnt lgkmcnt(5)
  v_mfma_f32_16x16x32_bf16 v[40:43], a[96:99], a[24:27], v[40:43]
  ds_read_b128 a[92:95], v253 offset:46080
  v_mfma_f32_16x16x32_bf16 v[44:47], a[100:103], a[24:27], v[44:47]
  ds_read_b128 a[96:99], v253 offset:47104
  s_waitcnt lgkmcnt(5)
  v_mfma_f32_16x16x32_bf16 v[48:51], a[72:75], a[24:27], v[48:51]
  ds_read_b128 a[100:103], v253 offset:48128
  v_mfma_f32_16x16x32_bf16 v[52:55], a[76:79], a[24:27], v[52:55]
  ds_read_b128 a[72:75], v253 offset:49152
  s_waitcnt vmcnt(34)
  s_waitcnt lgkmcnt(5)
  v_mfma_f32_16x16x32_bf16 v[32:35], a[80:83], a[28:31], v[32:35]
  ds_read_b128 a[76:79], v253 offset:50176
  v_mfma_f32_16x16x32_bf16 v[36:39], a[84:87], a[28:31], v[36:39]
  ds_read_b128 a[80:83], v253 offset:51200
  s_waitcnt lgkmcnt(5)
  v_mfma_f32_16x16x32_bf16 v[40:43], a[88:91], a[28:31], v[40:43]
  ds_read_b128 a[84:87], v253 offset:52224
  s_barrier
  v_mfma_f32_16x16x32_bf16 v[44:47], a[92:95], a[28:31], v[44:47]
  ds_read_b128 a[88:91], v253 offset:53248
  s_waitcnt lgkmcnt(5)
  v_mfma_f32_16x16x32_bf16 v[48:51], a[96:99], a[28:31], v[48:51]
  ds_read_b128 a[92:95], v253 offset:54272
  v_mfma_f32_16x16x32_bf16 v[52:55], a[100:103], a[28:31], v[52:55]
  ds_read_b128 a[96:99], v13 offset:0
  s_add_u32 s55, s50, 0x288000
  s_add_u32 m0, s24, 0x0
  s_mov_b64 exec, s[56:57]
  buffer_load_dwordx4 v200, s[8:11], s55 offen offset:0 lds
  buffer_load_dwordx4 v201, s[8:11], s55 offen offset:1024 lds
  buffer_load_dwordx4 v202, s[8:11], s55 offen offset:2048 lds
  buffer_load_dwordx4 v203, s[8:11], s55 offen offset:3072 lds
  s_not_b64 exec, s[56:57]
  buffer_load_dwordx4 v200, s[12:15], s55 offen offset:0 lds
  buffer_load_dwordx4 v201, s[12:15], s55 offen offset:1024 lds
  buffer_load_dwordx4 v202, s[12:15], s55 offen offset:2048 lds
  buffer_load_dwordx4 v203, s[12:15], s55 offen offset:3072 lds
  s_mov_b64 exec, -1
  s_waitcnt vmcnt(41)
  s_waitcnt lgkmcnt(5)
  v_mfma_f32_16x16x32_bf16 v[32:35], a[72:75], a[32:35], v[32:35]
  ds_read_b128 a[100:103], v13 offset:1024
  v_mfma_f32_16x16x32_bf16 v[36:39], a[76:79], a[32:35], v[36:39]
  ds_read_b128 a[72:75], v13 offset:2048
  s_waitcnt lgkmcnt(5)
  v_mfma_f32_16x16x32_bf16 v[40:43], a[80:83], a[32:35], v[40:43]
  ds_read_b128 a[76:79], v13 offset:3072
  v_mfma_f32_16x16x32_bf16 v[44:47], a[84:87], a[32:35], v[44:47]
  ds_read_b128 a[80:83], v13 offset:4096
  s_waitcnt lgkmcnt(5)
  v_mfma_f32_16x16x32_bf16 v[48:51], a[88:91], a[32:35], v[48:51]
  ds_read_b128 a[84:87], v13 offset:5120
  v_mfma_f32_16x16x32_bf16 v[52:55], a[92:95], a[32:35], v[52:55]
  ds_read_b128 a[88:91], v13 offset:6144
  s_add_u32 s55, s50, 0x2d0000
  s_add_u32 m0, s24, 0x1000
  s_mov_b64 exec, s[56:57]
  buffer_load_dwordx4 v200, s[8:11], s55 offen offset:0 lds
  buffer_load_dwordx4 v201, s[8:11], s55 offen offset:1024 lds
  buffer_load_dwordx4 v202, s[8:11], s55 offen offset:2048 lds
  buffer_load_dwordx4 v203, s[8:11], s55 offen offset:3072 lds
  s_not_b64 exec, s[56:57]
  buffer_load_dwordx4 v200, s[12:15], s55 offen offset:0 lds
  buffer_load_dwordx4 v201, s[12:15], s55 offen offset:1024 lds
  buffer_load_dwordx4 v202, s[12:15], s55 offen offset:2048 lds
  buffer_load_dwordx4 v203, s[12:15], s55 offen offset:3072 lds
  s_mov_b64 exec, -1
  s_waitcnt vmcnt(48)
  s_waitcnt lgkmcnt(5)
  v_mfma_f32_16x16x32_bf16 v[32:35], a[96:99], a[36:39], v[32:35]
  ds_read_b128 a[92:95], v13 offset:7168
  v_mfma_f32_16x16x32_bf16 v[36:39], a[100:103], a[36:39], v[36:39]
  ds_read_b128 a[96:99], v13 offset:8192
  s_waitcnt lgkmcnt(5)
  v_mfma_f32_16x16x32_bf16 v[40:43], a[72:75], a[36:39], v[40:43]
  ds_read_b128 a[100:103], v13 offset:9216
  v_mfma_f32_16x16x32_bf16 v[44:47], a[76:79], a[36:39], v[44:47]
  ds_read_b128 a[72:75], v13 offset:10240
  s_waitcnt lgkmcnt(5)
  v_mfma_f32_16x16x32_bf16 v[48:51], a[80:83], a[36:39], v[48:51]
  ds_read_b128 a[76:79], v13 offset:11264
  v_mfma_f32_16x16x32_bf16 v[52:55], a[84:87], a[36:39], v[52:55]
  ds_read_b128 a[80:83], v13 offset:12288
  s_add_u32 s55, s50, 0x318000
  s_add_u32 m0, s24, 0x2000
  s_mov_b64 exec, s[56:57]
  buffer_load_dwordx4 v200, s[8:11], s55 offen offset:0 lds
  s_not_b64 exec, s[56:57]
  buffer_load_dwordx4 v200, s[12:15], s55 offen offset:0 lds
  s_mov_b64 exec, -1
  s_waitcnt vmcnt(49)
  s_waitcnt lgkmcnt(5)
  v_mfma_f32_16x16x32_bf16 v[32:35], a[88:91], a[40:43], v[32:35]
  ds_read_b128 a[84:87], v13 offset:13312
  v_mfma_f32_16x16x32_bf16 v[36:39], a[92:95], a[40:43], v[36:39]
  ds_read_b128 a[88:91], v13 offset:14336
  s_waitcnt lgkmcnt(5)
  v_mfma_f32_16x16x32_bf16 v[40:43], a[96:99], a[40:43], v[40:43]
  ds_read_b128 a[92:95], v13 offset:15360
  v_mfma_f32_16x16x32_bf16 v[44:47], a[100:103], a[40:43], v[44:47]
  ds_read_b128 a[96:99], v13 offset:16384
  s_waitcnt lgkmcnt(5)
  v_mfma_f32_16x16x32_bf16 v[48:51], a[72:75], a[40:43], v[48:51]
  ds_read_b128 a[100:103], v13 offset:17408
  v_mfma_f32_16x16x32_bf16 v[52:55], a[76:79], a[40:43], v[52:55]
  ds_read_b128 a[72:75], v13 offset:18432
  s_waitcnt vmcnt(48)
  s_waitcnt lgkmcnt(5)
  v_mfma_f32_16x16x32_bf16 v[32:35], a[80:83], a[44:47], v[32:35]
  ds_read_b128 a[76:79], v13 offset:19456
  v_mfma_f32_16x16x32_bf16 v[36:39], a[84:87], a[44:47], v[36:39]
  ds_read_b128 a[80:83], v13 offset:20480
  s_waitcnt lgkmcnt(5)
  v_mfma_f32_16x16x32_bf16 v[40:43], a[88:91], a[44:47], v[40:43]
  ds_read_b128 a[84:87], v13 offset:21504
  v_mfma_f32_16x16x32_bf16 v[44:47], a[92:95], a[44:47], v[44:47]
  ds_read_b128 a[88:91], v13 offset:22528
  s_waitcnt lgkmcnt(5)
  v_mfma_f32_16x16x32_bf16 v[48:51], a[96:99], a[44:47], v[48:51]
  ds_read_b128 a[92:95], v13 offset:23552
  v_mfma_f32_16x16x32_bf16 v[52:55], a[100:103], a[44:47], v[52:55]
  ds_read_b128 a[96:99], v13 offset:24576
  s_waitcnt vmcnt(47)
  s_waitcnt lgkmcnt(5)
  v_mfma_f32_16x16x32_bf16 v[32:35], a[72:75], a[48:51], v[32:35]
  ds_read_b128 a[100:103], v13 offset:25600
  v_mfma_f32_16x16x32_bf16 v[36:39], a[76:79], a[48:51], v[36:39]
  ds_read_b128 a[72:75], v13 offset:26624
  s_waitcnt lgkmcnt(5)
  v_mfma_f32_16x16x32_bf16 v[40:43], a[80:83], a[48:51], v[40:43]
  ds_read_b128 a[76:79], v13 offset:27648
  v_mfma_f32_16x16x32_bf16 v[44:47], a[84:87], a[48:51], v[44:47]
  ds_read_b128 a[80:83], v13 offset:28672
  s_waitcnt lgkmcnt(5)
  v_mfma_f32_16x16x32_bf16 v[48:51], a[88:91], a[48:51], v[48:51]
  ds_read_b128 a[84:87], v13 offset:29696
  v_mfma_f32_16x16x32_bf16 v[52:55], a[92:95], a[48:51], v[52:55]
  ds_read_b128 a[88:91], v13 offset:30720
  s_waitcnt vmcnt(46)
  s_waitcnt lgkmcnt(5)
  v_mfma_f32_16x16x32_bf16 v[32:35], a[96:99], a[52:55], v[32:35]
  ds_read_b128 a[92:95], v13 offset:31744
  v_mfma_f32_16x16x32_bf16 v[36:39], a[100:103], a[52:55], v[36:39]
  ds_read_b128 a[96:99], v13 offset:32768
  s_waitcnt lgkmcnt(5)
  v_mfma_f32_16x16x32_bf16 v[40:43], a[72:75], a[52:55], v[40:43]
  ds_read_b128 a[100:103], v13 offset:33792
  v_mfma_f32_16x16x32_bf16 v[44:47], a[76:79], a[52:55], v[44:47]
  ds_read_b128 a[72:75], v13 offset:34816
  s_waitcnt lgkmcnt(5)
  v_mfma_f32_16x16x32_bf16 v[48:51], a[80:83], a[52:55], v[48:51]
  ds_read_b128 a[76:79], v13 offset:35840
  v_mfma_f32_16x16x32_bf16 v[52:55], a[84:87], a[52:55], v[52:55]
  ds_read_b128 a[80:83], v13 offset:36864
  s_waitcnt vmcnt(45)
  s_waitcnt lgkmcnt(5)
  v_mfma_f32_16x16x32_bf16 v[32:35], a[88:91], a[56:59], v[32:35]
  ds_read_b128 a[84:87], v13 offset:37888
  v_mfma_f32_16x16x32_bf16 v[36:39], a[92:95], a[56:59], v[36:39]
  ds_read_b128 a[88:91], v13 offset:38912
  s_waitcnt lgkmcnt(5)
  v_mfma_f32_16x16x32_bf16 v[40:43], a[96:99], a[56:59], v[40:43]
  ds_read_b128 a[92:95], v13 offset:39936
  v_mfma_f32_16x16x32_bf16 v[44:47], a[100:103], a[56:59], v[44:47]
  ds_read_b128 a[96:99], v13 offset:40960
  s_waitcnt lgkmcnt(5)
  v_mfma_f32_16x16x32_bf16 v[48:51], a[72:75], a[56:59], v[48:51]
  ds_read_b128 a[100:103], v13 offset:41984
  v_mfma_f32_16x16x32_bf16 v[52:55], a[76:79], a[56:59], v[52:55]
  ds_read_b128 a[72:75], v13 offset:43008
  s_waitcnt vmcnt(44)
  s_waitcnt vmcnt(40)
  v_add_f32 v8, v70, v74
  v_add_f32 v9, v78, v82
  v_mov_b32 v70, v72
  v_mov_b32 v71, v73
  v_mov_b32 v78, v80
  v_mov_b32 v79, v81
  v_add_f32 v8, v8, v9
  v_mov_b32 v9, v8
  s_nop 1
  v_permlane16_swap_b32 v8, v9
  s_nop 1
  v_add_f32 v8, v8, v9
  v_mov_b32 v9, v8
  s_nop 1
  v_permlane32_swap_b32 v8, v9
  s_nop 1
  v_add_f32 v8, v8, v9
  s_waitcnt lgkmcnt(5)
  v_mfma_f32_16x16x32_bf16 v[32:35], a[80:83], a[60:63], v[32:35]
  ds_read_b128 a[76:79], v13 offset:44032
  v_mfma_f32_16x16x32_bf16 v[36:39], a[84:87], a[60:63], v[36:39]
  ds_read_b128 a[80:83], v13 offset:45056
  s_waitcnt lgkmcnt(5)
  v_mfma_f32_16x16x32_bf16 v[40:43], a[88:91], a[60:63], v[40:43]
  ds_read_b128 a[84:87], v13 offset:46080
  v_mfma_f32_16x16x32_bf16 v[44:47], a[92:95], a[60:63], v[44:47]
  ds_read_b128 a[88:91], v13 offset:47104
  s_waitcnt lgkmcnt(5)
  v_mfma_f32_16x16x32_bf16 v[48:51], a[96:99], a[60:63], v[48:51]
  ds_read_b128 a[92:95], v13 offset:48128
  v_mfma_f32_16x16x32_bf16 v[52:55], a[100:103], a[60:63], v[52:55]
  ds_read_b128 a[96:99], v13 offset:49152
  s_waitcnt lgkmcnt(5)
  v_mfma_f32_16x16x32_bf16 v[32:35], a[72:75], v[68:71], v[32:35]
  ds_read_b128 a[100:103], v13 offset:50176
  v_mfma_f32_16x16x32_bf16 v[36:39], a[76:79], v[68:71], v[36:39]
  ds_read_b128 a[72:75], v13 offset:51200
  s_waitcnt lgkmcnt(5)
  v_mfma_f32_16x16x32_bf16 v[40:43], a[80:83], v[68:71], v[40:43]
  ds_read_b128 a[76:79], v13 offset:52224
  v_mfma_f32_16x16x32_bf16 v[44:47], a[84:87], v[68:71], v[44:47]
  ds_read_b128 a[80:83], v13 offset:53248
  s_waitcnt lgkmcnt(5)
  v_mfma_f32_16x16x32_bf16 v[48:51], a[88:91], v[68:71], v[48:51]
  ds_read_b128 a[84:87], v13 offset:54272
  v_mfma_f32_16x16x32_bf16 v[52:55], a[92:95], v[68:71], v[52:55]
  s_waitcnt lgkmcnt(4)
  v_mfma_f32_16x16x32_bf16 v[32:35], a[96:99], v[76:79], v[32:35]
  v_mfma_f32_16x16x32_bf16 v[36:39], a[100:103], v[76:79], v[36:39]
  s_waitcnt lgkmcnt(2)
  v_mfma_f32_16x16x32_bf16 v[40:43], a[72:75], v[76:79], v[40:43]
  v_mfma_f32_16x16x32_bf16 v[44:47], a[76:79], v[76:79], v[44:47]
  s_waitcnt lgkmcnt(0)
  v_mfma_f32_16x16x32_bf16 v[48:51], a[80:83], v[76:79], v[48:51]
  v_mfma_f32_16x16x32_bf16 v[52:55], a[84:87], v[76:79], v[52:55]
  s_add_u32 s71, s68, 0x6c0000
  s_add_u32 s72, s68, 0x900000
  s_waitcnt vmcnt(36)
  v_add_f32 v8, v8, v12
  v_mov_b32 v9, 0
  v_lshlrev_b32 v16, 16, v56
  v_and_b32 v17, 0xffff0000, v56
  v_add_f32 v16, v16, v32
  v_add_f32 v17, v17, v33
  v_cvt_pk_bf16_f32 v56, v16, v17
  v_lshlrev_b32 v16, 16, v56
  v_and_b32 v17, 0xffff0000, v56
  v_sub_f32 v32, v16, v8
  v_sub_f32 v33, v17, v8
  v_cvt_pk_bf16_f32 v20, v32, v33
  v_lshlrev_b32 v16, 16, v57
  v_and_b32 v17, 0xffff0000, v57
  v_add_f32 v16, v16, v34
  v_add_f32 v17, v17, v35
  v_cvt_pk_bf16_f32 v57, v16, v17
  v_lshlrev_b32 v16, 16, v57
  v_and_b32 v17, 0xffff0000, v57
  v_sub_f32 v34, v16, v8
  v_sub_f32 v35, v17, v8
  v_cvt_pk_bf16_f32 v21, v34, v35
  v_lshlrev_b32 v16, 16, v58
  v_and_b32 v17, 0xffff0000, v58
  v_add_f32 v16, v16, v36
  v_add_f32 v17, v17, v37
  v_cvt_pk_bf16_f32 v58, v16, v17
  v_lshlrev_b32 v16, 16, v58
  v_and_b32 v17, 0xffff0000, v58
  v_sub_f32 v36, v16, v8
  v_sub_f32 v37, v17, v8
  v_cvt_pk_bf16_f32 v22, v36, v37
  v_lshlrev_b32 v16, 16, v59
  v_and_b32 v17, 0xffff0000, v59
  v_add_f32 v16, v16, v38
  v_add_f32 v17, v17, v39
  v_cvt_pk_bf16_f32 v59, v16, v17
  v_lshlrev_b32 v16, 16, v59
  v_and_b32 v17, 0xffff0000, v59
  v_sub_f32 v38, v16, v8
  v_sub_f32 v39, v17, v8
  v_cvt_pk_bf16_f32 v23, v38, v39
  buffer_store_dwordx4 v[20:23], v253, s[4:7], s72 offen offset:0 sc1
  v_lshlrev_b32 v16, 16, v60
  v_and_b32 v17, 0xffff0000, v60
  v_add_f32 v16, v16, v40
  v_add_f32 v17, v17, v41
  v_cvt_pk_bf16_f32 v60, v16, v17
  v_lshlrev_b32 v16, 16, v60
  v_and_b32 v17, 0xffff0000, v60
  v_sub_f32 v40, v16, v8
  v_sub_f32 v41, v17, v8
  v_cvt_pk_bf16_f32 v24, v40, v41
  v_lshlrev_b32 v16, 16, v61
  v_and_b32 v17, 0xffff0000, v61
  v_add_f32 v16, v16, v42
  v_add_f32 v17, v17, v43
  v_cvt_pk_bf16_f32 v61, v16, v17
  v_lshlrev_b32 v16, 16, v61
  v_and_b32 v17, 0xffff0000, v61
  v_sub_f32 v42, v16, v8
  v_sub_f32 v43, v17, v8
  v_cvt_pk_bf16_f32 v25, v42, v43
  v_lshlrev_b32 v16, 16, v62
  v_and_b32 v17, 0xffff0000, v62
  v_add_f32 v16, v16, v44
  v_add_f32 v17, v17, v45
  v_cvt_pk_bf16_f32 v62, v16, v17
  v_lshlrev_b32 v16, 16, v62
  v_and_b32 v17, 0xffff0000, v62
  v_sub_f32 v44, v16, v8
  v_sub_f32 v45, v17, v8
  v_cvt_pk_bf16_f32 v26, v44, v45
  v_lshlrev_b32 v16, 16, v63
  v_and_b32 v17, 0xffff0000, v63
  v_add_f32 v16, v16, v46
  v_add_f32 v17, v17, v47
  v_cvt_pk_bf16_f32 v63, v16, v17
  v_lshlrev_b32 v16, 16, v63
  v_and_b32 v17, 0xffff0000, v63
  v_sub_f32 v46, v16, v8
  v_sub_f32 v47, v17, v8
  v_cvt_pk_bf16_f32 v27, v46, v47
  buffer_store_dwordx4 v[24:27], v253, s[4:7], s72 offen offset:1024 sc1
  v_lshlrev_b32 v16, 16, v64
  v_and_b32 v17, 0xffff0000, v64
  v_add_f32 v16, v16, v48
  v_add_f32 v17, v17, v49
  v_cvt_pk_bf16_f32 v64, v16, v17
  v_lshlrev_b32 v16, 16, v64
  v_and_b32 v17, 0xffff0000, v64
  v_sub_f32 v48, v16, v8
  v_sub_f32 v49, v17, v8
  v_cvt_pk_bf16_f32 v28, v48, v49
  v_lshlrev_b32 v16, 16, v65
  v_and_b32 v17, 0xffff0000, v65
  v_add_f32 v16, v16, v50
  v_add_f32 v17, v17, v51
  v_cvt_pk_bf16_f32 v65, v16, v17
  v_lshlrev_b32 v16, 16, v65
  v_and_b32 v17, 0xffff0000, v65
  v_sub_f32 v50, v16, v8
  v_sub_f32 v51, v17, v8
  v_cvt_pk_bf16_f32 v29, v50, v51
  v_lshlrev_b32 v16, 16, v66
  v_and_b32 v17, 0xffff0000, v66
  v_add_f32 v16, v16, v52
  v_add_f32 v17, v17, v53
  v_cvt_pk_bf16_f32 v66, v16, v17
  v_lshlrev_b32 v16, 16, v66
  v_and_b32 v17, 0xffff0000, v66
  v_sub_f32 v52, v16, v8
  v_sub_f32 v53, v17, v8
  v_cvt_pk_bf16_f32 v30, v52, v53
  v_lshlrev_b32 v16, 16, v67
  v_and_b32 v17, 0xffff0000, v67
  v_add_f32 v16, v16, v54
  v_add_f32 v17, v17, v55
  v_cvt_pk_bf16_f32 v67, v16, v17
  v_lshlrev_b32 v16, 16, v67
  v_and_b32 v17, 0xffff0000, v67
  v_sub_f32 v54, v16, v8
  v_sub_f32 v55, v17, v8
  v_cvt_pk_bf16_f32 v31, v54, v55
  buffer_store_dwordx4 v[28:31], v253, s[4:7], s72 offen offset:2048 sc1
  s_and_b32 s73, s67, 7
  s_lshl_b32 s73, s73, 5
  s_lshl_b32 s74, s66, 2
  s_add_u32 s73, s73, s74
  v_fmac_f32 v9, v32, v32
  v_fmac_f32 v9, v33, v33
  v_fmac_f32 v9, v34, v34
  v_fmac_f32 v9, v35, v35
  v_fmac_f32 v9, v36, v36
  v_fmac_f32 v9, v37, v37
  v_fmac_f32 v9, v38, v38
  v_fmac_f32 v9, v39, v39
  v_fmac_f32 v9, v40, v40
  v_fmac_f32 v9, v41, v41
  v_fmac_f32 v9, v42, v42
  v_fmac_f32 v9, v43, v43
  v_fmac_f32 v9, v44, v44
  v_fmac_f32 v9, v45, v45
  v_fmac_f32 v9, v46, v46
  v_fmac_f32 v9, v47, v47
  v_fmac_f32 v9, v48, v48
  v_fmac_f32 v9, v49, v49
  v_fmac_f32 v9, v50, v50
  v_fmac_f32 v9, v51, v51
  v_fmac_f32 v9, v52, v52
  v_fmac_f32 v9, v53, v53
  v_fmac_f32 v9, v54, v54
  v_fmac_f32 v9, v55, v55
  v_mov_b32 v10, v9
  s_nop 1
  v_permlane16_swap_b32 v9, v10
  s_nop 1
  v_add_f32 v9, v9, v10
  v_mov_b32 v10, v9
  s_nop 1
  v_permlane32_swap_b32 v9, v10
  s_nop 1
  v_add_f32 v9, v9, v10
  s_lshl_b32 s62, s73, 2
  s_add_u32 s62, s62, s60
  v_mov_b32 v250, s97
  v_mov_b32 v251, 16384
  s_waitcnt vmcnt(0)
  s_mov_b64 exec, 1
  buffer_store_dword v250, v251, s[4:7], s62 offen sc1
  s_mov_b64 exec, -1
  s_barrier
  s_add_u32 m0, s24, 0x9000
  s_nop 0
  buffer_load_dwordx4 v176, s[8:11], s25 offen offset:0 lds
  buffer_load_dwordx4 v177, s[8:11], s25 offen offset:1024 lds
  buffer_load_dwordx4 v178, s[8:11], s25 offen offset:2048 lds
  buffer_load_dwordx4 v179, s[8:11], s25 offen offset:3072 lds
  s_add_u32 s25, s25, s27
  s_add_u32 m0, s24, 0xa000
  s_nop 0
  buffer_load_dwordx4 v176, s[8:11], s25 offen offset:0 lds
  buffer_load_dwordx4 v177, s[8:11], s25 offen offset:1024 lds
  buffer_load_dwordx4 v178, s[8:11], s25 offen offset:2048 lds
  buffer_load_dwordx4 v179, s[8:11], s25 offen offset:3072 lds
  s_add_u32 s25, s25, s28
  s_add_u32 m0, s24, 0xb000
  s_nop 0
  buffer_load_dwordx4 v176, s[8:11], s25 offen offset:0 lds
  s_add_u32 s25, s25, s29
  buffer_store_dwordx4 v[56:59], v253, s[4:7], s71 offen offset:0 sc1
  buffer_store_dwordx4 v[60:63], v253, s[4:7], s71 offen offset:1024 sc1
  buffer_store_dwordx4 v[64:67], v253, s[4:7], s71 offen offset:2048 sc1
  v_lshlrev_b32 v6, 2, v4
  s_lshl_b32 s69, s67, 9
  s_lshl_b32 s74, s74, 4
  s_add_u32 s69, s69, s74
  s_add_u32 s69, s69, s23
  s_add_u32 s69, s69, 0xb42000
  s_mov_b64 exec, 0xffff
  buffer_store_dword v9, v6, s[4:7], s69 offen sc1
  s_mov_b64 exec, -1
  s_branch m_B_join_24
m_B_idle_23:
  s_add_u32 s55, s50, 0x0
  s_add_u32 m0, s24, 0x1b000
  s_mov_b64 exec, s[56:57]
  buffer_load_dwordx4 v200, s[8:11], s55 offen offset:0 lds
  buffer_load_dwordx4 v201, s[8:11], s55 offen offset:1024 lds
  buffer_load_dwordx4 v202, s[8:11], s55 offen offset:2048 lds
  buffer_load_dwordx4 v203, s[8:11], s55 offen offset:3072 lds
  s_not_b64 exec, s[56:57]
  buffer_load_dwordx4 v200, s[12:15], s55 offen offset:0 lds
  buffer_load_dwordx4 v201, s[12:15], s55 offen offset:1024 lds
  buffer_load_dwordx4 v202, s[12:15], s55 offen offset:2048 lds
  buffer_load_dwordx4 v203, s[12:15], s55 offen offset:3072 lds
  s_mov_b64 exec, -1
  s_add_u32 s55, s50, 0x48000
  s_add_u32 m0, s24, 0x1c000
  s_mov_b64 exec, s[56:57]
  buffer_load_dwordx4 v200, s[8:11], s55 offen offset:0 lds
  buffer_load_dwordx4 v201, s[8:11], s55 offen offset:1024 lds
  buffer_load_dwordx4 v202, s[8:11], s55 offen offset:2048 lds
  buffer_load_dwordx4 v203, s[8:11], s55 offen offset:3072 lds
  s_not_b64 exec, s[56:57]
  buffer_load_dwordx4 v200, s[12:15], s55 offen offset:0 lds
  buffer_load_dwordx4 v201, s[12:15], s55 offen offset:1024 lds
  buffer_load_dwordx4 v202, s[12:15], s55 offen offset:2048 lds
  buffer_load_dwordx4 v203, s[12:15], s55 offen offset:3072 lds
  s_mov_b64 exec, -1
  s_add_u32 s55, s50, 0x90000
  s_add_u32 m0, s24, 0x1d000
  s_mov_b64 exec, s[56:57]
  buffer_load_dwordx4 v200, s[8:11], s55 offen offset:0 lds
  s_not_b64 exec, s[56:57]
  buffer_load_dwordx4 v200, s[12:15], s55 offen offset:0 lds
  s_mov_b64 exec, -1
  s_add_u32 s55, s50, 0x288000
  s_add_u32 m0, s24, 0x0
  s_mov_b64 exec, s[56:57]
  buffer_load_dwordx4 v200, s[8:11], s55 offen offset:0 lds
  buffer_load_dwordx4 v201, s[8:11], s55 offen offset:1024 lds
  buffer_load_dwordx4 v202, s[8:11], s55 offen offset:2048 lds
  buffer_load_dwordx4 v203, s[8:11], s55 offen offset:3072 lds
  s_not_b64 exec, s[56:57]
  buffer_load_dwordx4 v200, s[12:15], s55 offen offset:0 lds
  buffer_load_dwordx4 v201, s[12:15], s55 offen offset:1024 lds
  buffer_load_dwordx4 v202, s[12:15], s55 offen offset:2048 lds
  buffer_load_dwordx4 v203, s[12:15], s55 offen offset:3072 lds
  s_mov_b64 exec, -1
  s_add_u32 s55, s50, 0x2d0000
  s_add_u32 m0, s24, 0x1000
  s_mov_b64 exec, s[56:57]
  buffer_load_dwordx4 v200, s[8:11], s55 offen offset:0 lds
  buffer_load_dwordx4 v201, s[8:11], s55 offen offset:1024 lds
  buffer_load_dwordx4 v202, s[8:11], s55 offen offset:2048 lds
  buffer_load_dwordx4 v203, s[8:11], s55 offen offset:3072 lds
  s_not_b64 exec, s[56:57]
  buffer_load_dwordx4 v200, s[12:15], s55 offen offset:0 lds
  buffer_load_dwordx4 v201, s[12:15], s55 offen offset:1024 lds
  buffer_load_dwordx4 v202, s[12:15], s55 offen offset:2048 lds
  buffer_load_dwordx4 v203, s[12:15], s55 offen offset:3072 lds
  s_mov_b64 exec, -1
  s_add_u32 s55, s50, 0x318000
  s_add_u32 m0, s24, 0x2000
  s_mov_b64 exec, s[56:57]
  buffer_load_dwordx4 v200, s[8:11], s55 offen offset:0 lds
  s_not_b64 exec, s[56:57]
  buffer_load_dwordx4 v200, s[12:15], s55 offen offset:0 lds
  s_mov_b64 exec, -1
  s_add_u32 m0, s24, 0x9000
  s_nop 0
  buffer_load_dwordx4 v176, s[8:11], s25 offen offset:0 lds
  buffer_load_dwordx4 v177, s[8:11], s25 offen offset:1024 lds
  buffer_load_dwordx4 v178, s[8:11], s25 offen offset:2048 lds
  buffer_load_dwordx4 v179, s[8:11], s25 offen offset:3072 lds
  s_add_u32 s25, s25, s27
  s_add_u32 m0, s24, 0xa000
  s_nop 0
  buffer_load_dwordx4 v176, s[8:11], s25 offen offset:0 lds
  buffer_load_dwordx4 v177, s[8:11], s25 offen offset:1024 lds
  buffer_load_dwordx4 v178, s[8:11], s25 offen offset:2048 lds
  buffer_load_dwordx4 v179, s[8:11], s25 offen offset:3072 lds
  s_add_u32 s25, s25, s28
  s_add_u32 m0, s24, 0xb000
  s_nop 0
  buffer_load_dwordx4 v176, s[8:11], s25 offen offset:0 lds
  s_add_u32 s25, s25, s29
  s_cmp_lg_u32 s23, 0
  s_cbranch_scc1 m_B_nopf_28
  s_lshl_b32 s68, s22, 2
  s_add_u32 s68, s68, s20
  s_lshr_b32 s69, s21, 2
  s_mul_i32 s70, s68, 82944
  s_mul_i32 s71, s69, 2304
  s_add_u32 s70, s70, s71
  s_mul_i32 s71, s68, 20736
  s_mul_i32 s72, s69, 1327104
  s_add_u32 s71, s71, s72
  s_mov_b32 s84, s40
  s_and_b32 s85, s41, 0xffff
  s_mov_b32 s86, 0x510000
  s_mov_b32 s87, 0x20000
  v_add_u32 v4, 0, v252
  v_min_u32 v4, 161, v4
  v_mul_u32_u24 v5, 3641, v4
  v_lshrrev_b32 v5, 16, v5
  v_lshlrev_b32 v8, 7, v4
  v_mul_u32_u24 v5, 6912, v5
  v_add_u32 v12, v5, v8
  v_add_u32 v4, 64, v252
  v_min_u32 v4, 161, v4
  v_mul_u32_u24 v5, 3641, v4
  v_lshrrev_b32 v5, 16, v5
  v_lshlrev_b32 v9, 7, v4
  v_mul_u32_u24 v5, 6912, v5
  v_add_u32 v13, v5, v9
  v_add_u32 v4, 128, v252
  v_min_u32 v4, 161, v4
  v_mul_u32_u24 v5, 3641, v4
  v_lshrrev_b32 v5, 16, v5
  v_lshlrev_b32 v10, 7, v4
  v_mul_u32_u24 v5, 6912, v5
  v_add_u32 v14, v5, v10
  buffer_load_dword v24, v8, s[84:87], s71 offen
  buffer_load_dword v25, v9, s[84:87], s71 offen
  buffer_load_dword v26, v10, s[84:87], s71 offen
  s_waitcnt vmcnt(12)
  s_branch m_B_nopf_28j
m_B_nopf_28:
  s_waitcnt vmcnt(9)
m_B_nopf_28j:
  s_barrier
m_B_join_24:
  ds_read_b64_tr_b16 a[144:145], v194 offset:12288
  ds_read_b64_tr_b16 a[146:147], v194 offset:14336
  ds_read_b64_tr_b16 a[148:149], v195 offset:12288
  ds_read_b64_tr_b16 a[150:151], v195 offset:14336
  ds_read_b64_tr_b16 a[152:153], v196 offset:12288
  ds_read_b64_tr_b16 a[154:155], v196 offset:14336
  ds_read_b64_tr_b16 a[156:157], v197 offset:12288
  ds_read_b64_tr_b16 a[158:159], v197 offset:14336
  ds_read_b64_tr_b16 a[160:161], v194 offset:16384
  ds_read_b64_tr_b16 a[162:163], v194 offset:18432
  s_lshl_b32 s49, s20, 6
  s_cmp_lg_u32 s20, 0
  s_cbranch_scc1 m_wf_skip_31
  v_lshlrev_b32 v250, 2, v252
  s_add_u32 s62, s60, 0x3c00
  s_movk_i32 s63, 256
  v_add_u32 v250, s63, v250
  s_mov_b32 s64, 0x3f3f3f3f
  v_lshlrev_b32 v250, 2, v250
  s_mov_b32 s65, 0x3f3f3f3f
  s_mov_b64 exec, s[64:65]
  s_mov_b32 s63, 0
m_wf_loop_29:
  buffer_load_dword v246, v250, s[4:7], s62 offen sc1
  s_waitcnt vmcnt(0)
  v_cmp_eq_u32 vcc, s97, v246
  s_cmp_eq_u64 vcc, s[64:65]
  s_cbranch_scc1 m_wf_done_30
  s_add_u32 s63, s63, 1
  s_cmp_lt_u32 s63, 0x30d40
  s_cbranch_scc1 m_wf_loop_29
m_wf_done_30:
  s_mov_b64 exec, -1
m_wf_skip_31:
  s_barrier
  buffer_load_dwordx4 a[0:3], v253, s[4:7], s51 offen offset:0 sc1
  buffer_load_dwordx4 a[72:75], v254, s[4:7], s51 offen offset:0 sc1
  buffer_load_dwordx4 a[4:7], v253, s[4:7], s51 offen offset:1024 sc1
  buffer_load_dwordx4 a[76:79], v254, s[4:7], s51 offen offset:1024 sc1
  buffer_load_dwordx4 a[8:11], v253, s[4:7], s51 offen offset:2048 sc1
  buffer_load_dwordx4 a[80:83], v254, s[4:7], s51 offen offset:2048 sc1
  buffer_load_dwordx4 a[12:15], v253, s[4:7], s51 offen offset:3072 sc1
  buffer_load_dwordx4 a[84:87], v254, s[4:7], s51 offen offset:3072 sc1
  s_add_u32 s51, s51, 4096
  buffer_load_dwordx4 a[16:19], v253, s[4:7], s51 offen offset:0 sc1
  buffer_load_dwordx4 a[88:91], v254, s[4:7], s51 offen offset:0 sc1
  buffer_load_dwordx4 a[20:23], v253, s[4:7], s51 offen offset:1024 sc1
  buffer_load_dwordx4 a[92:95], v254, s[4:7], s51 offen offset:1024 sc1
  s_mov_b64 vcc, -1
  s_waitcnt vmcnt(10)
  s_branch m_C_22_C
m_C_22_g1:
  s_waitcnt lgkmcnt(6)
  v_mfma_f32_16x16x32_bf16 v[32:35], a[144:147], a[0:3], 0
  ds_read_b64_tr_b16 a[164:165], v187 offset:40960
  s_add_u32 m0, s24, 0x0
  v_mfma_f32_16x16x32_bf16 v[36:39], a[144:147], a[72:75], 0
  ds_read_b64_tr_b16 a[166:167], v187 offset:43008
  buffer_load_dwordx4 v176, s[12:15], s26 offen offset:0 lds
  v_mfma_f32_16x16x32_bf16 v[40:43], a[148:151], a[0:3], 0
  ds_read_b64_tr_b16 a[144:145], v188 offset:40960
  v_mfma_f32_16x16x32_bf16 v[44:47], a[148:151], a[72:75], 0
  ds_read_b64_tr_b16 a[146:147], v188 offset:43008
  s_waitcnt lgkmcnt(6)
  v_mfma_f32_16x16x32_bf16 v[48:51], a[152:155], a[0:3], 0
  ds_read_b64_tr_b16 a[148:149], v189 offset:40960
  s_cbranch_vccnz m_C_22_fix
m_C_22_fixr:
  v_mfma_f32_16x16x32_bf16 v[52:55], a[152:155], a[72:75], 0
  ds_read_b64_tr_b16 a[150:151], v189 offset:43008
  v_mul_f32 v0, v0, v64
  v_mfma_f32_16x16x32_bf16 v[56:59], a[156:159], a[0:3], 0
  ds_read_b64_tr_b16 a[152:153], v186 offset:45056
  v_mul_f32 v1, v1, v65
  v_mfma_f32_16x16x32_bf16 v[60:63], a[156:159], a[72:75], 0
  ds_read_b64_tr_b16 a[154:155], v186 offset:47104
  s_waitcnt lgkmcnt(6)
  v_mfma_f32_16x16x32_bf16 v[32:35], a[160:163], a[4:7], v[32:35]
  ds_read_b64_tr_b16 a[156:157], v187 offset:45056
  buffer_load_dwordx4 v177, s[12:15], s26 offen offset:1024 lds
  v_mfma_f32_16x16x32_bf16 v[36:39], a[160:163], a[76:79], v[36:39]
  ds_read_b64_tr_b16 a[158:159], v187 offset:47104
  v_mul_f32 v2, v2, v66
  v_mfma_f32_16x16x32_bf16 v[40:43], a[164:167], a[4:7], v[40:43]
  ds_read_b64_tr_b16 a[160:161], v188 offset:45056
  v_mul_f32 v3, v3, v67
  v_mfma_f32_16x16x32_bf16 v[44:47], a[164:167], a[76:79], v[44:47]
  ds_read_b64_tr_b16 a[162:163], v188 offset:47104
  s_waitcnt lgkmcnt(6)
  v_mfma_f32_16x16x32_bf16 v[48:51], a[144:147], a[4:7], v[48:51]
  ds_read_b64_tr_b16 a[164:165], v189 offset:45056
  v_mul_f32 v4, v4, v68
  v_mfma_f32_16x16x32_bf16 v[52:55], a[144:147], a[76:79], v[52:55]
  ds_read_b64_tr_b16 a[166:167], v189 offset:47104
  v_mul_f32 v5, v5, v69
  v_mfma_f32_16x16x32_bf16 v[56:59], a[148:151], a[4:7], v[56:59]
  ds_read_b64_tr_b16 a[144:145], v190 offset:0
  buffer_load_dwordx4 v178, s[12:15], s26 offen offset:2048 lds
  v_mfma_f32_16x16x32_bf16 v[60:63], a[148:151], a[76:79], v[60:63]
  ds_read_b64_tr_b16 a[146:147], v190 offset:2048
  s_waitcnt lgkmcnt(6)
  v_mfma_f32_16x16x32_bf16 v[32:35], a[152:155], a[8:11], v[32:35]
  ds_read_b64_tr_b16 a[148:149], v191 offset:0
  v_mul_f32 v6, v6, v70
  v_mfma_f32_16x16x32_bf16 v[36:39], a[152:155], a[80:83], v[36:39]
  ds_read_b64_tr_b16 a[150:151], v191 offset:2048
  v_mul_f32 v7, v7, v71
  v_mfma_f32_16x16x32_bf16 v[40:43], a[156:159], a[8:11], v[40:43]
  ds_read_b64_tr_b16 a[152:153], v192 offset:0
  v_mul_f32 v8, v8, v72
  v_mfma_f32_16x16x32_bf16 v[44:47], a[156:159], a[80:83], v[44:47]
  ds_read_b64_tr_b16 a[154:155], v192 offset:2048
  s_waitcnt lgkmcnt(6)
  v_mfma_f32_16x16x32_bf16 v[48:51], a[160:163], a[8:11], v[48:51]
  ds_read_b64_tr_b16 a[156:157], v193 offset:0
  v_mul_f32 v9, v9, v73
  v_mfma_f32_16x16x32_bf16 v[52:55], a[160:163], a[80:83], v[52:55]
  ds_read_b64_tr_b16 a[158:159], v193 offset:2048
  buffer_load_dwordx4 v179, s[12:15], s26 offen offset:3072 lds
  v_mfma_f32_16x16x32_bf16 v[56:59], a[164:167], a[8:11], v[56:59]
  ds_read_b64_tr_b16 a[160:161], v190 offset:4096
  s_add_u32 s26, s26, s27
  v_mfma_f32_16x16x32_bf16 v[60:63], a[164:167], a[80:83], v[60:63]
  ds_read_b64_tr_b16 a[162:163], v190 offset:6144
  s_waitcnt lgkmcnt(6)
  v_mfma_f32_16x16x32_bf16 v[32:35], a[144:147], a[12:15], v[32:35]
  ds_read_b64_tr_b16 a[164:165], v191 offset:4096
  v_mul_f32 v10, v10, v74
  v_mfma_f32_16x16x32_bf16 v[36:39], a[144:147], a[84:87], v[36:39]
  ds_read_b64_tr_b16 a[166:167], v191 offset:6144
  v_mul_f32 v11, v11, v75
  v_mfma_f32_16x16x32_bf16 v[40:43], a[148:151], a[12:15], v[40:43]
  ds_read_b64_tr_b16 a[144:145], v192 offset:4096
  s_add_u32 m0, s24, 0x1000
  v_mfma_f32_16x16x32_bf16 v[44:47], a[148:151], a[84:87], v[44:47]
  ds_read_b64_tr_b16 a[146:147], v192 offset:6144
  s_waitcnt lgkmcnt(6)
  v_mfma_f32_16x16x32_bf16 v[48:51], a[152:155], a[12:15], v[48:51]
  ds_read_b64_tr_b16 a[148:149], v193 offset:4096
  buffer_load_dwordx4 v176, s[12:15], s26 offen offset:0 lds
  v_mfma_f32_16x16x32_bf16 v[52:55], a[152:155], a[84:87], v[52:55]
  ds_read_b64_tr_b16 a[150:151], v193 offset:6144
  v_mul_f32 v12, v12, v76
  v_mfma_f32_16x16x32_bf16 v[56:59], a[156:159], a[12:15], v[56:59]
  ds_read_b64_tr_b16 a[152:153], v190 offset:8192
  v_mul_f32 v13, v13, v77
  v_mfma_f32_16x16x32_bf16 v[60:63], a[156:159], a[84:87], v[60:63]
  ds_read_b64_tr_b16 a[154:155], v190 offset:10240
  s_waitcnt lgkmcnt(6)
  v_mfma_f32_16x16x32_bf16 v[32:35], a[160:163], a[16:19], v[32:35]
  ds_read_b64_tr_b16 a[156:157], v191 offset:8192
  v_mul_f32 v14, v14, v78
  v_mfma_f32_16x16x32_bf16 v[36:39], a[160:163], a[88:91], v[36:39]
  ds_read_b64_tr_b16 a[158:159], v191 offset:10240
  v_mul_f32 v15, v15, v79
  v_mfma_f32_16x16x32_bf16 v[40:43], a[164:167], a[16:19], v[40:43]
  ds_read_b64_tr_b16 a[160:161], v192 offset:8192
  buffer_load_dwordx4 v177, s[12:15], s26 offen offset:1024 lds
  v_mfma_f32_16x16x32_bf16 v[44:47], a[164:167], a[88:91], v[44:47]
  ds_read_b64_tr_b16 a[162:163], v192 offset:10240
  s_waitcnt lgkmcnt(6)
  v_mfma_f32_16x16x32_bf16 v[48:51], a[144:147], a[16:19], v[48:51]
  ds_read_b64_tr_b16 a[164:165], v193 offset:8192
  v_mul_f32 v16, v16, v80
  v_mfma_f32_16x16x32_bf16 v[52:55], a[144:147], a[88:91], v[52:55]
  ds_read_b64_tr_b16 a[166:167], v193 offset:10240
  v_mul_f32 v17, v17, v81
  v_mfma_f32_16x16x32_bf16 v[56:59], a[148:151], a[16:19], v[56:59]
  ds_read_b64_tr_b16 a[144:145], v190 offset:12288
  v_mul_f32 v18, v18, v82
  v_mfma_f32_16x16x32_bf16 v[60:63], a[148:151], a[88:91], v[60:63]
  ds_read_b64_tr_b16 a[146:147], v190 offset:14336
  s_waitcnt lgkmcnt(6)
  v_mfma_f32_16x16x32_bf16 v[32:35], a[152:155], a[20:23], v[32:35]
  ds_read_b64_tr_b16 a[148:149], v191 offset:12288
  v_mul_f32 v19, v19, v83
  v_mfma_f32_16x16x32_bf16 v[36:39], a[152:155], a[92:95], v[36:39]
  ds_read_b64_tr_b16 a[150:151], v191 offset:14336
  buffer_load_dwordx4 v178, s[12:15], s26 offen offset:2048 lds
  v_mfma_f32_16x16x32_bf16 v[40:43], a[156:159], a[20:23], v[40:43]
  ds_read_b64_tr_b16 a[152:153], v192 offset:12288
  v_mul_f32 v20, v20, v84
  v_mfma_f32_16x16x32_bf16 v[44:47], a[156:159], a[92:95], v[44:47]
  ds_read_b64_tr_b16 a[154:155], v192 offset:14336
  s_waitcnt lgkmcnt(6)
  v_mfma_f32_16x16x32_bf16 v[48:51], a[160:163], a[20:23], v[48:51]
  ds_read_b64_tr_b16 a[156:157], v193 offset:12288
  v_mul_f32 v21, v21, v85
  v_mfma_f32_16x16x32_bf16 v[52:55], a[160:163], a[92:95], v[52:55]
  ds_read_b64_tr_b16 a[158:159], v193 offset:14336
  v_mul_f32 v22, v22, v86
  v_mfma_f32_16x16x32_bf16 v[56:59], a[164:167], a[20:23], v[56:59]
  ds_read_b64_tr_b16 a[160:161], v190 offset:16384
  v_mul_f32 v23, v23, v87
  v_mfma_f32_16x16x32_bf16 v[60:63], a[164:167], a[92:95], v[60:63]
  ds_read_b64_tr_b16 a[162:163], v190 offset:18432
  s_waitcnt lgkmcnt(6)
  v_mfma_f32_16x16x32_bf16 v[32:35], a[144:147], a[24:27], v[32:35]
  ds_read_b64_tr_b16 a[164:165], v191 offset:16384
  buffer_load_dwordx4 v179, s[12:15], s26 offen offset:3072 lds
  v_mfma_f32_16x16x32_bf16 v[36:39], a[144:147], a[96:99], v[36:39]
  ds_read_b64_tr_b16 a[166:167], v191 offset:18432
  s_add_u32 s26, s26, s28
  v_mfma_f32_16x16x32_bf16 v[40:43], a[148:151], a[24:27], v[40:43]
  ds_read_b64_tr_b16 a[144:145], v192 offset:16384
  v_mul_f32 v24, v24, v88
  v_mfma_f32_16x16x32_bf16 v[44:47], a[148:151], a[96:99], v[44:47]
  ds_read_b64_tr_b16 a[146:147], v192 offset:18432
  s_waitcnt lgkmcnt(6)
  v_mfma_f32_16x16x32_bf16 v[48:51], a[152:155], a[24:27], v[48:51]
  ds_read_b64_tr_b16 a[148:149], v193 offset:16384
  v_mul_f32 v25, v25, v89
  v_mfma_f32_16x16x32_bf16 v[52:55], a[152:155], a[96:99], v[52:55]
  ds_read_b64_tr_b16 a[150:151], v193 offset:18432
  s_add_u32 m0, s24, 0x2000
  v_mfma_f32_16x16x32_bf16 v[56:59], a[156:159], a[24:27], v[56:59]
  ds_read_b64_tr_b16 a[152:153], v190 offset:20480
  buffer_load_dwordx4 v176, s[12:15], s26 offen offset:0 lds
  v_mfma_f32_16x16x32_bf16 v[60:63], a[156:159], a[96:99], v[60:63]
  ds_read_b64_tr_b16 a[154:155], v190 offset:22528
  s_waitcnt lgkmcnt(6)
  v_mfma_f32_16x16x32_bf16 v[32:35], a[160:163], a[28:31], v[32:35]
  ds_read_b64_tr_b16 a[156:157], v191 offset:20480
  s_add_u32 s26, s26, s30
  v_mfma_f32_16x16x32_bf16 v[36:39], a[160:163], a[100:103], v[36:39]
  ds_read_b64_tr_b16 a[158:159], v191 offset:22528
  v_mul_f32 v26, v26, v90
  v_mfma_f32_16x16x32_bf16 v[40:43], a[164:167], a[28:31], v[40:43]
  ds_read_b64_tr_b16 a[160:161], v192 offset:20480
  v_mul_f32 v27, v27, v91
  v_mfma_f32_16x16x32_bf16 v[44:47], a[164:167], a[100:103], v[44:47]
  ds_read_b64_tr_b16 a[162:163], v192 offset:22528
  s_waitcnt lgkmcnt(6)
  v_mfma_f32_16x16x32_bf16 v[48:51], a[144:147], a[28:31], v[48:51]
  ds_read_b64_tr_b16 a[164:165], v193 offset:20480
  v_mul_f32 v28, v28, v92
  v_mfma_f32_16x16x32_bf16 v[52:55], a[144:147], a[100:103], v[52:55]
  ds_read_b64_tr_b16 a[166:167], v193 offset:22528
  v_mul_f32 v29, v29, v93
  s_waitcnt vmcnt(20)
  s_barrier
  v_mfma_f32_16x16x32_bf16 v[56:59], a[148:151], a[28:31], v[56:59]
  ds_read_b64_tr_b16 a[144:145], v190 offset:24576
  v_mul_f32 v30, v30, v94
  v_mfma_f32_16x16x32_bf16 v[60:63], a[148:151], a[100:103], v[60:63]
  ds_read_b64_tr_b16 a[146:147], v190 offset:26624
  s_waitcnt lgkmcnt(6)
  v_mfma_f32_16x16x32_bf16 v[32:35], a[152:155], a[32:35], v[32:35]
  ds_read_b64_tr_b16 a[148:149], v191 offset:24576
  v_mul_f32 v31, v31, v95
  v_mfma_f32_16x16x32_bf16 v[36:39], a[152:155], a[104:107], v[36:39]
  ds_read_b64_tr_b16 a[150:151], v191 offset:26624
  v_mfma_f32_16x16x32_bf16 v[40:43], a[156:159], a[32:35], v[40:43]
  ds_read_b64_tr_b16 a[152:153], v192 offset:24576
  v_mfma_f32_16x16x32_bf16 v[44:47], a[156:159], a[104:107], v[44:47]
  ds_read_b64_tr_b16 a[154:155], v192 offset:26624
  s_waitcnt lgkmcnt(6)
  v_mfma_f32_16x16x32_bf16 v[48:51], a[160:163], a[32:35], v[48:51]
  ds_read_b64_tr_b16 a[156:157], v193 offset:24576
  v_mfma_f32_16x16x32_bf16 v[52:55], a[160:163], a[104:107], v[52:55]
  ds_read_b64_tr_b16 a[158:159], v193 offset:26624
  v_mfma_f32_16x16x32_bf16 v[56:59], a[164:167], a[32:35], v[56:59]
  ds_read_b64_tr_b16 a[160:161], v190 offset:28672
  v_mfma_f32_16x16x32_bf16 v[60:63], a[164:167], a[104:107], v[60:63]
  ds_read_b64_tr_b16 a[162:163], v190 offset:30720
  s_waitcnt lgkmcnt(6)
  v_mfma_f32_16x16x32_bf16 v[32:35], a[144:147], a[36:39], v[32:35]
  ds_read_b64_tr_b16 a[164:165], v191 offset:28672
  s_cmp_eq_u32 s32, 3
  s_cbranch_scc1 m_C_22_sw
m_C_22_swr:
  v_mfma_f32_16x16x32_bf16 v[36:39], a[144:147], a[108:111], v[36:39]
  ds_read_b64_tr_b16 a[166:167], v191 offset:30720
  s_set_gpr_idx_on s33, 0x8
  v_cvt_pk_bf16_f32 v96, v0, v1
  v_cvt_pk_bf16_f32 v97, v2, v3
  v_cvt_pk_bf16_f32 v98, v8, v9
  v_cvt_pk_bf16_f32 v99, v10, v11
  s_set_gpr_idx_off
  v_mfma_f32_16x16x32_bf16 v[40:43], a[148:151], a[36:39], v[40:43]
  ds_read_b64_tr_b16 a[144:145], v192 offset:28672
  v_mfma_f32_16x16x32_bf16 v[44:47], a[148:151], a[108:111], v[44:47]
  ds_read_b64_tr_b16 a[146:147], v192 offset:30720
  s_waitcnt lgkmcnt(6)
  v_mfma_f32_16x16x32_bf16 v[48:51], a[152:155], a[36:39], v[48:51]
  ds_read_b64_tr_b16 a[148:149], v193 offset:28672
  s_set_gpr_idx_on s33, 0x8
  v_cvt_pk_bf16_f32 v100, v4, v5
  v_cvt_pk_bf16_f32 v101, v6, v7
  v_cvt_pk_bf16_f32 v102, v12, v13
  v_cvt_pk_bf16_f32 v103, v14, v15
  s_set_gpr_idx_off
  v_mfma_f32_16x16x32_bf16 v[52:55], a[152:155], a[108:111], v[52:55]
  ds_read_b64_tr_b16 a[150:151], v193 offset:30720
  v_mfma_f32_16x16x32_bf16 v[56:59], a[156:159], a[36:39], v[56:59]
  ds_read_b64_tr_b16 a[152:153], v190 offset:32768
  s_set_gpr_idx_on s33, 0x8
  v_cvt_pk_bf16_f32 v104, v16, v17
  v_cvt_pk_bf16_f32 v105, v18, v19
  v_cvt_pk_bf16_f32 v106, v24, v25
  v_cvt_pk_bf16_f32 v107, v26, v27
  s_set_gpr_idx_off
  v_mfma_f32_16x16x32_bf16 v[60:63], a[156:159], a[108:111], v[60:63]
  ds_read_b64_tr_b16 a[154:155], v190 offset:34816
  s_waitcnt lgkmcnt(6)
  v_mfma_f32_16x16x32_bf16 v[32:35], a[160:163], a[40:43], v[32:35]
  ds_read_b64_tr_b16 a[156:157], v191 offset:32768
  v_mfma_f32_16x16x32_bf16 v[36:39], a[160:163], a[112:115], v[36:39]
  ds_read_b64_tr_b16 a[158:159], v191 offset:34816
  s_set_gpr_idx_on s33, 0x8
  v_cvt_pk_bf16_f32 v108, v20, v21
  v_cvt_pk_bf16_f32 v109, v22, v23
  v_cvt_pk_bf16_f32 v110, v28, v29
  v_cvt_pk_bf16_f32 v111, v30, v31
  s_set_gpr_idx_off
  v_mfma_f32_16x16x32_bf16 v[40:43], a[164:167], a[40:43], v[40:43]
  ds_read_b64_tr_b16 a[160:161], v192 offset:32768
  v_mfma_f32_16x16x32_bf16 v[44:47], a[164:167], a[112:115], v[44:47]
  ds_read_b64_tr_b16 a[162:163], v192 offset:34816
  s_waitcnt lgkmcnt(6)
  v_mfma_f32_16x16x32_bf16 v[48:51], a[144:147], a[40:43], v[48:51]
  ds_read_b64_tr_b16 a[164:165], v193 offset:32768
  s_add_u32 m0, s24, 0x9000
  v_mfma_f32_16x16x32_bf16 v[52:55], a[144:147], a[112:115], v[52:55]
  ds_read_b64_tr_b16 a[166:167], v193 offset:34816
  buffer_load_dwordx4 v176, s[8:11], s25 offen offset:0 lds
  v_mfma_f32_16x16x32_bf16 v[56:59], a[148:151], a[40:43], v[56:59]
  ds_read_b64_tr_b16 a[144:145], v190 offset:36864
  v_cvt_pk_bf16_f32 v204, v0, v1
  v_mfma_f32_16x16x32_bf16 v[60:63], a[148:151], a[112:115], v[60:63]
  ds_read_b64_tr_b16 a[146:147], v190 offset:38912
  s_waitcnt lgkmcnt(6)
  v_mfma_f32_16x16x32_bf16 v[32:35], a[152:155], a[44:47], v[32:35]
  ds_read_b64_tr_b16 a[148:149], v191 offset:36864
  v_cvt_pk_bf16_f32 v205, v2, v3
  v_mfma_f32_16x16x32_bf16 v[36:39], a[152:155], a[116:119], v[36:39]
  ds_read_b64_tr_b16 a[150:151], v191 offset:38912
  v_cvt_pk_bf16_f32 v206, v8, v9
  v_mfma_f32_16x16x32_bf16 v[40:43], a[156:159], a[44:47], v[40:43]
  ds_read_b64_tr_b16 a[152:153], v192 offset:36864
  buffer_load_dwordx4 v177, s[8:11], s25 offen offset:1024 lds
  v_mfma_f32_16x16x32_bf16 v[44:47], a[156:159], a[116:119], v[44:47]
  ds_read_b64_tr_b16 a[154:155], v192 offset:38912
  s_waitcnt lgkmcnt(6)
  v_mfma_f32_16x16x32_bf16 v[48:51], a[160:163], a[44:47], v[48:51]
  ds_read_b64_tr_b16 a[156:157], v193 offset:36864
  v_cvt_pk_bf16_f32 v207, v10, v11
  v_mfma_f32_16x16x32_bf16 v[52:55], a[160:163], a[116:119], v[52:55]
  ds_read_b64_tr_b16 a[158:159], v193 offset:38912
  buffer_store_dwordx4 v[204:207], v253, s[4:7], s76 offen offset:0 sc1
  v_mfma_f32_16x16x32_bf16 v[56:59], a[164:167], a[44:47], v[56:59]
  ds_read_b64_tr_b16 a[160:161], v190 offset:40960
  v_cvt_pk_bf16_f32 v208, v4, v5
  v_mfma_f32_16x16x32_bf16 v[60:63], a[164:167], a[116:119], v[60:63]
  ds_read_b64_tr_b16 a[162:163], v190 offset:43008
  s_waitcnt lgkmcnt(6)
  v_mfma_f32_16x16x32_bf16 v[32:35], a[144:147], a[48:51], v[32:35]
  ds_read_b64_tr_b16 a[164:165], v191 offset:40960
  buffer_load_dwordx4 v178, s[8:11], s25 offen offset:2048 lds
  v_mfma_f32_16x16x32_bf16 v[36:39], a[144:147], a[120:123], v[36:39]
  ds_read_b64_tr_b16 a[166:167], v191 offset:43008
  v_cvt_pk_bf16_f32 v209, v6, v7
  v_mfma_f32_16x16x32_bf16 v[40:43], a[148:151], a[48:51], v[40:43]
  ds_read_b64_tr_b16 a[144:145], v192 offset:40960
  v_cvt_pk_bf16_f32 v210, v12, v13
  v_mfma_f32_16x16x32_bf16 v[44:47], a[148:151], a[120:123], v[44:47]
  ds_read_b64_tr_b16 a[146:147], v192 offset:43008
  s_waitcnt lgkmcnt(6)
  v_mfma_f32_16x16x32_bf16 v[48:51], a[152:155], a[48:51], v[48:51]
  ds_read_b64_tr_b16 a[148:149], v193 offset:40960
  v_cvt_pk_bf16_f32 v211, v14, v15
  v_mfma_f32_16x16x32_bf16 v[52:55], a[152:155], a[120:123], v[52:55]
  ds_read_b64_tr_b16 a[150:151], v193 offset:43008
  buffer_load_dwordx4 v179, s[8:11], s25 offen offset:3072 lds
  v_mfma_f32_16x16x32_bf16 v[56:59], a[156:159], a[48:51], v[56:59]
  ds_read_b64_tr_b16 a[152:153], v190 offset:45056
  s_add_u32 s25, s25, s27
  v_mfma_f32_16x16x32_bf16 v[60:63], a[156:159], a[120:123], v[60:63]
  ds_read_b64_tr_b16 a[154:155], v190 offset:47104
  s_waitcnt lgkmcnt(6)
  v_mfma_f32_16x16x32_bf16 v[32:35], a[160:163], a[52:55], v[32:35]
  ds_read_b64_tr_b16 a[156:157], v191 offset:45056
  buffer_store_dwordx4 v[208:211], v253, s[4:7], s76 offen offset:1024 sc1
  v_mfma_f32_16x16x32_bf16 v[36:39], a[160:163], a[124:127], v[36:39]
  ds_read_b64_tr_b16 a[158:159], v191 offset:47104
  s_add_u32 m0, s24, 0xa000
  v_mfma_f32_16x16x32_bf16 v[40:43], a[164:167], a[52:55], v[40:43]
  ds_read_b64_tr_b16 a[160:161], v192 offset:45056
  buffer_load_dwordx4 v176, s[8:11], s25 offen offset:0 lds
  v_mfma_f32_16x16x32_bf16 v[44:47], a[164:167], a[124:127], v[44:47]
  ds_read_b64_tr_b16 a[162:163], v192 offset:47104
  s_waitcnt lgkmcnt(6)
  v_mfma_f32_16x16x32_bf16 v[48:51], a[144:147], a[52:55], v[48:51]
  ds_read_b64_tr_b16 a[164:165], v193 offset:45056
  v_cvt_pk_bf16_f32 v212, v16, v17
  v_mfma_f32_16x16x32_bf16 v[52:55], a[144:147], a[124:127], v[52:55]
  ds_read_b64_tr_b16 a[166:167], v193 offset:47104
  v_cvt_pk_bf16_f32 v213, v18, v19
  v_mfma_f32_16x16x32_bf16 v[56:59], a[148:151], a[52:55], v[56:59]
  ds_read_b64_tr_b16 a[144:145], v194 offset:0
  v_cvt_pk_bf16_f32 v214, v24, v25
  v_mfma_f32_16x16x32_bf16 v[60:63], a[148:151], a[124:127], v[60:63]
  ds_read_b64_tr_b16 a[146:147], v194 offset:2048
  s_waitcnt lgkmcnt(6)
  v_mfma_f32_16x16x32_bf16 v[32:35], a[152:155], a[56:59], v[32:35]
  ds_read_b64_tr_b16 a[148:149], v195 offset:0
  buffer_load_dwordx4 v177, s[8:11], s25 offen offset:1024 lds
  v_mfma_f32_16x16x32_bf16 v[36:39], a[152:155], a[128:131], v[36:39]
  ds_read_b64_tr_b16 a[150:151], v195 offset:2048
  v_cvt_pk_bf16_f32 v215, v26, v27
  v_mfma_f32_16x16x32_bf16 v[40:43], a[156:159], a[56:59], v[40:43]
  ds_read_b64_tr_b16 a[152:153], v196 offset:0
  buffer_store_dwordx4 v[212:215], v253, s[4:7], s76 offen offset:2048 sc1
  v_mfma_f32_16x16x32_bf16 v[44:47], a[156:159], a[128:131], v[44:47]
  ds_read_b64_tr_b16 a[154:155], v196 offset:2048
  s_waitcnt lgkmcnt(6)
  v_mfma_f32_16x16x32_bf16 v[48:51], a[160:163], a[56:59], v[48:51]
  ds_read_b64_tr_b16 a[156:157], v197 offset:0
  v_cvt_pk_bf16_f32 v216, v20, v21
  v_mfma_f32_16x16x32_bf16 v[52:55], a[160:163], a[128:131], v[52:55]
  ds_read_b64_tr_b16 a[158:159], v197 offset:2048
  buffer_load_dwordx4 v178, s[8:11], s25 offen offset:2048 lds
  v_mfma_f32_16x16x32_bf16 v[56:59], a[164:167], a[56:59], v[56:59]
  ds_read_b64_tr_b16 a[160:161], v194 offset:4096
  v_cvt_pk_bf16_f32 v217, v22, v23
  v_mfma_f32_16x16x32_bf16 v[60:63], a[164:167], a[128:131], v[60:63]
  ds_read_b64_tr_b16 a[162:163], v194 offset:6144
  s_waitcnt lgkmcnt(6)
  v_mfma_f32_16x16x32_bf16 v[32:35], a[144:147], a[60:63], v[32:35]
  ds_read_b64_tr_b16 a[164:165], v195 offset:4096
  v_cvt_pk_bf16_f32 v218, v28, v29
  v_mfma_f32_16x16x32_bf16 v[36:39], a[144:147], a[132:135], v[36:39]
  ds_read_b64_tr_b16 a[166:167], v195 offset:6144
  v_cvt_pk_bf16_f32 v219, v30, v31
  v_mfma_f32_16x16x32_bf16 v[40:43], a[148:151], a[60:63], v[40:43]
  ds_read_b64_tr_b16 a[144:145], v196 offset:4096
  buffer_load_dwordx4 v179, s[8:11], s25 offen offset:3072 lds
  v_mfma_f32_16x16x32_bf16 v[44:47], a[148:151], a[132:135], v[44:47]
  ds_read_b64_tr_b16 a[146:147], v196 offset:6144
  s_waitcnt lgkmcnt(6)
  v_mfma_f32_16x16x32_bf16 v[48:51], a[152:155], a[60:63], v[48:51]
  ds_read_b64_tr_b16 a[148:149], v197 offset:4096
  s_add_u32 s25, s25, s28
  v_mfma_f32_16x16x32_bf16 v[52:55], a[152:155], a[132:135], v[52:55]
  ds_read_b64_tr_b16 a[150:151], v197 offset:6144
  buffer_store_dwordx4 v[216:219], v253, s[4:7], s76 offen offset:3072 sc1
  v_mfma_f32_16x16x32_bf16 v[56:59], a[156:159], a[60:63], v[56:59]
  ds_read_b64_tr_b16 a[152:153], v194 offset:8192
  s_add_u32 m0, s24, 0xb000
  v_mfma_f32_16x16x32_bf16 v[60:63], a[156:159], a[132:135], v[60:63]
  ds_read_b64_tr_b16 a[154:155], v194 offset:10240
  s_waitcnt lgkmcnt(6)
  v_mfma_f32_16x16x32_bf16 v[32:35], a[160:163], a[64:67], v[32:35]
  ds_read_b64_tr_b16 a[156:157], v195 offset:8192
  buffer_load_dwordx4 v176, s[8:11], s25 offen offset:0 lds
  v_mfma_f32_16x16x32_bf16 v[36:39], a[160:163], a[136:139], v[36:39]
  ds_read_b64_tr_b16 a[158:159], v195 offset:10240
  s_add_u32 s25, s25, s29
  v_mfma_f32_16x16x32_bf16 v[40:43], a[164:167], a[64:67], v[40:43]
  ds_read_b64_tr_b16 a[160:161], v196 offset:8192
  s_add_u32 s33, s33, 16
  v_mfma_f32_16x16x32_bf16 v[44:47], a[164:167], a[136:139], v[44:47]
  ds_read_b64_tr_b16 a[162:163], v196 offset:10240
  s_waitcnt lgkmcnt(6)
  v_mfma_f32_16x16x32_bf16 v[48:51], a[144:147], a[64:67], v[48:51]
  ds_read_b64_tr_b16 a[164:165], v197 offset:8192
  s_add_u32 s76, s76, 4096
  v_mfma_f32_16x16x32_bf16 v[52:55], a[144:147], a[136:139], v[52:55]
  ds_read_b64_tr_b16 a[166:167], v197 offset:10240
  s_waitcnt vmcnt(22)
  s_barrier
  v_mfma_f32_16x16x32_bf16 v[56:59], a[148:151], a[64:67], v[56:59]
  ds_read_b64_tr_b16 a[144:145], v194 offset:12288
  v_mfma_f32_16x16x32_bf16 v[60:63], a[148:151], a[136:139], v[60:63]
  ds_read_b64_tr_b16 a[146:147], v194 offset:14336
  s_waitcnt lgkmcnt(6)
  v_mfma_f32_16x16x32_bf16 v[32:35], a[152:155], a[68:71], v[32:35]
  ds_read_b64_tr_b16 a[148:149], v195 offset:12288
  v_mfma_f32_16x16x32_bf16 v[36:39], a[152:155], a[140:143], v[36:39]
  ds_read_b64_tr_b16 a[150:151], v195 offset:14336
  v_mfma_f32_16x16x32_bf16 v[40:43], a[156:159], a[68:71], v[40:43]
  ds_read_b64_tr_b16 a[152:153], v196 offset:12288
  v_mfma_f32_16x16x32_bf16 v[44:47], a[156:159], a[140:143], v[44:47]
  ds_read_b64_tr_b16 a[154:155], v196 offset:14336
  s_waitcnt lgkmcnt(6)
  v_mfma_f32_16x16x32_bf16 v[48:51], a[160:163], a[68:71], v[48:51]
  ds_read_b64_tr_b16 a[156:157], v197 offset:12288
  v_mfma_f32_16x16x32_bf16 v[52:55], a[160:163], a[140:143], v[52:55]
  ds_read_b64_tr_b16 a[158:159], v197 offset:14336
  v_mfma_f32_16x16x32_bf16 v[56:59], a[164:167], a[68:71], v[56:59]
  ds_read_b64_tr_b16 a[160:161], v194 offset:16384
  v_mfma_f32_16x16x32_bf16 v[60:63], a[164:167], a[140:143], v[60:63]
  ds_read_b64_tr_b16 a[162:163], v194 offset:18432
m_C_22_C:
  s_waitcnt lgkmcnt(6)
  v_mfma_f32_16x16x32_bf16 v[64:67], a[144:147], a[0:3], 0
  ds_read_b64_tr_b16 a[164:165], v195 offset:16384
  s_add_u32 m0, s24, 0x12000
  v_mfma_f32_16x16x32_bf16 v[68:71], a[144:147], a[72:75], 0
  ds_read_b64_tr_b16 a[166:167], v195 offset:18432
  buffer_load_dwordx4 v176, s[8:11], s25 offen offset:0 lds
  v_mfma_f32_16x16x32_bf16 v[72:75], a[148:151], a[0:3], 0
  ds_read_b64_tr_b16 a[144:145], v196 offset:16384
  v_mfma_f32_16x16x32_bf16 v[76:79], a[148:151], a[72:75], 0
  ds_read_b64_tr_b16 a[146:147], v196 offset:18432
  s_waitcnt lgkmcnt(6)
  v_mfma_f32_16x16x32_bf16 v[80:83], a[152:155], a[0:3], 0
  ds_read_b64_tr_b16 a[148:149], v197 offset:16384
  v_mfma_f32_16x16x32_bf16 v[84:87], a[152:155], a[72:75], 0
  ds_read_b64_tr_b16 a[150:151], v197 offset:18432
  v_max_f32 v0, 0, v32
  v_mfma_f32_16x16x32_bf16 v[88:91], a[156:159], a[0:3], 0
  ds_read_b64_tr_b16 a[152:153], v194 offset:20480
  s_cbranch_vccnz m_C_22_sC1
m_C_22_sC1r:
  v_mfma_f32_16x16x32_bf16 v[92:95], a[156:159], a[72:75], 0
  ds_read_b64_tr_b16 a[154:155], v194 offset:22528
  s_waitcnt lgkmcnt(6)
  v_mfma_f32_16x16x32_bf16 v[64:67], a[160:163], a[4:7], v[64:67]
  ds_read_b64_tr_b16 a[156:157], v195 offset:20480
  buffer_load_dwordx4 v177, s[8:11], s25 offen offset:1024 lds
  v_mfma_f32_16x16x32_bf16 v[68:71], a[160:163], a[76:79], v[68:71]
  ds_read_b64_tr_b16 a[158:159], v195 offset:22528
  v_max_f32 v1, 0, v33
  v_mfma_f32_16x16x32_bf16 v[72:75], a[164:167], a[4:7], v[72:75]
  ds_read_b64_tr_b16 a[160:161], v196 offset:20480
  v_max_f32 v2, 0, v34
  v_mfma_f32_16x16x32_bf16 v[76:79], a[164:167], a[76:79], v[76:79]
  ds_read_b64_tr_b16 a[162:163], v196 offset:22528
  s_waitcnt lgkmcnt(6)
  v_mfma_f32_16x16x32_bf16 v[80:83], a[144:147], a[4:7], v[80:83]
  ds_read_b64_tr_b16 a[164:165], v197 offset:20480
  v_max_f32 v3, 0, v35
  v_mfma_f32_16x16x32_bf16 v[84:87], a[144:147], a[76:79], v[84:87]
  ds_read_b64_tr_b16 a[166:167], v197 offset:22528
  v_max_f32 v4, 0, v36
  v_mfma_f32_16x16x32_bf16 v[88:91], a[148:151], a[4:7], v[88:91]
  ds_read_b64_tr_b16 a[144:145], v194 offset:24576
  s_cbranch_vccnz m_C_22_sC2
m_C_22_sC2r:
  buffer_load_dwordx4 v178, s[8:11], s25 offen offset:2048 lds
  v_mfma_f32_16x16x32_bf16 v[92:95], a[148:151], a[76:79], v[92:95]
  ds_read_b64_tr_b16 a[146:147], v194 offset:26624
  s_waitcnt lgkmcnt(6)
  v_mfma_f32_16x16x32_bf16 v[64:67], a[152:155], a[8:11], v[64:67]
  ds_read_b64_tr_b16 a[148:149], v195 offset:24576
  v_max_f32 v5, 0, v37
  v_mfma_f32_16x16x32_bf16 v[68:71], a[152:155], a[80:83], v[68:71]
  ds_read_b64_tr_b16 a[150:151], v195 offset:26624
  v_max_f32 v6, 0, v38
  v_mfma_f32_16x16x32_bf16 v[72:75], a[156:159], a[8:11], v[72:75]
  ds_read_b64_tr_b16 a[152:153], v196 offset:24576
  v_max_f32 v7, 0, v39
  v_mfma_f32_16x16x32_bf16 v[76:79], a[156:159], a[80:83], v[76:79]
  ds_read_b64_tr_b16 a[154:155], v196 offset:26624
  s_waitcnt lgkmcnt(6)
  v_mfma_f32_16x16x32_bf16 v[80:83], a[160:163], a[8:11], v[80:83]
  ds_read_b64_tr_b16 a[156:157], v197 offset:24576
  v_max_f32 v8, 0, v40
  v_mfma_f32_16x16x32_bf16 v[84:87], a[160:163], a[80:83], v[84:87]
  ds_read_b64_tr_b16 a[158:159], v197 offset:26624
  buffer_load_dwordx4 v179, s[8:11], s25 offen offset:3072 lds
  v_mfma_f32_16x16x32_bf16 v[88:91], a[164:167], a[8:11], v[88:91]
  ds_read_b64_tr_b16 a[160:161], v194 offset:28672
  s_cbranch_vccnz m_C_22_sC3
m_C_22_sC3r:
  s_add_u32 s25, s25, s27
  v_mfma_f32_16x16x32_bf16 v[92:95], a[164:167], a[80:83], v[92:95]
  ds_read_b64_tr_b16 a[162:163], v194 offset:30720
  s_waitcnt lgkmcnt(6)
  v_mfma_f32_16x16x32_bf16 v[64:67], a[144:147], a[12:15], v[64:67]
  ds_read_b64_tr_b16 a[164:165], v195 offset:28672
  v_max_f32 v9, 0, v41
  v_mfma_f32_16x16x32_bf16 v[68:71], a[144:147], a[84:87], v[68:71]
  ds_read_b64_tr_b16 a[166:167], v195 offset:30720
  v_max_f32 v10, 0, v42
  v_mfma_f32_16x16x32_bf16 v[72:75], a[148:151], a[12:15], v[72:75]
  ds_read_b64_tr_b16 a[144:145], v196 offset:28672
  s_add_u32 m0, s24, 0x13000
  v_mfma_f32_16x16x32_bf16 v[76:79], a[148:151], a[84:87], v[76:79]
  ds_read_b64_tr_b16 a[146:147], v196 offset:30720
  s_waitcnt lgkmcnt(6)
  v_mfma_f32_16x16x32_bf16 v[80:83], a[152:155], a[12:15], v[80:83]
  ds_read_b64_tr_b16 a[148:149], v197 offset:28672
  buffer_load_dwordx4 v176, s[8:11], s25 offen offset:0 lds
  v_mfma_f32_16x16x32_bf16 v[84:87], a[152:155], a[84:87], v[84:87]
  ds_read_b64_tr_b16 a[150:151], v197 offset:30720
  v_max_f32 v11, 0, v43
  v_mfma_f32_16x16x32_bf16 v[88:91], a[156:159], a[12:15], v[88:91]
  ds_read_b64_tr_b16 a[152:153], v194 offset:32768
  s_cbranch_vccnz m_C_22_sC4
m_C_22_sC4r:
  v_mfma_f32_16x16x32_bf16 v[92:95], a[156:159], a[84:87], v[92:95]
  ds_read_b64_tr_b16 a[154:155], v194 offset:34816
  s_waitcnt lgkmcnt(6)
  v_mfma_f32_16x16x32_bf16 v[64:67], a[160:163], a[16:19], v[64:67]
  ds_read_b64_tr_b16 a[156:157], v195 offset:32768
  v_max_f32 v12, 0, v44
  v_mfma_f32_16x16x32_bf16 v[68:71], a[160:163], a[88:91], v[68:71]
  ds_read_b64_tr_b16 a[158:159], v195 offset:34816
  v_max_f32 v13, 0, v45
  v_mfma_f32_16x16x32_bf16 v[72:75], a[164:167], a[16:19], v[72:75]
  ds_read_b64_tr_b16 a[160:161], v196 offset:32768
  buffer_load_dwordx4 v177, s[8:11], s25 offen offset:1024 lds
  v_mfma_f32_16x16x32_bf16 v[76:79], a[164:167], a[88:91], v[76:79]
  ds_read_b64_tr_b16 a[162:163], v196 offset:34816
  s_waitcnt lgkmcnt(6)
  v_mfma_f32_16x16x32_bf16 v[80:83], a[144:147], a[16:19], v[80:83]
  ds_read_b64_tr_b16 a[164:165], v197 offset:32768
  v_mfma_f32_16x16x32_bf16 v[84:87], a[144:147], a[88:91], v[84:87]
  ds_read_b64_tr_b16 a[166:167], v197 offset:34816
  v_mfma_f32_16x16x32_bf16 v[88:91], a[148:151], a[16:19], v[88:91]
  ds_read_b64_tr_b16 a[144:145], v194 offset:36864
  s_cbranch_vccnz m_C_22_sC5
m_C_22_sC5r:
  v_mfma_f32_16x16x32_bf16 v[92:95], a[148:151], a[88:91], v[92:95]
  ds_read_b64_tr_b16 a[146:147], v194 offset:38912
  s_waitcnt lgkmcnt(6)
  v_mfma_f32_16x16x32_bf16 v[64:67], a[152:155], a[20:23], v[64:67]
  ds_read_b64_tr_b16 a[148:149], v195 offset:36864
  v_mfma_f32_16x16x32_bf16 v[68:71], a[152:155], a[92:95], v[68:71]
  ds_read_b64_tr_b16 a[150:151], v195 offset:38912
  buffer_load_dwordx4 v178, s[8:11], s25 offen offset:2048 lds
  v_mfma_f32_16x16x32_bf16 v[72:75], a[156:159], a[20:23], v[72:75]
  ds_read_b64_tr_b16 a[152:153], v196 offset:36864
  v_mfma_f32_16x16x32_bf16 v[76:79], a[156:159], a[92:95], v[76:79]
  ds_read_b64_tr_b16 a[154:155], v196 offset:38912
  s_waitcnt lgkmcnt(6)
  v_mfma_f32_16x16x32_bf16 v[80:83], a[160:163], a[20:23], v[80:83]
  ds_read_b64_tr_b16 a[156:157], v197 offset:36864
  v_mfma_f32_16x16x32_bf16 v[84:87], a[160:163], a[92:95], v[84:87]
  ds_read_b64_tr_b16 a[158:159], v197 offset:38912
  v_mfma_f32_16x16x32_bf16 v[88:91], a[164:167], a[20:23], v[88:91]
  ds_read_b64_tr_b16 a[160:161], v194 offset:40960
  s_cbranch_vccnz m_C_22_sC6
m_C_22_sC6r:
  v_mfma_f32_16x16x32_bf16 v[92:95], a[164:167], a[92:95], v[92:95]
  ds_read_b64_tr_b16 a[162:163], v194 offset:43008
  s_waitcnt lgkmcnt(6)
  v_mfma_f32_16x16x32_bf16 v[64:67], a[144:147], a[24:27], v[64:67]
  ds_read_b64_tr_b16 a[164:165], v195 offset:40960
  buffer_load_dwordx4 v179, s[8:11], s25 offen offset:3072 lds
  v_mfma_f32_16x16x32_bf16 v[68:71], a[144:147], a[96:99], v[68:71]
  ds_read_b64_tr_b16 a[166:167], v195 offset:43008
  s_add_u32 s25, s25, s28
  v_mfma_f32_16x16x32_bf16 v[72:75], a[148:151], a[24:27], v[72:75]
  ds_read_b64_tr_b16 a[144:145], v196 offset:40960
  v_mfma_f32_16x16x32_bf16 v[76:79], a[148:151], a[96:99], v[76:79]
  ds_read_b64_tr_b16 a[146:147], v196 offset:43008
  s_waitcnt lgkmcnt(6)
  v_mfma_f32_16x16x32_bf16 v[80:83], a[152:155], a[24:27], v[80:83]
  ds_read_b64_tr_b16 a[148:149], v197 offset:40960
  v_mfma_f32_16x16x32_bf16 v[84:87], a[152:155], a[96:99], v[84:87]
  ds_read_b64_tr_b16 a[150:151], v197 offset:43008
  s_add_u32 m0, s24, 0x14000
  v_mfma_f32_16x16x32_bf16 v[88:91], a[156:159], a[24:27], v[88:91]
  ds_read_b64_tr_b16 a[152:153], v194 offset:45056
  s_cbranch_vccnz m_C_22_sC7
m_C_22_sC7r:
  buffer_load_dwordx4 v176, s[8:11], s25 offen offset:0 lds
  v_mfma_f32_16x16x32_bf16 v[92:95], a[156:159], a[96:99], v[92:95]
  ds_read_b64_tr_b16 a[154:155], v194 offset:47104
  s_waitcnt lgkmcnt(6)
  v_mfma_f32_16x16x32_bf16 v[64:67], a[160:163], a[28:31], v[64:67]
  ds_read_b64_tr_b16 a[156:157], v195 offset:45056
  s_add_u32 s25, s25, s30
  v_mfma_f32_16x16x32_bf16 v[68:71], a[160:163], a[100:103], v[68:71]
  ds_read_b64_tr_b16 a[158:159], v195 offset:47104
  v_mfma_f32_16x16x32_bf16 v[72:75], a[164:167], a[28:31], v[72:75]
  ds_read_b64_tr_b16 a[160:161], v196 offset:45056
  v_mfma_f32_16x16x32_bf16 v[76:79], a[164:167], a[100:103], v[76:79]
  ds_read_b64_tr_b16 a[162:163], v196 offset:47104
  s_waitcnt lgkmcnt(6)
  v_mfma_f32_16x16x32_bf16 v[80:83], a[144:147], a[28:31], v[80:83]
  ds_read_b64_tr_b16 a[164:165], v197 offset:45056
  v_mfma_f32_16x16x32_bf16 v[84:87], a[144:147], a[100:103], v[84:87]
  ds_read_b64_tr_b16 a[166:167], v197 offset:47104
  s_cbranch_vccnz m_C_22_bC
  s_waitcnt vmcnt(22)
m_C_22_bCr:
  s_barrier
  v_mfma_f32_16x16x32_bf16 v[88:91], a[148:151], a[28:31], v[88:91]
  ds_read_b64_tr_b16 a[144:145], v186 offset:0
  s_cbranch_vccnz m_C_22_sC8
m_C_22_sC8r:
  v_mfma_f32_16x16x32_bf16 v[92:95], a[148:151], a[100:103], v[92:95]
  ds_read_b64_tr_b16 a[146:147], v186 offset:2048
  s_waitcnt lgkmcnt(6)
  v_mfma_f32_16x16x32_bf16 v[64:67], a[152:155], a[32:35], v[64:67]
  ds_read_b64_tr_b16 a[148:149], v187 offset:0
  v_mfma_f32_16x16x32_bf16 v[68:71], a[152:155], a[104:107], v[68:71]
  ds_read_b64_tr_b16 a[150:151], v187 offset:2048
  v_mfma_f32_16x16x32_bf16 v[72:75], a[156:159], a[32:35], v[72:75]
  ds_read_b64_tr_b16 a[152:153], v188 offset:0
  v_mfma_f32_16x16x32_bf16 v[76:79], a[156:159], a[104:107], v[76:79]
  ds_read_b64_tr_b16 a[154:155], v188 offset:2048
  s_waitcnt lgkmcnt(6)
  v_mfma_f32_16x16x32_bf16 v[80:83], a[160:163], a[32:35], v[80:83]
  ds_read_b64_tr_b16 a[156:157], v189 offset:0
  v_mfma_f32_16x16x32_bf16 v[84:87], a[160:163], a[104:107], v[84:87]
  ds_read_b64_tr_b16 a[158:159], v189 offset:2048
  v_mfma_f32_16x16x32_bf16 v[88:91], a[164:167], a[32:35], v[88:91]
  ds_read_b64_tr_b16 a[160:161], v186 offset:4096
  s_cbranch_vccnz m_C_22_sC9
m_C_22_sC9r:
  v_mfma_f32_16x16x32_bf16 v[92:95], a[164:167], a[104:107], v[92:95]
  ds_read_b64_tr_b16 a[162:163], v186 offset:6144
  s_waitcnt lgkmcnt(6)
  v_mfma_f32_16x16x32_bf16 v[64:67], a[144:147], a[36:39], v[64:67]
  ds_read_b64_tr_b16 a[164:165], v187 offset:4096
  buffer_load_dword v241, v240, s[4:7], s81 offen sc1
  s_add_u32 m0, s24, 0x1b000
  v_mfma_f32_16x16x32_bf16 v[68:71], a[144:147], a[108:111], v[68:71]
  ds_read_b64_tr_b16 a[166:167], v187 offset:6144
  buffer_load_dwordx4 v176, s[12:15], s26 offen offset:0 lds
  v_mfma_f32_16x16x32_bf16 v[72:75], a[148:151], a[36:39], v[72:75]
  ds_read_b64_tr_b16 a[144:145], v188 offset:4096
  v_max_f32 v14, 0, v46
  v_mfma_f32_16x16x32_bf16 v[76:79], a[148:151], a[108:111], v[76:79]
  ds_read_b64_tr_b16 a[146:147], v188 offset:6144
  s_waitcnt lgkmcnt(6)
  v_mfma_f32_16x16x32_bf16 v[80:83], a[152:155], a[36:39], v[80:83]
  ds_read_b64_tr_b16 a[148:149], v189 offset:4096
  v_max_f32 v15, 0, v47
  v_mfma_f32_16x16x32_bf16 v[84:87], a[152:155], a[108:111], v[84:87]
  ds_read_b64_tr_b16 a[150:151], v189 offset:6144
  v_max_f32 v16, 0, v48
  v_mfma_f32_16x16x32_bf16 v[88:91], a[156:159], a[36:39], v[88:91]
  ds_read_b64_tr_b16 a[152:153], v186 offset:8192
  s_cbranch_vccnz m_C_22_sD1
m_C_22_sD1r:
  v_mfma_f32_16x16x32_bf16 v[92:95], a[156:159], a[108:111], v[92:95]
  ds_read_b64_tr_b16 a[154:155], v186 offset:10240
  s_waitcnt lgkmcnt(6)
  v_mfma_f32_16x16x32_bf16 v[64:67], a[160:163], a[40:43], v[64:67]
  ds_read_b64_tr_b16 a[156:157], v187 offset:8192
  buffer_load_dwordx4 v177, s[12:15], s26 offen offset:1024 lds
  v_mfma_f32_16x16x32_bf16 v[68:71], a[160:163], a[112:115], v[68:71]
  ds_read_b64_tr_b16 a[158:159], v187 offset:10240
  v_max_f32 v17, 0, v49
  v_mfma_f32_16x16x32_bf16 v[72:75], a[164:167], a[40:43], v[72:75]
  ds_read_b64_tr_b16 a[160:161], v188 offset:8192
  v_max_f32 v18, 0, v50
  v_mfma_f32_16x16x32_bf16 v[76:79], a[164:167], a[112:115], v[76:79]
  ds_read_b64_tr_b16 a[162:163], v188 offset:10240
  s_waitcnt lgkmcnt(6)
  v_mfma_f32_16x16x32_bf16 v[80:83], a[144:147], a[40:43], v[80:83]
  ds_read_b64_tr_b16 a[164:165], v189 offset:8192
  v_max_f32 v19, 0, v51
  v_mfma_f32_16x16x32_bf16 v[84:87], a[144:147], a[112:115], v[84:87]
  ds_read_b64_tr_b16 a[166:167], v189 offset:10240
  v_max_f32 v20, 0, v52
  v_mfma_f32_16x16x32_bf16 v[88:91], a[148:151], a[40:43], v[88:91]
  ds_read_b64_tr_b16 a[144:145], v186 offset:12288
  s_cbranch_vccnz m_C_22_sD2
m_C_22_sD2r:
  buffer_load_dwordx4 v178, s[12:15], s26 offen offset:2048 lds
  v_mfma_f32_16x16x32_bf16 v[92:95], a[148:151], a[112:115], v[92:95]
  ds_read_b64_tr_b16 a[146:147], v186 offset:14336
  s_waitcnt lgkmcnt(6)
  v_mfma_f32_16x16x32_bf16 v[64:67], a[152:155], a[44:47], v[64:67]
  ds_read_b64_tr_b16 a[148:149], v187 offset:12288
  v_max_f32 v21, 0, v53
  v_mfma_f32_16x16x32_bf16 v[68:71], a[152:155], a[116:119], v[68:71]
  ds_read_b64_tr_b16 a[150:151], v187 offset:14336
  v_max_f32 v22, 0, v54
  v_mfma_f32_16x16x32_bf16 v[72:75], a[156:159], a[44:47], v[72:75]
  ds_read_b64_tr_b16 a[152:153], v188 offset:12288
  v_max_f32 v23, 0, v55
  v_mfma_f32_16x16x32_bf16 v[76:79], a[156:159], a[116:119], v[76:79]
  ds_read_b64_tr_b16 a[154:155], v188 offset:14336
  s_waitcnt lgkmcnt(6)
  v_mfma_f32_16x16x32_bf16 v[80:83], a[160:163], a[44:47], v[80:83]
  ds_read_b64_tr_b16 a[156:157], v189 offset:12288
  v_max_f32 v24, 0, v56
  v_mfma_f32_16x16x32_bf16 v[84:87], a[160:163], a[116:119], v[84:87]
  ds_read_b64_tr_b16 a[158:159], v189 offset:14336
  buffer_load_dwordx4 v179, s[12:15], s26 offen offset:3072 lds
  v_mfma_f32_16x16x32_bf16 v[88:91], a[164:167], a[44:47], v[88:91]
  ds_read_b64_tr_b16 a[160:161], v186 offset:16384
  s_cbranch_vccnz m_C_22_sD3
m_C_22_sD3r:
  s_add_u32 s26, s26, s27
  v_mfma_f32_16x16x32_bf16 v[92:95], a[164:167], a[116:119], v[92:95]
  ds_read_b64_tr_b16 a[162:163], v186 offset:18432
  s_waitcnt lgkmcnt(6)
  v_mfma_f32_16x16x32_bf16 v[64:67], a[144:147], a[48:51], v[64:67]
  ds_read_b64_tr_b16 a[164:165], v187 offset:16384
  v_max_f32 v25, 0, v57
  v_mfma_f32_16x16x32_bf16 v[68:71], a[144:147], a[120:123], v[68:71]
  ds_read_b64_tr_b16 a[166:167], v187 offset:18432
  v_max_f32 v26, 0, v58
  v_mfma_f32_16x16x32_bf16 v[72:75], a[148:151], a[48:51], v[72:75]
  ds_read_b64_tr_b16 a[144:145], v188 offset:16384
  s_add_u32 m0, s24, 0x1c000
  v_mfma_f32_16x16x32_bf16 v[76:79], a[148:151], a[120:123], v[76:79]
  ds_read_b64_tr_b16 a[146:147], v188 offset:18432
  s_waitcnt lgkmcnt(6)
  v_mfma_f32_16x16x32_bf16 v[80:83], a[152:155], a[48:51], v[80:83]
  ds_read_b64_tr_b16 a[148:149], v189 offset:16384
  buffer_load_dwordx4 v176, s[12:15], s26 offen offset:0 lds
  v_mfma_f32_16x16x32_bf16 v[84:87], a[152:155], a[120:123], v[84:87]
  ds_read_b64_tr_b16 a[150:151], v189 offset:18432
  v_max_f32 v27, 0, v59
  v_mfma_f32_16x16x32_bf16 v[88:91], a[156:159], a[48:51], v[88:91]
  ds_read_b64_tr_b16 a[152:153], v186 offset:20480
  s_cbranch_vccnz m_C_22_sD4
m_C_22_sD4r:
  v_mfma_f32_16x16x32_bf16 v[92:95], a[156:159], a[120:123], v[92:95]
  ds_read_b64_tr_b16 a[154:155], v186 offset:22528
  s_waitcnt lgkmcnt(6)
  v_mfma_f32_16x16x32_bf16 v[64:67], a[160:163], a[52:55], v[64:67]
  ds_read_b64_tr_b16 a[156:157], v187 offset:20480
  v_max_f32 v28, 0, v60
  v_mfma_f32_16x16x32_bf16 v[68:71], a[160:163], a[124:127], v[68:71]
  ds_read_b64_tr_b16 a[158:159], v187 offset:22528
  v_max_f32 v29, 0, v61
  v_mfma_f32_16x16x32_bf16 v[72:75], a[164:167], a[52:55], v[72:75]
  ds_read_b64_tr_b16 a[160:161], v188 offset:20480
  buffer_load_dwordx4 v177, s[12:15], s26 offen offset:1024 lds
  v_mfma_f32_16x16x32_bf16 v[76:79], a[164:167], a[124:127], v[76:79]
  ds_read_b64_tr_b16 a[162:163], v188 offset:22528
  s_waitcnt lgkmcnt(6)
  v_mfma_f32_16x16x32_bf16 v[80:83], a[144:147], a[52:55], v[80:83]
  ds_read_b64_tr_b16 a[164:165], v189 offset:20480
  v_max_f32 v30, 0, v62
  v_mfma_f32_16x16x32_bf16 v[84:87], a[144:147], a[124:127], v[84:87]
  ds_read_b64_tr_b16 a[166:167], v189 offset:22528
  v_max_f32 v31, 0, v63
  v_mfma_f32_16x16x32_bf16 v[88:91], a[148:151], a[52:55], v[88:91]
  ds_read_b64_tr_b16 a[144:145], v186 offset:24576
  s_cbranch_vccnz m_C_22_sD5
m_C_22_sD5r:
  v_mfma_f32_16x16x32_bf16 v[92:95], a[148:151], a[124:127], v[92:95]
  ds_read_b64_tr_b16 a[146:147], v186 offset:26624
  s_waitcnt lgkmcnt(6)
  v_mfma_f32_16x16x32_bf16 v[64:67], a[152:155], a[56:59], v[64:67]
  ds_read_b64_tr_b16 a[148:149], v187 offset:24576
  v_mfma_f32_16x16x32_bf16 v[68:71], a[152:155], a[128:131], v[68:71]
  ds_read_b64_tr_b16 a[150:151], v187 offset:26624
  buffer_load_dwordx4 v178, s[12:15], s26 offen offset:2048 lds
  v_mfma_f32_16x16x32_bf16 v[72:75], a[156:159], a[56:59], v[72:75]
  ds_read_b64_tr_b16 a[152:153], v188 offset:24576
  v_mfma_f32_16x16x32_bf16 v[76:79], a[156:159], a[128:131], v[76:79]
  ds_read_b64_tr_b16 a[154:155], v188 offset:26624
  s_waitcnt lgkmcnt(6)
  v_mfma_f32_16x16x32_bf16 v[80:83], a[160:163], a[56:59], v[80:83]
  ds_read_b64_tr_b16 a[156:157], v189 offset:24576
  v_mfma_f32_16x16x32_bf16 v[84:87], a[160:163], a[128:131], v[84:87]
  ds_read_b64_tr_b16 a[158:159], v189 offset:26624
  v_mfma_f32_16x16x32_bf16 v[88:91], a[164:167], a[56:59], v[88:91]
  ds_read_b64_tr_b16 a[160:161], v186 offset:28672
  s_cbranch_vccnz m_C_22_sD6
m_C_22_sD6r:
  v_mfma_f32_16x16x32_bf16 v[92:95], a[164:167], a[128:131], v[92:95]
  ds_read_b64_tr_b16 a[162:163], v186 offset:30720
  s_waitcnt lgkmcnt(6)
  v_mfma_f32_16x16x32_bf16 v[64:67], a[144:147], a[60:63], v[64:67]
  ds_read_b64_tr_b16 a[164:165], v187 offset:28672
  buffer_load_dwordx4 v179, s[12:15], s26 offen offset:3072 lds
  v_mfma_f32_16x16x32_bf16 v[68:71], a[144:147], a[132:135], v[68:71]
  ds_read_b64_tr_b16 a[166:167], v187 offset:30720
  s_add_u32 s26, s26, s28
  v_mfma_f32_16x16x32_bf16 v[72:75], a[148:151], a[60:63], v[72:75]
  ds_read_b64_tr_b16 a[144:145], v188 offset:28672
  v_mfma_f32_16x16x32_bf16 v[76:79], a[148:151], a[132:135], v[76:79]
  ds_read_b64_tr_b16 a[146:147], v188 offset:30720
  s_waitcnt lgkmcnt(6)
  v_mfma_f32_16x16x32_bf16 v[80:83], a[152:155], a[60:63], v[80:83]
  ds_read_b64_tr_b16 a[148:149], v189 offset:28672
  v_mfma_f32_16x16x32_bf16 v[84:87], a[152:155], a[132:135], v[84:87]
  ds_read_b64_tr_b16 a[150:151], v189 offset:30720
  s_add_u32 m0, s24, 0x1d000
  v_mfma_f32_16x16x32_bf16 v[88:91], a[156:159], a[60:63], v[88:91]
  ds_read_b64_tr_b16 a[152:153], v186 offset:32768
  s_cbranch_vccnz m_C_22_sD7
m_C_22_sD7r:
  buffer_load_dwordx4 v176, s[12:15], s26 offen offset:0 lds
  v_mfma_f32_16x16x32_bf16 v[92:95], a[156:159], a[132:135], v[92:95]
  ds_read_b64_tr_b16 a[154:155], v186 offset:34816
  s_waitcnt lgkmcnt(6)
  v_mfma_f32_16x16x32_bf16 v[64:67], a[160:163], a[64:67], v[64:67]
  ds_read_b64_tr_b16 a[156:157], v187 offset:32768
  s_add_u32 s26, s26, s29
  v_mfma_f32_16x16x32_bf16 v[68:71], a[160:163], a[136:139], v[68:71]
  ds_read_b64_tr_b16 a[158:159], v187 offset:34816
  v_mfma_f32_16x16x32_bf16 v[72:75], a[164:167], a[64:67], v[72:75]
  ds_read_b64_tr_b16 a[160:161], v188 offset:32768
  v_mfma_f32_16x16x32_bf16 v[76:79], a[164:167], a[136:139], v[76:79]
  ds_read_b64_tr_b16 a[162:163], v188 offset:34816
  s_waitcnt lgkmcnt(6)
  v_mfma_f32_16x16x32_bf16 v[80:83], a[144:147], a[64:67], v[80:83]
  ds_read_b64_tr_b16 a[164:165], v189 offset:32768
  v_mfma_f32_16x16x32_bf16 v[84:87], a[144:147], a[136:139], v[84:87]
  ds_read_b64_tr_b16 a[166:167], v189 offset:34816
  s_cbranch_vccnz m_C_22_bD
  s_waitcnt vmcnt(19)
m_C_22_bDr:
  s_barrier
  v_mfma_f32_16x16x32_bf16 v[88:91], a[148:151], a[64:67], v[88:91]
  ds_read_b64_tr_b16 a[144:145], v186 offset:36864
  s_cbranch_vccnz m_C_22_sD8
m_C_22_sD8r:
  buffer_store_dword v242, v240, s[4:7], s80 offen sc1
  v_mfma_f32_16x16x32_bf16 v[92:95], a[148:151], a[136:139], v[92:95]
  ds_read_b64_tr_b16 a[146:147], v186 offset:38912
  s_waitcnt lgkmcnt(6)
  v_mfma_f32_16x16x32_bf16 v[64:67], a[152:155], a[68:71], v[64:67]
  ds_read_b64_tr_b16 a[148:149], v187 offset:36864
  v_mfma_f32_16x16x32_bf16 v[68:71], a[152:155], a[140:143], v[68:71]
  ds_read_b64_tr_b16 a[150:151], v187 offset:38912
  v_add_u32 v242, 1, v242
  v_mfma_f32_16x16x32_bf16 v[72:75], a[156:159], a[68:71], v[72:75]
  ds_read_b64_tr_b16 a[152:153], v188 offset:36864
  v_mfma_f32_16x16x32_bf16 v[76:79], a[156:159], a[140:143], v[76:79]
  ds_read_b64_tr_b16 a[154:155], v188 offset:38912
  s_waitcnt lgkmcnt(6)
  v_mfma_f32_16x16x32_bf16 v[80:83], a[160:163], a[68:71], v[80:83]
  ds_read_b64_tr_b16 a[156:157], v189 offset:36864
  v_mfma_f32_16x16x32_bf16 v[84:87], a[160:163], a[140:143], v[84:87]
  ds_read_b64_tr_b16 a[158:159], v189 offset:38912
  s_add_u32 s32, s32, 1
  v_mfma_f32_16x16x32_bf16 v[88:91], a[164:167], a[68:71], v[88:91]
  ds_read_b64_tr_b16 a[160:161], v186 offset:40960
  s_cmp_lt_u32 s32, 4
  v_mfma_f32_16x16x32_bf16 v[92:95], a[164:167], a[140:143], v[92:95]
  ds_read_b64_tr_b16 a[162:163], v186 offset:43008
  s_cbranch_scc1 m_C_22_g1
  s_waitcnt lgkmcnt(6)
  v_mfma_f32_16x16x32_bf16 v[32:35], a[144:147], v[104:107], 0
  ds_read_b64_tr_b16 a[164:165], v187 offset:40960
  v_mfma_f32_16x16x32_bf16 v[36:39], a[144:147], v[108:111], 0
  ds_read_b64_tr_b16 a[166:167], v187 offset:43008
  v_mfma_f32_16x16x32_bf16 v[40:43], a[148:151], v[104:107], 0
  ds_read_b64_tr_b16 a[144:145], v188 offset:40960
  v_mul_f32 v0, v0, v64
  v_mul_f32 v1, v1, v65
  v_mfma_f32_16x16x32_bf16 v[44:47], a[148:151], v[108:111], 0
  ds_read_b64_tr_b16 a[146:147], v188 offset:43008
  s_waitcnt lgkmcnt(6)
  v_mfma_f32_16x16x32_bf16 v[48:51], a[152:155], v[104:107], 0
  ds_read_b64_tr_b16 a[148:149], v189 offset:40960
  v_mul_f32 v2, v2, v66
  v_mul_f32 v3, v3, v67
  v_mfma_f32_16x16x32_bf16 v[52:55], a[152:155], v[108:111], 0
  ds_read_b64_tr_b16 a[150:151], v189 offset:43008
  v_mul_f32 v4, v4, v68
  v_mul_f32 v5, v5, v69
  v_mfma_f32_16x16x32_bf16 v[56:59], a[156:159], v[104:107], 0
  ds_read_b64_tr_b16 a[152:153], v186 offset:45056
  v_mul_f32 v6, v6, v70
  v_mul_f32 v7, v7, v71
  v_mfma_f32_16x16x32_bf16 v[60:63], a[156:159], v[108:111], 0
  ds_read_b64_tr_b16 a[154:155], v186 offset:47104
  s_waitcnt lgkmcnt(6)
  v_mfma_f32_16x16x32_bf16 v[32:35], a[160:163], v[112:115], v[32:35]
  ds_read_b64_tr_b16 a[156:157], v187 offset:45056
  v_mul_f32 v8, v8, v72
  v_mul_f32 v9, v9, v73
  v_mfma_f32_16x16x32_bf16 v[36:39], a[160:163], v[116:119], v[36:39]
  ds_read_b64_tr_b16 a[158:159], v187 offset:47104
  v_mul_f32 v10, v10, v74
  v_mul_f32 v11, v11, v75
  v_mfma_f32_16x16x32_bf16 v[40:43], a[164:167], v[112:115], v[40:43]
  ds_read_b64_tr_b16 a[160:161], v188 offset:45056
  v_mul_f32 v12, v12, v76
  v_mul_f32 v13, v13, v77
  v_mfma_f32_16x16x32_bf16 v[44:47], a[164:167], v[116:119], v[44:47]
  ds_read_b64_tr_b16 a[162:163], v188 offset:47104
  s_waitcnt lgkmcnt(6)
  v_mfma_f32_16x16x32_bf16 v[48:51], a[144:147], v[112:115], v[48:51]
  ds_read_b64_tr_b16 a[164:165], v189 offset:45056
  v_mul_f32 v14, v14, v78
  v_mul_f32 v15, v15, v79
  v_mfma_f32_16x16x32_bf16 v[52:55], a[144:147], v[116:119], v[52:55]
  ds_read_b64_tr_b16 a[166:167], v189 offset:47104
  v_mul_f32 v16, v16, v80
  v_mul_f32 v17, v17, v81
  v_mfma_f32_16x16x32_bf16 v[56:59], a[148:151], v[112:115], v[56:59]
  ds_read_b64_tr_b16 a[144:145], v190 offset:0
  v_mul_f32 v18, v18, v82
  v_mul_f32 v19, v19, v83
  v_mfma_f32_16x16x32_bf16 v[60:63], a[148:151], v[116:119], v[60:63]
  ds_read_b64_tr_b16 a[146:147], v190 offset:2048
  s_waitcnt lgkmcnt(6)
  v_mfma_f32_16x16x32_bf16 v[32:35], a[152:155], v[120:123], v[32:35]
  ds_read_b64_tr_b16 a[148:149], v191 offset:0
  v_mul_f32 v20, v20, v84
  v_mul_f32 v21, v21, v85
  v_mfma_f32_16x16x32_bf16 v[36:39], a[152:155], v[124:127], v[36:39]
  ds_read_b64_tr_b16 a[150:151], v191 offset:2048
  v_mul_f32 v22, v22, v86
  v_mul_f32 v23, v23, v87
  v_mfma_f32_16x16x32_bf16 v[40:43], a[156:159], v[120:123], v[40:43]
  ds_read_b64_tr_b16 a[152:153], v192 offset:0
  v_mul_f32 v24, v24, v88
  v_mul_f32 v25, v25, v89
  v_mfma_f32_16x16x32_bf16 v[44:47], a[156:159], v[124:127], v[44:47]
  ds_read_b64_tr_b16 a[154:155], v192 offset:2048
  s_waitcnt lgkmcnt(6)
  v_mfma_f32_16x16x32_bf16 v[48:51], a[160:163], v[120:123], v[48:51]
  ds_read_b64_tr_b16 a[156:157], v193 offset:0
  v_mul_f32 v26, v26, v90
  v_mul_f32 v27, v27, v91
  v_mfma_f32_16x16x32_bf16 v[52:55], a[160:163], v[124:127], v[52:55]
  ds_read_b64_tr_b16 a[158:159], v193 offset:2048
  v_mul_f32 v28, v28, v92
  v_mul_f32 v29, v29, v93
  v_mfma_f32_16x16x32_bf16 v[56:59], a[164:167], v[120:123], v[56:59]
  ds_read_b64_tr_b16 a[160:161], v190 offset:4096
  v_mul_f32 v30, v30, v94
  v_mul_f32 v31, v31, v95
  v_mfma_f32_16x16x32_bf16 v[60:63], a[164:167], v[124:127], v[60:63]
  ds_read_b64_tr_b16 a[162:163], v190 offset:6144
  s_waitcnt lgkmcnt(6)
  v_mfma_f32_16x16x32_bf16 v[32:35], a[144:147], v[128:131], v[32:35]
  ds_read_b64_tr_b16 a[164:165], v191 offset:4096
  v_cvt_pk_bf16_f32 v160, v0, v1
  v_mfma_f32_16x16x32_bf16 v[36:39], a[144:147], v[132:135], v[36:39]
  ds_read_b64_tr_b16 a[166:167], v191 offset:6144
  v_cvt_pk_bf16_f32 v161, v2, v3
  v_mfma_f32_16x16x32_bf16 v[40:43], a[148:151], v[128:131], v[40:43]
  ds_read_b64_tr_b16 a[144:145], v192 offset:4096
  v_cvt_pk_bf16_f32 v162, v8, v9
  v_mfma_f32_16x16x32_bf16 v[44:47], a[148:151], v[132:135], v[44:47]
  ds_read_b64_tr_b16 a[146:147], v192 offset:6144
  s_waitcnt lgkmcnt(6)
  v_mfma_f32_16x16x32_bf16 v[48:51], a[152:155], v[128:131], v[48:51]
  ds_read_b64_tr_b16 a[148:149], v193 offset:4096
  v_cvt_pk_bf16_f32 v163, v10, v11
  v_mfma_f32_16x16x32_bf16 v[52:55], a[152:155], v[132:135], v[52:55]
  ds_read_b64_tr_b16 a[150:151], v193 offset:6144
  buffer_store_dwordx4 v[160:163], v253, s[4:7], s76 offen offset:0 sc1
  v_mfma_f32_16x16x32_bf16 v[56:59], a[156:159], v[128:131], v[56:59]
  ds_read_b64_tr_b16 a[152:153], v190 offset:8192
  v_cvt_pk_bf16_f32 v164, v4, v5
  v_mfma_f32_16x16x32_bf16 v[60:63], a[156:159], v[132:135], v[60:63]
  ds_read_b64_tr_b16 a[154:155], v190 offset:10240
  s_waitcnt lgkmcnt(6)
  v_mfma_f32_16x16x32_bf16 v[32:35], a[160:163], v[136:139], v[32:35]
  ds_read_b64_tr_b16 a[156:157], v191 offset:8192
  v_cvt_pk_bf16_f32 v165, v6, v7
  v_mfma_f32_16x16x32_bf16 v[36:39], a[160:163], v[140:143], v[36:39]
  ds_read_b64_tr_b16 a[158:159], v191 offset:10240
  v_cvt_pk_bf16_f32 v166, v12, v13
  v_mfma_f32_16x16x32_bf16 v[40:43], a[164:167], v[136:139], v[40:43]
  ds_read_b64_tr_b16 a[160:161], v192 offset:8192
  v_cvt_pk_bf16_f32 v167, v14, v15
  v_mfma_f32_16x16x32_bf16 v[44:47], a[164:167], v[140:143], v[44:47]
  ds_read_b64_tr_b16 a[162:163], v192 offset:10240
  s_waitcnt lgkmcnt(6)
  v_mfma_f32_16x16x32_bf16 v[48:51], a[144:147], v[136:139], v[48:51]
  ds_read_b64_tr_b16 a[164:165], v193 offset:8192
  buffer_store_dwordx4 v[164:167], v253, s[4:7], s76 offen offset:1024 sc1
  v_mfma_f32_16x16x32_bf16 v[52:55], a[144:147], v[140:143], v[52:55]
  ds_read_b64_tr_b16 a[166:167], v193 offset:10240
  v_cvt_pk_bf16_f32 v168, v16, v17
  v_mfma_f32_16x16x32_bf16 v[56:59], a[148:151], v[136:139], v[56:59]
  ds_read_b64_tr_b16 a[144:145], v190 offset:12288
  v_cvt_pk_bf16_f32 v169, v18, v19
  v_mfma_f32_16x16x32_bf16 v[60:63], a[148:151], v[140:143], v[60:63]
  ds_read_b64_tr_b16 a[146:147], v190 offset:14336
  s_waitcnt lgkmcnt(6)
  v_mfma_f32_16x16x32_bf16 v[32:35], a[152:155], v[144:147], v[32:35]
  ds_read_b64_tr_b16 a[148:149], v191 offset:12288
  v_cvt_pk_bf16_f32 v170, v24, v25
  v_mfma_f32_16x16x32_bf16 v[36:39], a[152:155], v[148:151], v[36:39]
  ds_read_b64_tr_b16 a[150:151], v191 offset:14336
  v_cvt_pk_bf16_f32 v171, v26, v27
  v_mfma_f32_16x16x32_bf16 v[40:43], a[156:159], v[144:147], v[40:43]
  ds_read_b64_tr_b16 a[152:153], v192 offset:12288
  buffer_store_dwordx4 v[168:171], v253, s[4:7], s76 offen offset:2048 sc1
  v_mfma_f32_16x16x32_bf16 v[44:47], a[156:159], v[148:151], v[44:47]
  ds_read_b64_tr_b16 a[154:155], v192 offset:14336
  s_waitcnt lgkmcnt(6)
  v_mfma_f32_16x16x32_bf16 v[48:51], a[160:163], v[144:147], v[48:51]
  ds_read_b64_tr_b16 a[156:157], v193 offset:12288
  v_cvt_pk_bf16_f32 v172, v20, v21
  v_mfma_f32_16x16x32_bf16 v[52:55], a[160:163], v[148:151], v[52:55]
  ds_read_b64_tr_b16 a[158:159], v193 offset:14336
  v_cvt_pk_bf16_f32 v173, v22, v23
  v_mfma_f32_16x16x32_bf16 v[56:59], a[164:167], v[144:147], v[56:59]
  ds_read_b64_tr_b16 a[160:161], v190 offset:16384
  v_cvt_pk_bf16_f32 v174, v28, v29
  v_mfma_f32_16x16x32_bf16 v[60:63], a[164:167], v[148:151], v[60:63]
  ds_read_b64_tr_b16 a[162:163], v190 offset:18432
  s_waitcnt lgkmcnt(6)
  v_mfma_f32_16x16x32_bf16 v[32:35], a[144:147], v[152:155], v[32:35]
  ds_read_b64_tr_b16 a[164:165], v191 offset:16384
  v_cvt_pk_bf16_f32 v175, v30, v31
  v_mfma_f32_16x16x32_bf16 v[36:39], a[144:147], v[156:159], v[36:39]
  ds_read_b64_tr_b16 a[166:167], v191 offset:18432
  buffer_store_dwordx4 v[172:175], v253, s[4:7], s76 offen offset:3072 sc1
  v_mfma_f32_16x16x32_bf16 v[40:43], a[148:151], v[152:155], v[40:43]
  ds_read_b64_tr_b16 a[144:145], v192 offset:16384
  s_add_u32 m0, s24, 0x0
  v_mfma_f32_16x16x32_bf16 v[44:47], a[148:151], v[156:159], v[44:47]
  ds_read_b64_tr_b16 a[146:147], v192 offset:18432
  s_waitcnt lgkmcnt(6)
  v_mfma_f32_16x16x32_bf16 v[48:51], a[152:155], v[152:155], v[48:51]
  ds_read_b64_tr_b16 a[148:149], v193 offset:16384
  buffer_load_dwordx4 v176, s[12:15], s26 offen offset:0 lds
  v_mfma_f32_16x16x32_bf16 v[52:55], a[152:155], v[156:159], v[52:55]
  ds_read_b64_tr_b16 a[150:151], v193 offset:18432
  buffer_load_dwordx4 v177, s[12:15], s26 offen offset:1024 lds
  v_mfma_f32_16x16x32_bf16 v[56:59], a[156:159], v[152:155], v[56:59]
  ds_read_b64_tr_b16 a[152:153], v190 offset:20480
  buffer_load_dwordx4 v178, s[12:15], s26 offen offset:2048 lds
  v_mfma_f32_16x16x32_bf16 v[60:63], a[156:159], v[156:159], v[60:63]
  ds_read_b64_tr_b16 a[154:155], v190 offset:22528
  s_waitcnt lgkmcnt(6)
  v_mfma_f32_16x16x32_bf16 v[32:35], a[160:163], v[160:163], v[32:35]
  ds_read_b64_tr_b16 a[156:157], v191 offset:20480
  buffer_load_dwordx4 v179, s[12:15], s26 offen offset:3072 lds
  s_add_u32 m0, s24, 0x1000
  v_mfma_f32_16x16x32_bf16 v[36:39], a[160:163], v[164:167], v[36:39]
  ds_read_b64_tr_b16 a[158:159], v191 offset:22528
  s_add_u32 s26, s26, s27
  buffer_load_dwordx4 v176, s[12:15], s26 offen offset:0 lds
  v_mfma_f32_16x16x32_bf16 v[40:43], a[164:167], v[160:163], v[40:43]
  ds_read_b64_tr_b16 a[160:161], v192 offset:20480
  buffer_load_dwordx4 v177, s[12:15], s26 offen offset:1024 lds
  v_mfma_f32_16x16x32_bf16 v[44:47], a[164:167], v[164:167], v[44:47]
  ds_read_b64_tr_b16 a[162:163], v192 offset:22528
  s_waitcnt lgkmcnt(6)
  v_mfma_f32_16x16x32_bf16 v[48:51], a[144:147], v[160:163], v[48:51]
  ds_read_b64_tr_b16 a[164:165], v193 offset:20480
  buffer_load_dwordx4 v178, s[12:15], s26 offen offset:2048 lds
  v_mfma_f32_16x16x32_bf16 v[52:55], a[144:147], v[164:167], v[52:55]
  ds_read_b64_tr_b16 a[166:167], v193 offset:22528
  buffer_load_dwordx4 v179, s[12:15], s26 offen offset:3072 lds
  s_add_u32 m0, s24, 0x2000
  s_waitcnt vmcnt(23)
  s_barrier
  v_mfma_f32_16x16x32_bf16 v[56:59], a[148:151], v[160:163], v[56:59]
  ds_read_b64_tr_b16 a[144:145], v190 offset:24576
  s_add_u32 s26, s26, s28
  buffer_load_dwordx4 v176, s[12:15], s26 offen offset:0 lds
  v_mfma_f32_16x16x32_bf16 v[60:63], a[148:151], v[164:167], v[60:63]
  ds_read_b64_tr_b16 a[146:147], v190 offset:26624
  s_waitcnt lgkmcnt(6)
  v_mfma_f32_16x16x32_bf16 v[32:35], a[152:155], v[168:171], v[32:35]
  ds_read_b64_tr_b16 a[148:149], v191 offset:24576
  s_add_u32 s26, s26, s29
  v_mfma_f32_16x16x32_bf16 v[36:39], a[152:155], v[172:175], v[36:39]
  ds_read_b64_tr_b16 a[150:151], v191 offset:26624
  v_mfma_f32_16x16x32_bf16 v[40:43], a[156:159], v[168:171], v[40:43]
  ds_read_b64_tr_b16 a[152:153], v192 offset:24576
  s_waitcnt vmcnt(23)
  v_readfirstlane_b32 s83, v241
  v_mfma_f32_16x16x32_bf16 v[44:47], a[156:159], v[172:175], v[44:47]
  ds_read_b64_tr_b16 a[154:155], v192 offset:26624
  s_waitcnt lgkmcnt(6)
  v_mfma_f32_16x16x32_bf16 v[48:51], a[160:163], v[168:171], v[48:51]
  ds_read_b64_tr_b16 a[156:157], v193 offset:24576
  s_sub_u32 s83, s83, s97
  s_sub_u32 s83, s83, 3
  s_cmp_gt_u32 s83, 7
  s_cbranch_scc1 m_C_22_slow0
m_C_22_slowr0:
  v_mfma_f32_16x16x32_bf16 v[52:55], a[160:163], v[172:175], v[52:55]
  ds_read_b64_tr_b16 a[158:159], v193 offset:26624
  v_mfma_f32_16x16x32_bf16 v[56:59], a[164:167], v[168:171], v[56:59]
  ds_read_b64_tr_b16 a[160:161], v190 offset:28672
  v_mfma_f32_16x16x32_bf16 v[60:63], a[164:167], v[172:175], v[60:63]
  ds_read_b64_tr_b16 a[162:163], v190 offset:30720
  s_waitcnt lgkmcnt(6)
  v_mfma_f32_16x16x32_bf16 v[64:67], a[144:147], v[104:107], 0
  ds_read_b64_tr_b16 a[164:165], v191 offset:28672
  s_mov_b32 s26, s78
  s_sub_u32 s30, -36736, s79
  v_mfma_f32_16x16x32_bf16 v[68:71], a[144:147], v[108:111], 0
  ds_read_b64_tr_b16 a[166:167], v191 offset:30720
  s_add_u32 m0, s24, 0x9000
  v_mfma_f32_16x16x32_bf16 v[72:75], a[148:151], v[104:107], 0
  ds_read_b64_tr_b16 a[144:145], v192 offset:28672
  buffer_load_dwordx4 v176, s[12:15], s26 offen offset:0 lds
  v_mfma_f32_16x16x32_bf16 v[76:79], a[148:151], v[108:111], 0
  ds_read_b64_tr_b16 a[146:147], v192 offset:30720
  s_waitcnt lgkmcnt(6)
  v_mfma_f32_16x16x32_bf16 v[80:83], a[152:155], v[104:107], 0
  ds_read_b64_tr_b16 a[148:149], v193 offset:28672
  v_mfma_f32_16x16x32_bf16 v[84:87], a[152:155], v[108:111], 0
  ds_read_b64_tr_b16 a[150:151], v193 offset:30720
  buffer_load_dwordx4 a[0:3], v253, s[4:7], s77 offen offset:0 sc1
  v_mfma_f32_16x16x32_bf16 v[88:91], a[156:159], v[104:107], 0
  ds_read_b64_tr_b16 a[152:153], v190 offset:32768
  v_mfma_f32_16x16x32_bf16 v[92:95], a[156:159], v[108:111], 0
  ds_read_b64_tr_b16 a[154:155], v190 offset:34816
  s_waitcnt lgkmcnt(6)
  v_mfma_f32_16x16x32_bf16 v[64:67], a[160:163], v[112:115], v[64:67]
  ds_read_b64_tr_b16 a[156:157], v191 offset:32768
  v_mfma_f32_16x16x32_bf16 v[68:71], a[160:163], v[116:119], v[68:71]
  ds_read_b64_tr_b16 a[158:159], v191 offset:34816
  buffer_load_dwordx4 v177, s[12:15], s26 offen offset:1024 lds
  v_mfma_f32_16x16x32_bf16 v[72:75], a[164:167], v[112:115], v[72:75]
  ds_read_b64_tr_b16 a[160:161], v192 offset:32768
  v_mfma_f32_16x16x32_bf16 v[76:79], a[164:167], v[116:119], v[76:79]
  ds_read_b64_tr_b16 a[162:163], v192 offset:34816
  s_waitcnt lgkmcnt(6)
  v_mfma_f32_16x16x32_bf16 v[80:83], a[144:147], v[112:115], v[80:83]
  ds_read_b64_tr_b16 a[164:165], v193 offset:32768
  v_mfma_f32_16x16x32_bf16 v[84:87], a[144:147], v[116:119], v[84:87]
  ds_read_b64_tr_b16 a[166:167], v193 offset:34816
  buffer_load_dwordx4 a[4:7], v253, s[4:7], s77 offen offset:1024 sc1
  v_mfma_f32_16x16x32_bf16 v[88:91], a[148:151], v[112:115], v[88:91]
  ds_read_b64_tr_b16 a[144:145], v190 offset:36864
  v_mfma_f32_16x16x32_bf16 v[92:95], a[148:151], v[116:119], v[92:95]
  ds_read_b64_tr_b16 a[146:147], v190 offset:38912
  s_waitcnt lgkmcnt(6)
  v_mfma_f32_16x16x32_bf16 v[64:67], a[152:155], v[120:123], v[64:67]
  ds_read_b64_tr_b16 a[148:149], v191 offset:36864
  s_waitcnt vmcnt(13)
  buffer_store_dword v242, v240, s[4:7], s80 offen sc1
  buffer_load_dwordx4 v178, s[12:15], s26 offen offset:2048 lds
  v_mfma_f32_16x16x32_bf16 v[68:71], a[152:155], v[124:127], v[68:71]
  ds_read_b64_tr_b16 a[150:151], v191 offset:38912
  v_mfma_f32_16x16x32_bf16 v[72:75], a[156:159], v[120:123], v[72:75]
  ds_read_b64_tr_b16 a[152:153], v192 offset:36864
  v_mfma_f32_16x16x32_bf16 v[76:79], a[156:159], v[124:127], v[76:79]
  ds_read_b64_tr_b16 a[154:155], v192 offset:38912
  s_waitcnt lgkmcnt(6)
  v_mfma_f32_16x16x32_bf16 v[80:83], a[160:163], v[120:123], v[80:83]
  ds_read_b64_tr_b16 a[156:157], v193 offset:36864
  v_mfma_f32_16x16x32_bf16 v[84:87], a[160:163], v[124:127], v[84:87]
  ds_read_b64_tr_b16 a[158:159], v193 offset:38912
  buffer_load_dwordx4 a[8:11], v253, s[4:7], s77 offen offset:2048 sc1
  v_mfma_f32_16x16x32_bf16 v[88:91], a[164:167], v[120:123], v[88:91]
  ds_read_b64_tr_b16 a[160:161], v190 offset:40960
  buffer_load_dwordx4 v179, s[12:15], s26 offen offset:3072 lds
  v_mfma_f32_16x16x32_bf16 v[92:95], a[164:167], v[124:127], v[92:95]
  ds_read_b64_tr_b16 a[162:163], v190 offset:43008
  s_waitcnt lgkmcnt(6)
  v_mfma_f32_16x16x32_bf16 v[64:67], a[144:147], v[128:131], v[64:67]
  ds_read_b64_tr_b16 a[164:165], v191 offset:40960
  s_add_u32 s26, s26, s79
  v_mfma_f32_16x16x32_bf16 v[68:71], a[144:147], v[132:135], v[68:71]
  ds_read_b64_tr_b16 a[166:167], v191 offset:43008
  v_mfma_f32_16x16x32_bf16 v[72:75], a[148:151], v[128:131], v[72:75]
  ds_read_b64_tr_b16 a[144:145], v192 offset:40960
  v_mfma_f32_16x16x32_bf16 v[76:79], a[148:151], v[132:135], v[76:79]
  ds_read_b64_tr_b16 a[146:147], v192 offset:43008
  s_waitcnt lgkmcnt(6)
  v_mfma_f32_16x16x32_bf16 v[80:83], a[152:155], v[128:131], v[80:83]
  ds_read_b64_tr_b16 a[148:149], v193 offset:40960
  s_add_u32 m0, s24, 0xa000
  v_mfma_f32_16x16x32_bf16 v[84:87], a[152:155], v[132:135], v[84:87]
  ds_read_b64_tr_b16 a[150:151], v193 offset:43008
  buffer_load_dwordx4 v176, s[12:15], s26 offen offset:0 lds
  v_mfma_f32_16x16x32_bf16 v[88:91], a[156:159], v[128:131], v[88:91]
  ds_read_b64_tr_b16 a[152:153], v190 offset:45056
  buffer_load_dwordx4 a[12:15], v253, s[4:7], s77 offen offset:3072 sc1
  s_add_u32 s77, s77, 4096
  v_mfma_f32_16x16x32_bf16 v[92:95], a[156:159], v[132:135], v[92:95]
  ds_read_b64_tr_b16 a[154:155], v190 offset:47104
  s_waitcnt lgkmcnt(6)
  v_mfma_f32_16x16x32_bf16 v[64:67], a[160:163], v[136:139], v[64:67]
  ds_read_b64_tr_b16 a[156:157], v191 offset:45056
  v_mfma_f32_16x16x32_bf16 v[68:71], a[160:163], v[140:143], v[68:71]
  ds_read_b64_tr_b16 a[158:159], v191 offset:47104
  v_mfma_f32_16x16x32_bf16 v[72:75], a[164:167], v[136:139], v[72:75]
  ds_read_b64_tr_b16 a[160:161], v192 offset:45056
  v_mfma_f32_16x16x32_bf16 v[76:79], a[164:167], v[140:143], v[76:79]
  ds_read_b64_tr_b16 a[162:163], v192 offset:47104
  s_waitcnt lgkmcnt(6)
  v_mfma_f32_16x16x32_bf16 v[80:83], a[144:147], v[136:139], v[80:83]
  ds_read_b64_tr_b16 a[164:165], v193 offset:45056
  buffer_load_dwordx4 v177, s[12:15], s26 offen offset:1024 lds
  v_mfma_f32_16x16x32_bf16 v[84:87], a[144:147], v[140:143], v[84:87]
  ds_read_b64_tr_b16 a[166:167], v193 offset:47104
  v_mfma_f32_16x16x32_bf16 v[88:91], a[148:151], v[136:139], v[88:91]
  ds_read_b64_tr_b16 a[144:145], v194 offset:0
  buffer_load_dwordx4 a[16:19], v253, s[4:7], s77 offen offset:0 sc1
  v_mfma_f32_16x16x32_bf16 v[92:95], a[148:151], v[140:143], v[92:95]
  ds_read_b64_tr_b16 a[146:147], v194 offset:2048
  s_waitcnt lgkmcnt(6)
  v_mfma_f32_16x16x32_bf16 v[64:67], a[152:155], v[144:147], v[64:67]
  ds_read_b64_tr_b16 a[148:149], v195 offset:0
  v_mfma_f32_16x16x32_bf16 v[68:71], a[152:155], v[148:151], v[68:71]
  ds_read_b64_tr_b16 a[150:151], v195 offset:2048
  v_mfma_f32_16x16x32_bf16 v[72:75], a[156:159], v[144:147], v[72:75]
  ds_read_b64_tr_b16 a[152:153], v196 offset:0
  buffer_load_dwordx4 v178, s[12:15], s26 offen offset:2048 lds
  v_mfma_f32_16x16x32_bf16 v[76:79], a[156:159], v[148:151], v[76:79]
  ds_read_b64_tr_b16 a[154:155], v196 offset:2048
  s_waitcnt lgkmcnt(6)
  v_mfma_f32_16x16x32_bf16 v[80:83], a[160:163], v[144:147], v[80:83]
  ds_read_b64_tr_b16 a[156:157], v197 offset:0
  v_mfma_f32_16x16x32_bf16 v[84:87], a[160:163], v[148:151], v[84:87]
  ds_read_b64_tr_b16 a[158:159], v197 offset:2048
  v_mfma_f32_16x16x32_bf16 v[88:91], a[164:167], v[144:147], v[88:91]
  ds_read_b64_tr_b16 a[160:161], v194 offset:4096
  v_mfma_f32_16x16x32_bf16 v[92:95], a[164:167], v[148:151], v[92:95]
  ds_read_b64_tr_b16 a[162:163], v194 offset:6144
  s_waitcnt lgkmcnt(6)
  v_mfma_f32_16x16x32_bf16 v[64:67], a[144:147], v[152:155], v[64:67]
  ds_read_b64_tr_b16 a[164:165], v195 offset:4096
  v_mfma_f32_16x16x32_bf16 v[68:71], a[144:147], v[156:159], v[68:71]
  ds_read_b64_tr_b16 a[166:167], v195 offset:6144
  buffer_load_dwordx4 v179, s[12:15], s26 offen offset:3072 lds
  v_mfma_f32_16x16x32_bf16 v[72:75], a[148:151], v[152:155], v[72:75]
  ds_read_b64_tr_b16 a[144:145], v196 offset:4096
  s_add_u32 s26, s26, s28
  v_mfma_f32_16x16x32_bf16 v[76:79], a[148:151], v[156:159], v[76:79]
  ds_read_b64_tr_b16 a[146:147], v196 offset:6144
  s_waitcnt lgkmcnt(6)
  v_mfma_f32_16x16x32_bf16 v[80:83], a[152:155], v[152:155], v[80:83]
  ds_read_b64_tr_b16 a[148:149], v197 offset:4096
  v_mfma_f32_16x16x32_bf16 v[84:87], a[152:155], v[156:159], v[84:87]
  ds_read_b64_tr_b16 a[150:151], v197 offset:6144
  v_mfma_f32_16x16x32_bf16 v[88:91], a[156:159], v[152:155], v[88:91]
  ds_read_b64_tr_b16 a[152:153], v194 offset:8192
  s_add_u32 m0, s24, 0xb000
  v_mfma_f32_16x16x32_bf16 v[92:95], a[156:159], v[156:159], v[92:95]
  ds_read_b64_tr_b16 a[154:155], v194 offset:10240
  s_waitcnt lgkmcnt(6)
  v_mfma_f32_16x16x32_bf16 v[64:67], a[160:163], v[160:163], v[64:67]
  ds_read_b64_tr_b16 a[156:157], v195 offset:8192
  buffer_load_dwordx4 v176, s[12:15], s26 offen offset:0 lds
  v_mfma_f32_16x16x32_bf16 v[68:71], a[160:163], v[164:167], v[68:71]
  ds_read_b64_tr_b16 a[158:159], v195 offset:10240
  s_add_u32 s26, s26, s30
  v_mfma_f32_16x16x32_bf16 v[72:75], a[164:167], v[160:163], v[72:75]
  ds_read_b64_tr_b16 a[160:161], v196 offset:8192
  v_mfma_f32_16x16x32_bf16 v[76:79], a[164:167], v[164:167], v[76:79]
  ds_read_b64_tr_b16 a[162:163], v196 offset:10240
  s_waitcnt lgkmcnt(6)
  v_mfma_f32_16x16x32_bf16 v[80:83], a[144:147], v[160:163], v[80:83]
  ds_read_b64_tr_b16 a[164:165], v197 offset:8192
  v_mfma_f32_16x16x32_bf16 v[84:87], a[144:147], v[164:167], v[84:87]
  ds_read_b64_tr_b16 a[166:167], v197 offset:10240
  s_waitcnt vmcnt(29)
  s_barrier
  v_mfma_f32_16x16x32_bf16 v[88:91], a[148:151], v[160:163], v[88:91]
  ds_read_b64_tr_b16 a[144:145], v194 offset:12288
  v_mfma_f32_16x16x32_bf16 v[92:95], a[148:151], v[164:167], v[92:95]
  ds_read_b64_tr_b16 a[146:147], v194 offset:14336
  s_waitcnt lgkmcnt(6)
  v_mfma_f32_16x16x32_bf16 v[64:67], a[152:155], v[168:171], v[64:67]
  ds_read_b64_tr_b16 a[148:149], v195 offset:12288
  v_mfma_f32_16x16x32_bf16 v[68:71], a[152:155], v[172:175], v[68:71]
  ds_read_b64_tr_b16 a[150:151], v195 offset:14336
  v_mfma_f32_16x16x32_bf16 v[72:75], a[156:159], v[168:171], v[72:75]
  ds_read_b64_tr_b16 a[152:153], v196 offset:12288
  v_mfma_f32_16x16x32_bf16 v[76:79], a[156:159], v[172:175], v[76:79]
  ds_read_b64_tr_b16 a[154:155], v196 offset:14336
  s_waitcnt lgkmcnt(6)
  v_mfma_f32_16x16x32_bf16 v[80:83], a[160:163], v[168:171], v[80:83]
  ds_read_b64_tr_b16 a[156:157], v197 offset:12288
  v_mfma_f32_16x16x32_bf16 v[84:87], a[160:163], v[172:175], v[84:87]
  ds_read_b64_tr_b16 a[158:159], v197 offset:14336
  v_mfma_f32_16x16x32_bf16 v[88:91], a[164:167], v[168:171], v[88:91]
  ds_read_b64_tr_b16 a[160:161], v194 offset:16384
  v_mfma_f32_16x16x32_bf16 v[92:95], a[164:167], v[172:175], v[92:95]
  ds_read_b64_tr_b16 a[162:163], v194 offset:18432
  s_waitcnt lgkmcnt(6)
  v_mfma_f32_16x16x32_bf16 v[0:3], a[144:147], v[104:107], 0
  ds_read_b64_tr_b16 a[164:165], v195 offset:16384
  buffer_load_dword v243, v240, s[4:7], s81 offen sc1
  v_mfma_f32_16x16x32_bf16 v[4:7], a[144:147], v[108:111], 0
  ds_read_b64_tr_b16 a[166:167], v195 offset:18432
  s_add_u32 m0, s24, 0x12000
  v_mfma_f32_16x16x32_bf16 v[8:11], a[148:151], v[104:107], 0
  ds_read_b64_tr_b16 a[144:145], v196 offset:16384
  buffer_load_dwordx4 v176, s[12:15], s26 offen offset:0 lds
  v_mfma_f32_16x16x32_bf16 v[12:15], a[148:151], v[108:111], 0
  ds_read_b64_tr_b16 a[146:147], v196 offset:18432
  s_waitcnt lgkmcnt(6)
  v_mfma_f32_16x16x32_bf16 v[16:19], a[152:155], v[104:107], 0
  ds_read_b64_tr_b16 a[148:149], v197 offset:16384
  v_mfma_f32_16x16x32_bf16 v[20:23], a[152:155], v[108:111], 0
  ds_read_b64_tr_b16 a[150:151], v197 offset:18432
  buffer_load_dwordx4 a[20:23], v253, s[4:7], s77 offen offset:1024 sc1
  v_mfma_f32_16x16x32_bf16 v[24:27], a[156:159], v[104:107], 0
  ds_read_b64_tr_b16 a[152:153], v194 offset:20480
  v_mfma_f32_16x16x32_bf16 v[28:31], a[156:159], v[108:111], 0
  ds_read_b64_tr_b16 a[154:155], v194 offset:22528
  s_waitcnt lgkmcnt(6)
  v_mfma_f32_16x16x32_bf16 v[0:3], a[160:163], v[112:115], v[0:3]
  ds_read_b64_tr_b16 a[156:157], v195 offset:20480
  v_mfma_f32_16x16x32_bf16 v[4:7], a[160:163], v[116:119], v[4:7]
  ds_read_b64_tr_b16 a[158:159], v195 offset:22528
  buffer_load_dwordx4 v177, s[12:15], s26 offen offset:1024 lds
  v_mfma_f32_16x16x32_bf16 v[8:11], a[164:167], v[112:115], v[8:11]
  ds_read_b64_tr_b16 a[160:161], v196 offset:20480
  v_mfma_f32_16x16x32_bf16 v[12:15], a[164:167], v[116:119], v[12:15]
  ds_read_b64_tr_b16 a[162:163], v196 offset:22528
  s_waitcnt lgkmcnt(6)
  v_mfma_f32_16x16x32_bf16 v[16:19], a[144:147], v[112:115], v[16:19]
  ds_read_b64_tr_b16 a[164:165], v197 offset:20480
  v_mfma_f32_16x16x32_bf16 v[20:23], a[144:147], v[116:119], v[20:23]
  ds_read_b64_tr_b16 a[166:167], v197 offset:22528
  buffer_load_dwordx4 a[24:27], v253, s[4:7], s77 offen offset:2048 sc1
  v_mfma_f32_16x16x32_bf16 v[24:27], a[148:151], v[112:115], v[24:27]
  ds_read_b64_tr_b16 a[144:145], v194 offset:24576
  v_mfma_f32_16x16x32_bf16 v[28:31], a[148:151], v[116:119], v[28:31]
  ds_read_b64_tr_b16 a[146:147], v194 offset:26624
  s_waitcnt lgkmcnt(6)
  v_mfma_f32_16x16x32_bf16 v[0:3], a[152:155], v[120:123], v[0:3]
  ds_read_b64_tr_b16 a[148:149], v195 offset:24576
  buffer_load_dwordx4 v178, s[12:15], s26 offen offset:2048 lds
  v_mfma_f32_16x16x32_bf16 v[4:7], a[152:155], v[124:127], v[4:7]
  ds_read_b64_tr_b16 a[150:151], v195 offset:26624
  v_mfma_f32_16x16x32_bf16 v[8:11], a[156:159], v[120:123], v[8:11]
  ds_read_b64_tr_b16 a[152:153], v196 offset:24576
  v_mfma_f32_16x16x32_bf16 v[12:15], a[156:159], v[124:127], v[12:15]
  ds_read_b64_tr_b16 a[154:155], v196 offset:26624
  s_waitcnt lgkmcnt(6)
  v_mfma_f32_16x16x32_bf16 v[16:19], a[160:163], v[120:123], v[16:19]
  ds_read_b64_tr_b16 a[156:157], v197 offset:24576
  v_mfma_f32_16x16x32_bf16 v[20:23], a[160:163], v[124:127], v[20:23]
  ds_read_b64_tr_b16 a[158:159], v197 offset:26624
  buffer_load_dwordx4 a[28:31], v253, s[4:7], s77 offen offset:3072 sc1
  s_add_u32 s77, s77, 4096
  v_mfma_f32_16x16x32_bf16 v[24:27], a[164:167], v[120:123], v[24:27]
  ds_read_b64_tr_b16 a[160:161], v194 offset:28672
  buffer_load_dwordx4 v179, s[12:15], s26 offen offset:3072 lds
  v_mfma_f32_16x16x32_bf16 v[28:31], a[164:167], v[124:127], v[28:31]
  ds_read_b64_tr_b16 a[162:163], v194 offset:30720
  s_waitcnt lgkmcnt(6)
  v_mfma_f32_16x16x32_bf16 v[0:3], a[144:147], v[128:131], v[0:3]
  ds_read_b64_tr_b16 a[164:165], v195 offset:28672
  s_add_u32 s26, s26, s79
  v_mfma_f32_16x16x32_bf16 v[4:7], a[144:147], v[132:135], v[4:7]
  ds_read_b64_tr_b16 a[166:167], v195 offset:30720
  v_mfma_f32_16x16x32_bf16 v[8:11], a[148:151], v[128:131], v[8:11]
  ds_read_b64_tr_b16 a[144:145], v196 offset:28672
  v_mfma_f32_16x16x32_bf16 v[12:15], a[148:151], v[132:135], v[12:15]
  ds_read_b64_tr_b16 a[146:147], v196 offset:30720
  s_waitcnt lgkmcnt(6)
  v_mfma_f32_16x16x32_bf16 v[16:19], a[152:155], v[128:131], v[16:19]
  ds_read_b64_tr_b16 a[148:149], v197 offset:28672
  s_add_u32 m0, s24, 0x13000
  v_mfma_f32_16x16x32_bf16 v[20:23], a[152:155], v[132:135], v[20:23]
  ds_read_b64_tr_b16 a[150:151], v197 offset:30720
  buffer_load_dwordx4 v176, s[12:15], s26 offen offset:0 lds
  v_mfma_f32_16x16x32_bf16 v[24:27], a[156:159], v[128:131], v[24:27]
  ds_read_b64_tr_b16 a[152:153], v194 offset:32768
  buffer_load_dwordx4 a[32:35], v253, s[4:7], s77 offen offset:0 sc1
  v_mfma_f32_16x16x32_bf16 v[28:31], a[156:159], v[132:135], v[28:31]
  ds_read_b64_tr_b16 a[154:155], v194 offset:34816
  s_waitcnt lgkmcnt(6)
  v_mfma_f32_16x16x32_bf16 v[0:3], a[160:163], v[136:139], v[0:3]
  ds_read_b64_tr_b16 a[156:157], v195 offset:32768
  v_mfma_f32_16x16x32_bf16 v[4:7], a[160:163], v[140:143], v[4:7]
  ds_read_b64_tr_b16 a[158:159], v195 offset:34816
  v_mfma_f32_16x16x32_bf16 v[8:11], a[164:167], v[136:139], v[8:11]
  ds_read_b64_tr_b16 a[160:161], v196 offset:32768
  v_mfma_f32_16x16x32_bf16 v[12:15], a[164:167], v[140:143], v[12:15]
  ds_read_b64_tr_b16 a[162:163], v196 offset:34816
  s_waitcnt lgkmcnt(6)
  v_mfma_f32_16x16x32_bf16 v[16:19], a[144:147], v[136:139], v[16:19]
  ds_read_b64_tr_b16 a[164:165], v197 offset:32768
  buffer_load_dwordx4 v177, s[12:15], s26 offen offset:1024 lds
  v_mfma_f32_16x16x32_bf16 v[20:23], a[144:147], v[140:143], v[20:23]
  ds_read_b64_tr_b16 a[166:167], v197 offset:34816
  v_mfma_f32_16x16x32_bf16 v[24:27], a[148:151], v[136:139], v[24:27]
  ds_read_b64_tr_b16 a[144:145], v194 offset:36864
  buffer_load_dwordx4 a[36:39], v253, s[4:7], s77 offen offset:1024 sc1
  v_mfma_f32_16x16x32_bf16 v[28:31], a[148:151], v[140:143], v[28:31]
  ds_read_b64_tr_b16 a[146:147], v194 offset:38912
  s_waitcnt lgkmcnt(6)
  v_mfma_f32_16x16x32_bf16 v[0:3], a[152:155], v[144:147], v[0:3]
  ds_read_b64_tr_b16 a[148:149], v195 offset:36864
  v_mfma_f32_16x16x32_bf16 v[4:7], a[152:155], v[148:151], v[4:7]
  ds_read_b64_tr_b16 a[150:151], v195 offset:38912
  v_mfma_f32_16x16x32_bf16 v[8:11], a[156:159], v[144:147], v[8:11]
  ds_read_b64_tr_b16 a[152:153], v196 offset:36864
  buffer_load_dwordx4 v178, s[12:15], s26 offen offset:2048 lds
  v_mfma_f32_16x16x32_bf16 v[12:15], a[156:159], v[148:151], v[12:15]
  ds_read_b64_tr_b16 a[154:155], v196 offset:38912
  s_waitcnt lgkmcnt(6)
  v_mfma_f32_16x16x32_bf16 v[16:19], a[160:163], v[144:147], v[16:19]
  ds_read_b64_tr_b16 a[156:157], v197 offset:36864
  v_mfma_f32_16x16x32_bf16 v[20:23], a[160:163], v[148:151], v[20:23]
  ds_read_b64_tr_b16 a[158:159], v197 offset:38912
  v_mfma_f32_16x16x32_bf16 v[24:27], a[164:167], v[144:147], v[24:27]
  ds_read_b64_tr_b16 a[160:161], v194 offset:40960
  v_mfma_f32_16x16x32_bf16 v[28:31], a[164:167], v[148:151], v[28:31]
  ds_read_b64_tr_b16 a[162:163], v194 offset:43008
  s_waitcnt lgkmcnt(6)
  v_mfma_f32_16x16x32_bf16 v[0:3], a[144:147], v[152:155], v[0:3]
  ds_read_b64_tr_b16 a[164:165], v195 offset:40960
  v_mfma_f32_16x16x32_bf16 v[4:7], a[144:147], v[156:159], v[4:7]
  ds_read_b64_tr_b16 a[166:167], v195 offset:43008
  buffer_load_dwordx4 v179, s[12:15], s26 offen offset:3072 lds
  v_mfma_f32_16x16x32_bf16 v[8:11], a[148:151], v[152:155], v[8:11]
  ds_read_b64_tr_b16 a[144:145], v196 offset:40960
  s_add_u32 s26, s26, s28
  v_mfma_f32_16x16x32_bf16 v[12:15], a[148:151], v[156:159], v[12:15]
  ds_read_b64_tr_b16 a[146:147], v196 offset:43008
  s_waitcnt lgkmcnt(6)
  v_mfma_f32_16x16x32_bf16 v[16:19], a[152:155], v[152:155], v[16:19]
  ds_read_b64_tr_b16 a[148:149], v197 offset:40960
  v_mfma_f32_16x16x32_bf16 v[20:23], a[152:155], v[156:159], v[20:23]
  ds_read_b64_tr_b16 a[150:151], v197 offset:43008
  v_mfma_f32_16x16x32_bf16 v[24:27], a[156:159], v[152:155], v[24:27]
  ds_read_b64_tr_b16 a[152:153], v194 offset:45056
  s_add_u32 m0, s24, 0x14000
  v_mfma_f32_16x16x32_bf16 v[28:31], a[156:159], v[156:159], v[28:31]
  ds_read_b64_tr_b16 a[154:155], v194 offset:47104
  s_waitcnt lgkmcnt(6)
  v_mfma_f32_16x16x32_bf16 v[0:3], a[160:163], v[160:163], v[0:3]
  ds_read_b64_tr_b16 a[156:157], v195 offset:45056
  buffer_load_dwordx4 v176, s[12:15], s26 offen offset:0 lds
  v_mfma_f32_16x16x32_bf16 v[4:7], a[160:163], v[164:167], v[4:7]
  ds_read_b64_tr_b16 a[158:159], v195 offset:47104
  s_add_u32 s26, s26, s30
  v_mfma_f32_16x16x32_bf16 v[8:11], a[164:167], v[160:163], v[8:11]
  ds_read_b64_tr_b16 a[160:161], v196 offset:45056
  v_mfma_f32_16x16x32_bf16 v[12:15], a[164:167], v[164:167], v[12:15]
  ds_read_b64_tr_b16 a[162:163], v196 offset:47104
  s_waitcnt lgkmcnt(6)
  v_mfma_f32_16x16x32_bf16 v[16:19], a[144:147], v[160:163], v[16:19]
  ds_read_b64_tr_b16 a[164:165], v197 offset:45056
  v_mfma_f32_16x16x32_bf16 v[20:23], a[144:147], v[164:167], v[20:23]
  ds_read_b64_tr_b16 a[166:167], v197 offset:47104
  s_waitcnt vmcnt(30)
  s_barrier
  v_mfma_f32_16x16x32_bf16 v[24:27], a[148:151], v[160:163], v[24:27]
  ds_read_b64_tr_b16 a[144:145], v186 offset:0
  v_mfma_f32_16x16x32_bf16 v[28:31], a[148:151], v[164:167], v[28:31]
  ds_read_b64_tr_b16 a[146:147], v186 offset:2048
  s_waitcnt lgkmcnt(6)
  v_mfma_f32_16x16x32_bf16 v[0:3], a[152:155], v[168:171], v[0:3]
  ds_read_b64_tr_b16 a[148:149], v187 offset:0
  v_mfma_f32_16x16x32_bf16 v[4:7], a[152:155], v[172:175], v[4:7]
  ds_read_b64_tr_b16 a[150:151], v187 offset:2048
  v_mfma_f32_16x16x32_bf16 v[8:11], a[156:159], v[168:171], v[8:11]
  ds_read_b64_tr_b16 a[152:153], v188 offset:0
  s_waitcnt vmcnt(14)
  v_readfirstlane_b32 s83, v243
  v_mfma_f32_16x16x32_bf16 v[12:15], a[156:159], v[172:175], v[12:15]
  ds_read_b64_tr_b16 a[154:155], v188 offset:2048
  s_waitcnt lgkmcnt(6)
  v_mfma_f32_16x16x32_bf16 v[16:19], a[160:163], v[168:171], v[16:19]
  ds_read_b64_tr_b16 a[156:157], v189 offset:0
  s_sub_u32 s83, s83, s97
  s_sub_u32 s83, s83, 5
  s_cmp_gt_u32 s83, 7
  s_cbranch_scc1 m_C_22_slow1
m_C_22_slowr1:
  v_mfma_f32_16x16x32_bf16 v[20:23], a[160:163], v[172:175], v[20:23]
  ds_read_b64_tr_b16 a[158:159], v189 offset:2048
  v_mfma_f32_16x16x32_bf16 v[24:27], a[164:167], v[168:171], v[24:27]
  ds_read_b64_tr_b16 a[160:161], v186 offset:4096
  v_mfma_f32_16x16x32_bf16 v[28:31], a[164:167], v[172:175], v[28:31]
  ds_read_b64_tr_b16 a[162:163], v186 offset:6144
  s_waitcnt lgkmcnt(6)
  v_mfma_f32_16x16x32_bf16 v[204:207], a[144:147], v[104:107], 0
  ds_read_b64_tr_b16 a[164:165], v187 offset:4096
  v_mfma_f32_16x16x32_bf16 v[208:211], a[144:147], v[108:111], 0
  ds_read_b64_tr_b16 a[166:167], v187 offset:6144
  s_add_u32 m0, s24, 0x1b000
  v_mfma_f32_16x16x32_bf16 v[212:215], a[148:151], v[104:107], 0
  ds_read_b64_tr_b16 a[144:145], v188 offset:4096
  buffer_load_dwordx4 v176, s[12:15], s26 offen offset:0 lds
  v_mfma_f32_16x16x32_bf16 v[216:219], a[148:151], v[108:111], 0
  ds_read_b64_tr_b16 a[146:147], v188 offset:6144
  s_waitcnt lgkmcnt(6)
  v_mfma_f32_16x16x32_bf16 v[220:223], a[152:155], v[104:107], 0
  ds_read_b64_tr_b16 a[148:149], v189 offset:4096
  v_mfma_f32_16x16x32_bf16 v[224:227], a[152:155], v[108:111], 0
  ds_read_b64_tr_b16 a[150:151], v189 offset:6144
  buffer_load_dwordx4 a[40:43], v253, s[4:7], s77 offen offset:2048 sc1
  v_mfma_f32_16x16x32_bf16 v[228:231], a[156:159], v[104:107], 0
  ds_read_b64_tr_b16 a[152:153], v186 offset:8192
  v_mfma_f32_16x16x32_bf16 v[232:235], a[156:159], v[108:111], 0
  ds_read_b64_tr_b16 a[154:155], v186 offset:10240
  s_waitcnt lgkmcnt(6)
  v_mfma_f32_16x16x32_bf16 v[204:207], a[160:163], v[112:115], v[204:207]
  ds_read_b64_tr_b16 a[156:157], v187 offset:8192
  v_mfma_f32_16x16x32_bf16 v[208:211], a[160:163], v[116:119], v[208:211]
  ds_read_b64_tr_b16 a[158:159], v187 offset:10240
  buffer_load_dwordx4 v177, s[12:15], s26 offen offset:1024 lds
  v_mfma_f32_16x16x32_bf16 v[212:215], a[164:167], v[112:115], v[212:215]
  ds_read_b64_tr_b16 a[160:161], v188 offset:8192
  v_mfma_f32_16x16x32_bf16 v[216:219], a[164:167], v[116:119], v[216:219]
  ds_read_b64_tr_b16 a[162:163], v188 offset:10240
  s_waitcnt lgkmcnt(6)
  v_mfma_f32_16x16x32_bf16 v[220:223], a[144:147], v[112:115], v[220:223]
  ds_read_b64_tr_b16 a[164:165], v189 offset:8192
  buffer_load_dwordx4 a[44:47], v253, s[4:7], s77 offen offset:3072 sc1
  s_add_u32 s77, s77, 4096
  v_mfma_f32_16x16x32_bf16 v[224:227], a[144:147], v[116:119], v[224:227]
  ds_read_b64_tr_b16 a[166:167], v189 offset:10240
  v_mfma_f32_16x16x32_bf16 v[228:231], a[148:151], v[112:115], v[228:231]
  ds_read_b64_tr_b16 a[144:145], v186 offset:12288
  v_mfma_f32_16x16x32_bf16 v[232:235], a[148:151], v[116:119], v[232:235]
  ds_read_b64_tr_b16 a[146:147], v186 offset:14336
  s_waitcnt lgkmcnt(6)
  v_mfma_f32_16x16x32_bf16 v[204:207], a[152:155], v[120:123], v[204:207]
  ds_read_b64_tr_b16 a[148:149], v187 offset:12288
  buffer_load_dwordx4 v178, s[12:15], s26 offen offset:2048 lds
  v_mfma_f32_16x16x32_bf16 v[208:211], a[152:155], v[124:127], v[208:211]
  ds_read_b64_tr_b16 a[150:151], v187 offset:14336
  v_mfma_f32_16x16x32_bf16 v[212:215], a[156:159], v[120:123], v[212:215]
  ds_read_b64_tr_b16 a[152:153], v188 offset:12288
  buffer_load_dwordx4 a[48:51], v253, s[4:7], s77 offen offset:0 sc1
  v_mfma_f32_16x16x32_bf16 v[216:219], a[156:159], v[124:127], v[216:219]
  ds_read_b64_tr_b16 a[154:155], v188 offset:14336
  s_waitcnt lgkmcnt(6)
  v_mfma_f32_16x16x32_bf16 v[220:223], a[160:163], v[120:123], v[220:223]
  ds_read_b64_tr_b16 a[156:157], v189 offset:12288
  v_mfma_f32_16x16x32_bf16 v[224:227], a[160:163], v[124:127], v[224:227]
  ds_read_b64_tr_b16 a[158:159], v189 offset:14336
  v_mfma_f32_16x16x32_bf16 v[228:231], a[164:167], v[120:123], v[228:231]
  ds_read_b64_tr_b16 a[160:161], v186 offset:16384
  buffer_load_dwordx4 v179, s[12:15], s26 offen offset:3072 lds
  v_mfma_f32_16x16x32_bf16 v[232:235], a[164:167], v[124:127], v[232:235]
  ds_read_b64_tr_b16 a[162:163], v186 offset:18432
  s_waitcnt lgkmcnt(6)
  v_mfma_f32_16x16x32_bf16 v[204:207], a[144:147], v[128:131], v[204:207]
  ds_read_b64_tr_b16 a[164:165], v187 offset:16384
  s_add_u32 s26, s26, s79
  v_mfma_f32_16x16x32_bf16 v[208:211], a[144:147], v[132:135], v[208:211]
  ds_read_b64_tr_b16 a[166:167], v187 offset:18432
  buffer_load_dwordx4 a[52:55], v253, s[4:7], s77 offen offset:1024 sc1
  v_mfma_f32_16x16x32_bf16 v[212:215], a[148:151], v[128:131], v[212:215]
  ds_read_b64_tr_b16 a[144:145], v188 offset:16384
  v_mfma_f32_16x16x32_bf16 v[216:219], a[148:151], v[132:135], v[216:219]
  ds_read_b64_tr_b16 a[146:147], v188 offset:18432
  s_waitcnt lgkmcnt(6)
  v_mfma_f32_16x16x32_bf16 v[220:223], a[152:155], v[128:131], v[220:223]
  ds_read_b64_tr_b16 a[148:149], v189 offset:16384
  s_add_u32 m0, s24, 0x1c000
  v_mfma_f32_16x16x32_bf16 v[224:227], a[152:155], v[132:135], v[224:227]
  ds_read_b64_tr_b16 a[150:151], v189 offset:18432
  buffer_load_dwordx4 v176, s[12:15], s26 offen offset:0 lds
  v_mfma_f32_16x16x32_bf16 v[228:231], a[156:159], v[128:131], v[228:231]
  ds_read_b64_tr_b16 a[152:153], v186 offset:20480
  v_mfma_f32_16x16x32_bf16 v[232:235], a[156:159], v[132:135], v[232:235]
  ds_read_b64_tr_b16 a[154:155], v186 offset:22528
  s_waitcnt lgkmcnt(6)
  v_mfma_f32_16x16x32_bf16 v[204:207], a[160:163], v[136:139], v[204:207]
  ds_read_b64_tr_b16 a[156:157], v187 offset:20480
  buffer_load_dwordx4 a[56:59], v253, s[4:7], s77 offen offset:2048 sc1
  v_mfma_f32_16x16x32_bf16 v[208:211], a[160:163], v[140:143], v[208:211]
  ds_read_b64_tr_b16 a[158:159], v187 offset:22528
  v_mfma_f32_16x16x32_bf16 v[212:215], a[164:167], v[136:139], v[212:215]
  ds_read_b64_tr_b16 a[160:161], v188 offset:20480
  v_mfma_f32_16x16x32_bf16 v[216:219], a[164:167], v[140:143], v[216:219]
  ds_read_b64_tr_b16 a[162:163], v188 offset:22528
  s_waitcnt lgkmcnt(6)
  v_mfma_f32_16x16x32_bf16 v[220:223], a[144:147], v[136:139], v[220:223]
  ds_read_b64_tr_b16 a[164:165], v189 offset:20480
  buffer_load_dwordx4 v177, s[12:15], s26 offen offset:1024 lds
  v_mfma_f32_16x16x32_bf16 v[224:227], a[144:147], v[140:143], v[224:227]
  ds_read_b64_tr_b16 a[166:167], v189 offset:22528
  v_mfma_f32_16x16x32_bf16 v[228:231], a[148:151], v[136:139], v[228:231]
  ds_read_b64_tr_b16 a[144:145], v186 offset:24576
  buffer_load_dwordx4 a[60:63], v253, s[4:7], s77 offen offset:3072 sc1
  s_add_u32 s77, s77, 4096
  v_mfma_f32_16x16x32_bf16 v[232:235], a[148:151], v[140:143], v[232:235]
  ds_read_b64_tr_b16 a[146:147], v186 offset:26624
  s_waitcnt lgkmcnt(6)
  v_mfma_f32_16x16x32_bf16 v[204:207], a[152:155], v[144:147], v[204:207]
  ds_read_b64_tr_b16 a[148:149], v187 offset:24576
  v_mfma_f32_16x16x32_bf16 v[208:211], a[152:155], v[148:151], v[208:211]
  ds_read_b64_tr_b16 a[150:151], v187 offset:26624
  v_mfma_f32_16x16x32_bf16 v[212:215], a[156:159], v[144:147], v[212:215]
  ds_read_b64_tr_b16 a[152:153], v188 offset:24576
  buffer_load_dwordx4 v178, s[12:15], s26 offen offset:2048 lds
  v_mfma_f32_16x16x32_bf16 v[216:219], a[156:159], v[148:151], v[216:219]
  ds_read_b64_tr_b16 a[154:155], v188 offset:26624
  s_waitcnt lgkmcnt(6)
  v_mfma_f32_16x16x32_bf16 v[220:223], a[160:163], v[144:147], v[220:223]
  ds_read_b64_tr_b16 a[156:157], v189 offset:24576
  v_mfma_f32_16x16x32_bf16 v[224:227], a[160:163], v[148:151], v[224:227]
  ds_read_b64_tr_b16 a[158:159], v189 offset:26624
  buffer_load_dwordx4 a[64:67], v253, s[4:7], s77 offen offset:0 sc1
  v_mfma_f32_16x16x32_bf16 v[228:231], a[164:167], v[144:147], v[228:231]
  ds_read_b64_tr_b16 a[160:161], v186 offset:28672
  v_mfma_f32_16x16x32_bf16 v[232:235], a[164:167], v[148:151], v[232:235]
  ds_read_b64_tr_b16 a[162:163], v186 offset:30720
  s_waitcnt lgkmcnt(6)
  v_mfma_f32_16x16x32_bf16 v[204:207], a[144:147], v[152:155], v[204:207]
  ds_read_b64_tr_b16 a[164:165], v187 offset:28672
  v_mfma_f32_16x16x32_bf16 v[208:211], a[144:147], v[156:159], v[208:211]
  ds_read_b64_tr_b16 a[166:167], v187 offset:30720
  buffer_load_dwordx4 v179, s[12:15], s26 offen offset:3072 lds
  v_mfma_f32_16x16x32_bf16 v[212:215], a[148:151], v[152:155], v[212:215]
  ds_read_b64_tr_b16 a[144:145], v188 offset:28672
  s_add_u32 s26, s26, s28
  v_mfma_f32_16x16x32_bf16 v[216:219], a[148:151], v[156:159], v[216:219]
  ds_read_b64_tr_b16 a[146:147], v188 offset:30720
  s_waitcnt lgkmcnt(6)
  v_mfma_f32_16x16x32_bf16 v[220:223], a[152:155], v[152:155], v[220:223]
  ds_read_b64_tr_b16 a[148:149], v189 offset:28672
  buffer_load_dwordx4 a[68:71], v253, s[4:7], s77 offen offset:1024 sc1
  v_mfma_f32_16x16x32_bf16 v[224:227], a[152:155], v[156:159], v[224:227]
  ds_read_b64_tr_b16 a[150:151], v189 offset:30720
  v_mfma_f32_16x16x32_bf16 v[228:231], a[156:159], v[152:155], v[228:231]
  ds_read_b64_tr_b16 a[152:153], v186 offset:32768
  s_add_u32 m0, s24, 0x1d000
  v_mfma_f32_16x16x32_bf16 v[232:235], a[156:159], v[156:159], v[232:235]
  ds_read_b64_tr_b16 a[154:155], v186 offset:34816
  s_waitcnt lgkmcnt(6)
  v_mfma_f32_16x16x32_bf16 v[204:207], a[160:163], v[160:163], v[204:207]
  ds_read_b64_tr_b16 a[156:157], v187 offset:32768
  buffer_load_dwordx4 v176, s[12:15], s26 offen offset:0 lds
  v_mfma_f32_16x16x32_bf16 v[208:211], a[160:163], v[164:167], v[208:211]
  ds_read_b64_tr_b16 a[158:159], v187 offset:34816
  s_add_u32 s26, s26, s30
  v_mfma_f32_16x16x32_bf16 v[212:215], a[164:167], v[160:163], v[212:215]
  ds_read_b64_tr_b16 a[160:161], v188 offset:32768
  v_mfma_f32_16x16x32_bf16 v[216:219], a[164:167], v[164:167], v[216:219]
  ds_read_b64_tr_b16 a[162:163], v188 offset:34816
  s_waitcnt lgkmcnt(6)
  v_mfma_f32_16x16x32_bf16 v[220:223], a[144:147], v[160:163], v[220:223]
  ds_read_b64_tr_b16 a[164:165], v189 offset:32768
  v_mfma_f32_16x16x32_bf16 v[224:227], a[144:147], v[164:167], v[224:227]
  ds_read_b64_tr_b16 a[166:167], v189 offset:34816
  s_waitcnt vmcnt(32)
  s_barrier
  v_mfma_f32_16x16x32_bf16 v[228:231], a[148:151], v[160:163], v[228:231]
  ds_read_b64_tr_b16 a[144:145], v186 offset:36864
  v_mfma_f32_16x16x32_bf16 v[232:235], a[148:151], v[164:167], v[232:235]
  ds_read_b64_tr_b16 a[146:147], v186 offset:38912
  s_waitcnt lgkmcnt(6)
  v_mfma_f32_16x16x32_bf16 v[204:207], a[152:155], v[168:171], v[204:207]
  ds_read_b64_tr_b16 a[148:149], v187 offset:36864
  v_mfma_f32_16x16x32_bf16 v[208:211], a[152:155], v[172:175], v[208:211]
  ds_read_b64_tr_b16 a[150:151], v187 offset:38912
  v_mfma_f32_16x16x32_bf16 v[212:215], a[156:159], v[168:171], v[212:215]
  ds_read_b64_tr_b16 a[152:153], v188 offset:36864
  v_mfma_f32_16x16x32_bf16 v[216:219], a[156:159], v[172:175], v[216:219]
  ds_read_b64_tr_b16 a[154:155], v188 offset:38912
  s_waitcnt lgkmcnt(6)
  v_mfma_f32_16x16x32_bf16 v[220:223], a[160:163], v[168:171], v[220:223]
  ds_read_b64_tr_b16 a[156:157], v189 offset:36864
  v_mfma_f32_16x16x32_bf16 v[224:227], a[160:163], v[172:175], v[224:227]
  ds_read_b64_tr_b16 a[158:159], v189 offset:38912
  v_mfma_f32_16x16x32_bf16 v[228:231], a[164:167], v[168:171], v[228:231]
  ds_read_b64_tr_b16 a[160:161], v186 offset:40960
  s_waitcnt vmcnt(43)
  v_mfma_f32_16x16x32_bf16 v[232:235], a[164:167], v[172:175], v[232:235]
  ds_read_b64_tr_b16 a[162:163], v186 offset:43008
  s_waitcnt lgkmcnt(6)
  v_mfma_f32_16x16x32_bf16 v[32:35], a[144:147], a[0:3], v[32:35]
  ds_read_b64_tr_b16 a[164:165], v187 offset:40960
  v_mfma_f32_16x16x32_bf16 v[36:39], a[144:147], a[4:7], v[36:39]
  ds_read_b64_tr_b16 a[166:167], v187 offset:43008
  s_add_u32 m0, s24, 0x0
  v_mfma_f32_16x16x32_bf16 v[40:43], a[148:151], a[0:3], v[40:43]
  ds_read_b64_tr_b16 a[144:145], v188 offset:40960
  buffer_load_dwordx4 v176, s[12:15], s26 offen offset:0 lds
  v_mfma_f32_16x16x32_bf16 v[44:47], a[148:151], a[4:7], v[44:47]
  ds_read_b64_tr_b16 a[146:147], v188 offset:43008
  s_waitcnt lgkmcnt(6)
  v_mfma_f32_16x16x32_bf16 v[48:51], a[152:155], a[0:3], v[48:51]
  ds_read_b64_tr_b16 a[148:149], v189 offset:40960
  v_mfma_f32_16x16x32_bf16 v[52:55], a[152:155], a[4:7], v[52:55]
  ds_read_b64_tr_b16 a[150:151], v189 offset:43008
  v_mfma_f32_16x16x32_bf16 v[56:59], a[156:159], a[0:3], v[56:59]
  ds_read_b64_tr_b16 a[152:153], v186 offset:45056
  s_waitcnt vmcnt(38)
  v_mfma_f32_16x16x32_bf16 v[60:63], a[156:159], a[4:7], v[60:63]
  ds_read_b64_tr_b16 a[154:155], v186 offset:47104
  s_waitcnt lgkmcnt(6)
  v_mfma_f32_16x16x32_bf16 v[32:35], a[160:163], a[8:11], v[32:35]
  ds_read_b64_tr_b16 a[156:157], v187 offset:45056
  v_mfma_f32_16x16x32_bf16 v[36:39], a[160:163], a[12:15], v[36:39]
  ds_read_b64_tr_b16 a[158:159], v187 offset:47104
  buffer_load_dwordx4 v177, s[12:15], s26 offen offset:1024 lds
  v_mfma_f32_16x16x32_bf16 v[40:43], a[164:167], a[8:11], v[40:43]
  ds_read_b64_tr_b16 a[160:161], v188 offset:45056
  v_mfma_f32_16x16x32_bf16 v[44:47], a[164:167], a[12:15], v[44:47]
  ds_read_b64_tr_b16 a[162:163], v188 offset:47104
  s_waitcnt lgkmcnt(6)
  v_mfma_f32_16x16x32_bf16 v[48:51], a[144:147], a[8:11], v[48:51]
  ds_read_b64_tr_b16 a[164:165], v189 offset:45056
  v_mfma_f32_16x16x32_bf16 v[52:55], a[144:147], a[12:15], v[52:55]
  ds_read_b64_tr_b16 a[166:167], v189 offset:47104
  v_mfma_f32_16x16x32_bf16 v[56:59], a[148:151], a[8:11], v[56:59]
  ds_read_b64_tr_b16 a[144:145], v190 offset:0
  s_waitcnt vmcnt(31)
  v_mfma_f32_16x16x32_bf16 v[60:63], a[148:151], a[12:15], v[60:63]
  ds_read_b64_tr_b16 a[146:147], v190 offset:2048
  s_waitcnt lgkmcnt(6)
  v_mfma_f32_16x16x32_bf16 v[32:35], a[152:155], a[16:19], v[32:35]
  ds_read_b64_tr_b16 a[148:149], v191 offset:0
  buffer_load_dwordx4 v178, s[12:15], s26 offen offset:2048 lds
  v_mfma_f32_16x16x32_bf16 v[36:39], a[152:155], a[20:23], v[36:39]
  ds_read_b64_tr_b16 a[150:151], v191 offset:2048
  v_mfma_f32_16x16x32_bf16 v[40:43], a[156:159], a[16:19], v[40:43]
  ds_read_b64_tr_b16 a[152:153], v192 offset:0
  v_mfma_f32_16x16x32_bf16 v[44:47], a[156:159], a[20:23], v[44:47]
  ds_read_b64_tr_b16 a[154:155], v192 offset:2048
  s_waitcnt lgkmcnt(6)
  v_mfma_f32_16x16x32_bf16 v[48:51], a[160:163], a[16:19], v[48:51]
  ds_read_b64_tr_b16 a[156:157], v193 offset:0
  v_mfma_f32_16x16x32_bf16 v[52:55], a[160:163], a[20:23], v[52:55]
  ds_read_b64_tr_b16 a[158:159], v193 offset:2048
  v_mfma_f32_16x16x32_bf16 v[56:59], a[164:167], a[16:19], v[56:59]
  ds_read_b64_tr_b16 a[160:161], v190 offset:4096
  buffer_load_dwordx4 v179, s[12:15], s26 offen offset:3072 lds
  s_waitcnt vmcnt(29)
  v_mfma_f32_16x16x32_bf16 v[60:63], a[164:167], a[20:23], v[60:63]
  ds_read_b64_tr_b16 a[162:163], v190 offset:6144
  s_waitcnt lgkmcnt(6)
  v_mfma_f32_16x16x32_bf16 v[32:35], a[144:147], a[24:27], v[32:35]
  ds_read_b64_tr_b16 a[164:165], v191 offset:4096
  s_add_u32 s26, s26, s79
  v_mfma_f32_16x16x32_bf16 v[36:39], a[144:147], a[28:31], v[36:39]
  ds_read_b64_tr_b16 a[166:167], v191 offset:6144
  v_mfma_f32_16x16x32_bf16 v[40:43], a[148:151], a[24:27], v[40:43]
  ds_read_b64_tr_b16 a[144:145], v192 offset:4096
  v_mfma_f32_16x16x32_bf16 v[44:47], a[148:151], a[28:31], v[44:47]
  ds_read_b64_tr_b16 a[146:147], v192 offset:6144
  s_waitcnt lgkmcnt(6)
  v_mfma_f32_16x16x32_bf16 v[48:51], a[152:155], a[24:27], v[48:51]
  ds_read_b64_tr_b16 a[148:149], v193 offset:4096
  s_add_u32 m0, s24, 0x1000
  v_mfma_f32_16x16x32_bf16 v[52:55], a[152:155], a[28:31], v[52:55]
  ds_read_b64_tr_b16 a[150:151], v193 offset:6144
  buffer_load_dwordx4 v176, s[12:15], s26 offen offset:0 lds
  v_mfma_f32_16x16x32_bf16 v[56:59], a[156:159], a[24:27], v[56:59]
  ds_read_b64_tr_b16 a[152:153], v190 offset:8192
  s_waitcnt vmcnt(25)
  v_mfma_f32_16x16x32_bf16 v[60:63], a[156:159], a[28:31], v[60:63]
  ds_read_b64_tr_b16 a[154:155], v190 offset:10240
  s_waitcnt lgkmcnt(6)
  v_mfma_f32_16x16x32_bf16 v[32:35], a[160:163], a[32:35], v[32:35]
  ds_read_b64_tr_b16 a[156:157], v191 offset:8192
  v_mfma_f32_16x16x32_bf16 v[36:39], a[160:163], a[36:39], v[36:39]
  ds_read_b64_tr_b16 a[158:159], v191 offset:10240
  v_mfma_f32_16x16x32_bf16 v[40:43], a[164:167], a[32:35], v[40:43]
  ds_read_b64_tr_b16 a[160:161], v192 offset:8192
  v_mfma_f32_16x16x32_bf16 v[44:47], a[164:167], a[36:39], v[44:47]
  ds_read_b64_tr_b16 a[162:163], v192 offset:10240
  s_waitcnt lgkmcnt(6)
  v_mfma_f32_16x16x32_bf16 v[48:51], a[144:147], a[32:35], v[48:51]
  ds_read_b64_tr_b16 a[164:165], v193 offset:8192
  buffer_load_dwordx4 v177, s[12:15], s26 offen offset:1024 lds
  v_mfma_f32_16x16x32_bf16 v[52:55], a[144:147], a[36:39], v[52:55]
  ds_read_b64_tr_b16 a[166:167], v193 offset:10240
  v_mfma_f32_16x16x32_bf16 v[56:59], a[148:151], a[32:35], v[56:59]
  ds_read_b64_tr_b16 a[144:145], v190 offset:12288
  s_waitcnt vmcnt(19)
  v_mfma_f32_16x16x32_bf16 v[60:63], a[148:151], a[36:39], v[60:63]
  ds_read_b64_tr_b16 a[146:147], v190 offset:14336
  s_waitcnt lgkmcnt(6)
  v_mfma_f32_16x16x32_bf16 v[32:35], a[152:155], a[40:43], v[32:35]
  ds_read_b64_tr_b16 a[148:149], v191 offset:12288
  v_mfma_f32_16x16x32_bf16 v[36:39], a[152:155], a[44:47], v[36:39]
  ds_read_b64_tr_b16 a[150:151], v191 offset:14336
  v_mfma_f32_16x16x32_bf16 v[40:43], a[156:159], a[40:43], v[40:43]
  ds_read_b64_tr_b16 a[152:153], v192 offset:12288
  buffer_load_dwordx4 v178, s[12:15], s26 offen offset:2048 lds
  v_mfma_f32_16x16x32_bf16 v[44:47], a[156:159], a[44:47], v[44:47]
  ds_read_b64_tr_b16 a[154:155], v192 offset:14336
  s_waitcnt lgkmcnt(6)
  v_mfma_f32_16x16x32_bf16 v[48:51], a[160:163], a[40:43], v[48:51]
  ds_read_b64_tr_b16 a[156:157], v193 offset:12288
  v_mfma_f32_16x16x32_bf16 v[52:55], a[160:163], a[44:47], v[52:55]
  ds_read_b64_tr_b16 a[158:159], v193 offset:14336
  v_mfma_f32_16x16x32_bf16 v[56:59], a[164:167], a[40:43], v[56:59]
  ds_read_b64_tr_b16 a[160:161], v190 offset:16384
  s_waitcnt vmcnt(16)
  v_mfma_f32_16x16x32_bf16 v[60:63], a[164:167], a[44:47], v[60:63]
  ds_read_b64_tr_b16 a[162:163], v190 offset:18432
  s_waitcnt lgkmcnt(6)
  v_mfma_f32_16x16x32_bf16 v[32:35], a[144:147], a[48:51], v[32:35]
  ds_read_b64_tr_b16 a[164:165], v191 offset:16384
  v_mfma_f32_16x16x32_bf16 v[36:39], a[144:147], a[52:55], v[36:39]
  ds_read_b64_tr_b16 a[166:167], v191 offset:18432
  buffer_load_dwordx4 v179, s[12:15], s26 offen offset:3072 lds
  v_mfma_f32_16x16x32_bf16 v[40:43], a[148:151], a[48:51], v[40:43]
  ds_read_b64_tr_b16 a[144:145], v192 offset:16384
  s_add_u32 s26, s26, s28
  v_mfma_f32_16x16x32_bf16 v[44:47], a[148:151], a[52:55], v[44:47]
  ds_read_b64_tr_b16 a[146:147], v192 offset:18432
  s_waitcnt lgkmcnt(6)
  v_mfma_f32_16x16x32_bf16 v[48:51], a[152:155], a[48:51], v[48:51]
  ds_read_b64_tr_b16 a[148:149], v193 offset:16384
  v_mfma_f32_16x16x32_bf16 v[52:55], a[152:155], a[52:55], v[52:55]
  ds_read_b64_tr_b16 a[150:151], v193 offset:18432
  v_mfma_f32_16x16x32_bf16 v[56:59], a[156:159], a[48:51], v[56:59]
  ds_read_b64_tr_b16 a[152:153], v190 offset:20480
  s_add_u32 m0, s24, 0x2000
  s_waitcnt vmcnt(13)
  v_mfma_f32_16x16x32_bf16 v[60:63], a[156:159], a[52:55], v[60:63]
  ds_read_b64_tr_b16 a[154:155], v190 offset:22528
  s_waitcnt lgkmcnt(6)
  v_mfma_f32_16x16x32_bf16 v[32:35], a[160:163], a[56:59], v[32:35]
  ds_read_b64_tr_b16 a[156:157], v191 offset:20480
  buffer_load_dwordx4 v176, s[12:15], s26 offen offset:0 lds
  v_mfma_f32_16x16x32_bf16 v[36:39], a[160:163], a[60:63], v[36:39]
  ds_read_b64_tr_b16 a[158:159], v191 offset:22528
  s_add_u32 s26, s26, s30
  v_mfma_f32_16x16x32_bf16 v[40:43], a[164:167], a[56:59], v[40:43]
  ds_read_b64_tr_b16 a[160:161], v192 offset:20480
  v_mfma_f32_16x16x32_bf16 v[44:47], a[164:167], a[60:63], v[44:47]
  ds_read_b64_tr_b16 a[162:163], v192 offset:22528
  s_waitcnt lgkmcnt(6)
  v_mfma_f32_16x16x32_bf16 v[48:51], a[144:147], a[56:59], v[48:51]
  ds_read_b64_tr_b16 a[164:165], v193 offset:20480
  v_mfma_f32_16x16x32_bf16 v[52:55], a[144:147], a[60:63], v[52:55]
  ds_read_b64_tr_b16 a[166:167], v193 offset:22528
  s_waitcnt vmcnt(26)
  s_barrier
  v_mfma_f32_16x16x32_bf16 v[56:59], a[148:151], a[56:59], v[56:59]
  ds_read_b64_tr_b16 a[144:145], v190 offset:24576
  s_waitcnt vmcnt(10)
  v_mfma_f32_16x16x32_bf16 v[60:63], a[148:151], a[60:63], v[60:63]
  ds_read_b64_tr_b16 a[146:147], v190 offset:26624
  s_waitcnt lgkmcnt(6)
  v_mfma_f32_16x16x32_bf16 v[32:35], a[152:155], a[64:67], v[32:35]
  ds_read_b64_tr_b16 a[148:149], v191 offset:24576
  v_mfma_f32_16x16x32_bf16 v[36:39], a[152:155], a[68:71], v[36:39]
  ds_read_b64_tr_b16 a[150:151], v191 offset:26624
  v_mfma_f32_16x16x32_bf16 v[40:43], a[156:159], a[64:67], v[40:43]
  ds_read_b64_tr_b16 a[152:153], v192 offset:24576
  v_mfma_f32_16x16x32_bf16 v[44:47], a[156:159], a[68:71], v[44:47]
  ds_read_b64_tr_b16 a[154:155], v192 offset:26624
  s_waitcnt lgkmcnt(6)
  v_mfma_f32_16x16x32_bf16 v[48:51], a[160:163], a[64:67], v[48:51]
  ds_read_b64_tr_b16 a[156:157], v193 offset:24576
  v_mfma_f32_16x16x32_bf16 v[52:55], a[160:163], a[68:71], v[52:55]
  ds_read_b64_tr_b16 a[158:159], v193 offset:26624
  v_mfma_f32_16x16x32_bf16 v[56:59], a[164:167], a[64:67], v[56:59]
  ds_read_b64_tr_b16 a[160:161], v190 offset:28672
  v_mfma_f32_16x16x32_bf16 v[60:63], a[164:167], a[68:71], v[60:63]
  ds_read_b64_tr_b16 a[162:163], v190 offset:30720
  s_waitcnt lgkmcnt(6)
  v_mfma_f32_16x16x32_bf16 v[64:67], a[144:147], a[0:3], v[64:67]
  ds_read_b64_tr_b16 a[164:165], v191 offset:28672
  v_mfma_f32_16x16x32_bf16 v[68:71], a[144:147], a[4:7], v[68:71]
  ds_read_b64_tr_b16 a[166:167], v191 offset:30720
  s_add_u32 m0, s24, 0x9000
  s_mov_b32 s25, 0
  v_mfma_f32_16x16x32_bf16 v[72:75], a[148:151], a[0:3], v[72:75]
  ds_read_b64_tr_b16 a[144:145], v192 offset:28672
  buffer_load_dwordx4 v236, s[12:15], s25 offen lds
  v_mfma_f32_16x16x32_bf16 v[76:79], a[148:151], a[4:7], v[76:79]
  ds_read_b64_tr_b16 a[146:147], v192 offset:30720
  s_waitcnt lgkmcnt(6)
  v_mfma_f32_16x16x32_bf16 v[80:83], a[152:155], a[0:3], v[80:83]
  ds_read_b64_tr_b16 a[148:149], v193 offset:28672
  v_mfma_f32_16x16x32_bf16 v[84:87], a[152:155], a[4:7], v[84:87]
  ds_read_b64_tr_b16 a[150:151], v193 offset:30720
  v_cvt_pk_bf16_f32 v32, v32, v33
  v_mfma_f32_16x16x32_bf16 v[88:91], a[156:159], a[0:3], v[88:91]
  ds_read_b64_tr_b16 a[152:153], v190 offset:32768
  v_cvt_pk_bf16_f32 v33, v34, v35
  v_mfma_f32_16x16x32_bf16 v[92:95], a[156:159], a[4:7], v[92:95]
  ds_read_b64_tr_b16 a[154:155], v190 offset:34816
  s_waitcnt lgkmcnt(6)
  v_mfma_f32_16x16x32_bf16 v[64:67], a[160:163], a[8:11], v[64:67]
  ds_read_b64_tr_b16 a[156:157], v191 offset:32768
  v_cvt_pk_bf16_f32 v34, v40, v41
  v_mfma_f32_16x16x32_bf16 v[68:71], a[160:163], a[12:15], v[68:71]
  ds_read_b64_tr_b16 a[158:159], v191 offset:34816
  v_cvt_pk_bf16_f32 v35, v42, v43
  v_mfma_f32_16x16x32_bf16 v[72:75], a[164:167], a[8:11], v[72:75]
  ds_read_b64_tr_b16 a[160:161], v192 offset:32768
  buffer_store_dwordx4 v[32:35], v253, s[4:7], s34 offen offset:0 sc1
  v_mfma_f32_16x16x32_bf16 v[76:79], a[164:167], a[12:15], v[76:79]
  ds_read_b64_tr_b16 a[162:163], v192 offset:34816
  s_waitcnt lgkmcnt(6)
  v_mfma_f32_16x16x32_bf16 v[80:83], a[144:147], a[8:11], v[80:83]
  ds_read_b64_tr_b16 a[164:165], v193 offset:32768
  v_cvt_pk_bf16_f32 v36, v36, v37
  v_mfma_f32_16x16x32_bf16 v[84:87], a[144:147], a[12:15], v[84:87]
  ds_read_b64_tr_b16 a[166:167], v193 offset:34816
  s_add_u32 m0, s24, 0x9400
  s_mov_b32 s25, 9216
  v_mfma_f32_16x16x32_bf16 v[88:91], a[148:151], a[8:11], v[88:91]
  ds_read_b64_tr_b16 a[144:145], v190 offset:36864
  buffer_load_dwordx4 v236, s[12:15], s25 offen lds
  v_mfma_f32_16x16x32_bf16 v[92:95], a[148:151], a[12:15], v[92:95]
  ds_read_b64_tr_b16 a[146:147], v190 offset:38912
  s_waitcnt lgkmcnt(6)
  v_mfma_f32_16x16x32_bf16 v[64:67], a[152:155], a[16:19], v[64:67]
  ds_read_b64_tr_b16 a[148:149], v191 offset:36864
  v_cvt_pk_bf16_f32 v37, v38, v39
  v_mfma_f32_16x16x32_bf16 v[68:71], a[152:155], a[20:23], v[68:71]
  ds_read_b64_tr_b16 a[150:151], v191 offset:38912
  v_cvt_pk_bf16_f32 v38, v44, v45
  v_mfma_f32_16x16x32_bf16 v[72:75], a[156:159], a[16:19], v[72:75]
  ds_read_b64_tr_b16 a[152:153], v192 offset:36864
  v_cvt_pk_bf16_f32 v39, v46, v47
  v_mfma_f32_16x16x32_bf16 v[76:79], a[156:159], a[20:23], v[76:79]
  ds_read_b64_tr_b16 a[154:155], v192 offset:38912
  s_waitcnt lgkmcnt(6)
  v_mfma_f32_16x16x32_bf16 v[80:83], a[160:163], a[16:19], v[80:83]
  ds_read_b64_tr_b16 a[156:157], v193 offset:36864
  buffer_store_dwordx4 v[36:39], v253, s[4:7], s34 offen offset:1024 sc1
  v_mfma_f32_16x16x32_bf16 v[84:87], a[160:163], a[20:23], v[84:87]
  ds_read_b64_tr_b16 a[158:159], v193 offset:38912
  v_cvt_pk_bf16_f32 v48, v48, v49
  v_mfma_f32_16x16x32_bf16 v[88:91], a[164:167], a[16:19], v[88:91]
  ds_read_b64_tr_b16 a[160:161], v190 offset:40960
  v_cvt_pk_bf16_f32 v49, v50, v51
  v_mfma_f32_16x16x32_bf16 v[92:95], a[164:167], a[20:23], v[92:95]
  ds_read_b64_tr_b16 a[162:163], v190 offset:43008
  s_waitcnt lgkmcnt(6)
  v_mfma_f32_16x16x32_bf16 v[64:67], a[144:147], a[24:27], v[64:67]
  ds_read_b64_tr_b16 a[164:165], v191 offset:40960
  v_cvt_pk_bf16_f32 v50, v56, v57
  v_mfma_f32_16x16x32_bf16 v[68:71], a[144:147], a[28:31], v[68:71]
  ds_read_b64_tr_b16 a[166:167], v191 offset:43008
  s_add_u32 m0, s24, 0x9800
  s_mov_b32 s25, 18432
  v_mfma_f32_16x16x32_bf16 v[72:75], a[148:151], a[24:27], v[72:75]
  ds_read_b64_tr_b16 a[144:145], v192 offset:40960
  buffer_load_dwordx4 v236, s[12:15], s25 offen lds
  v_mfma_f32_16x16x32_bf16 v[76:79], a[148:151], a[28:31], v[76:79]
  ds_read_b64_tr_b16 a[146:147], v192 offset:43008
  s_waitcnt lgkmcnt(6)
  v_mfma_f32_16x16x32_bf16 v[80:83], a[152:155], a[24:27], v[80:83]
  ds_read_b64_tr_b16 a[148:149], v193 offset:40960
  v_cvt_pk_bf16_f32 v51, v58, v59
  v_mfma_f32_16x16x32_bf16 v[84:87], a[152:155], a[28:31], v[84:87]
  ds_read_b64_tr_b16 a[150:151], v193 offset:43008
  buffer_store_dwordx4 v[48:51], v253, s[4:7], s34 offen offset:2048 sc1
  v_mfma_f32_16x16x32_bf16 v[88:91], a[156:159], a[24:27], v[88:91]
  ds_read_b64_tr_b16 a[152:153], v190 offset:45056
  v_cvt_pk_bf16_f32 v52, v52, v53
  v_mfma_f32_16x16x32_bf16 v[92:95], a[156:159], a[28:31], v[92:95]
  ds_read_b64_tr_b16 a[154:155], v190 offset:47104
  s_waitcnt lgkmcnt(6)
  v_mfma_f32_16x16x32_bf16 v[64:67], a[160:163], a[32:35], v[64:67]
  ds_read_b64_tr_b16 a[156:157], v191 offset:45056
  v_cvt_pk_bf16_f32 v53, v54, v55
  v_mfma_f32_16x16x32_bf16 v[68:71], a[160:163], a[36:39], v[68:71]
  ds_read_b64_tr_b16 a[158:159], v191 offset:47104
  v_cvt_pk_bf16_f32 v54, v60, v61
  v_mfma_f32_16x16x32_bf16 v[72:75], a[164:167], a[32:35], v[72:75]
  ds_read_b64_tr_b16 a[160:161], v192 offset:45056
  v_cvt_pk_bf16_f32 v55, v62, v63
  v_mfma_f32_16x16x32_bf16 v[76:79], a[164:167], a[36:39], v[76:79]
  ds_read_b64_tr_b16 a[162:163], v192 offset:47104
  s_waitcnt lgkmcnt(6)
  v_mfma_f32_16x16x32_bf16 v[80:83], a[144:147], a[32:35], v[80:83]
  ds_read_b64_tr_b16 a[164:165], v193 offset:45056
  buffer_store_dwordx4 v[52:55], v253, s[4:7], s34 offen offset:3072 sc1
  v_mfma_f32_16x16x32_bf16 v[84:87], a[144:147], a[36:39], v[84:87]
  ds_read_b64_tr_b16 a[166:167], v193 offset:47104
  s_add_u32 m0, s24, 0x9c00
  s_mov_b32 s25, 27648
  v_mfma_f32_16x16x32_bf16 v[88:91], a[148:151], a[32:35], v[88:91]
  ds_read_b64_tr_b16 a[144:145], v194 offset:0
  buffer_load_dwordx4 v236, s[12:15], s25 offen lds
  v_mfma_f32_16x16x32_bf16 v[92:95], a[148:151], a[36:39], v[92:95]
  ds_read_b64_tr_b16 a[146:147], v194 offset:2048
  s_waitcnt lgkmcnt(6)
  v_mfma_f32_16x16x32_bf16 v[64:67], a[152:155], a[40:43], v[64:67]
  ds_read_b64_tr_b16 a[148:149], v195 offset:0
  s_add_u32 s34, s34, 4096
  v_mfma_f32_16x16x32_bf16 v[68:71], a[152:155], a[44:47], v[68:71]
  ds_read_b64_tr_b16 a[150:151], v195 offset:2048
  v_mfma_f32_16x16x32_bf16 v[72:75], a[156:159], a[40:43], v[72:75]
  ds_read_b64_tr_b16 a[152:153], v196 offset:0
  v_mfma_f32_16x16x32_bf16 v[76:79], a[156:159], a[44:47], v[76:79]
  ds_read_b64_tr_b16 a[154:155], v196 offset:2048
  s_waitcnt lgkmcnt(6)
  v_mfma_f32_16x16x32_bf16 v[80:83], a[160:163], a[40:43], v[80:83]
  ds_read_b64_tr_b16 a[156:157], v197 offset:0
  v_mfma_f32_16x16x32_bf16 v[84:87], a[160:163], a[44:47], v[84:87]
  ds_read_b64_tr_b16 a[158:159], v197 offset:2048
  v_mfma_f32_16x16x32_bf16 v[88:91], a[164:167], a[40:43], v[88:91]
  ds_read_b64_tr_b16 a[160:161], v194 offset:4096
  v_mfma_f32_16x16x32_bf16 v[92:95], a[164:167], a[44:47], v[92:95]
  ds_read_b64_tr_b16 a[162:163], v194 offset:6144
  s_waitcnt lgkmcnt(6)
  v_mfma_f32_16x16x32_bf16 v[64:67], a[144:147], a[48:51], v[64:67]
  ds_read_b64_tr_b16 a[164:165], v195 offset:4096
  v_mfma_f32_16x16x32_bf16 v[68:71], a[144:147], a[52:55], v[68:71]
  ds_read_b64_tr_b16 a[166:167], v195 offset:6144
  s_add_u32 m0, s24, 0xa000
  s_mov_b32 s25, 0
  v_mfma_f32_16x16x32_bf16 v[72:75], a[148:151], a[48:51], v[72:75]
  ds_read_b64_tr_b16 a[144:145], v196 offset:4096
  buffer_load_dwordx4 v237, s[12:15], s25 offen lds
  v_mfma_f32_16x16x32_bf16 v[76:79], a[148:151], a[52:55], v[76:79]
  ds_read_b64_tr_b16 a[146:147], v196 offset:6144
  s_waitcnt lgkmcnt(6)
  v_mfma_f32_16x16x32_bf16 v[80:83], a[152:155], a[48:51], v[80:83]
  ds_read_b64_tr_b16 a[148:149], v197 offset:4096
  v_mfma_f32_16x16x32_bf16 v[84:87], a[152:155], a[52:55], v[84:87]
  ds_read_b64_tr_b16 a[150:151], v197 offset:6144
  v_mfma_f32_16x16x32_bf16 v[88:91], a[156:159], a[48:51], v[88:91]
  ds_read_b64_tr_b16 a[152:153], v194 offset:8192
  v_mfma_f32_16x16x32_bf16 v[92:95], a[156:159], a[52:55], v[92:95]
  ds_read_b64_tr_b16 a[154:155], v194 offset:10240
  s_waitcnt lgkmcnt(6)
  v_mfma_f32_16x16x32_bf16 v[64:67], a[160:163], a[56:59], v[64:67]
  ds_read_b64_tr_b16 a[156:157], v195 offset:8192
  v_mfma_f32_16x16x32_bf16 v[68:71], a[160:163], a[60:63], v[68:71]
  ds_read_b64_tr_b16 a[158:159], v195 offset:10240
  v_mfma_f32_16x16x32_bf16 v[72:75], a[164:167], a[56:59], v[72:75]
  ds_read_b64_tr_b16 a[160:161], v196 offset:8192
  v_mfma_f32_16x16x32_bf16 v[76:79], a[164:167], a[60:63], v[76:79]
  ds_read_b64_tr_b16 a[162:163], v196 offset:10240
  s_waitcnt lgkmcnt(6)
  v_mfma_f32_16x16x32_bf16 v[80:83], a[144:147], a[56:59], v[80:83]
  ds_read_b64_tr_b16 a[164:165], v197 offset:8192
  v_mfma_f32_16x16x32_bf16 v[84:87], a[144:147], a[60:63], v[84:87]
  ds_read_b64_tr_b16 a[166:167], v197 offset:10240
  s_waitcnt vmcnt(18)
  s_barrier
  v_mfma_f32_16x16x32_bf16 v[88:91], a[148:151], a[56:59], v[88:91]
  ds_read_b64_tr_b16 a[144:145], v194 offset:12288
  v_mfma_f32_16x16x32_bf16 v[92:95], a[148:151], a[60:63], v[92:95]
  ds_read_b64_tr_b16 a[146:147], v194 offset:14336
  s_waitcnt lgkmcnt(6)
  v_mfma_f32_16x16x32_bf16 v[64:67], a[152:155], a[64:67], v[64:67]
  ds_read_b64_tr_b16 a[148:149], v195 offset:12288
  v_mfma_f32_16x16x32_bf16 v[68:71], a[152:155], a[68:71], v[68:71]
  ds_read_b64_tr_b16 a[150:151], v195 offset:14336
  v_mfma_f32_16x16x32_bf16 v[72:75], a[156:159], a[64:67], v[72:75]
  ds_read_b64_tr_b16 a[152:153], v196 offset:12288
  v_mfma_f32_16x16x32_bf16 v[76:79], a[156:159], a[68:71], v[76:79]
  ds_read_b64_tr_b16 a[154:155], v196 offset:14336
  s_waitcnt lgkmcnt(6)
  v_mfma_f32_16x16x32_bf16 v[80:83], a[160:163], a[64:67], v[80:83]
  ds_read_b64_tr_b16 a[156:157], v197 offset:12288
  v_mfma_f32_16x16x32_bf16 v[84:87], a[160:163], a[68:71], v[84:87]
  ds_read_b64_tr_b16 a[158:159], v197 offset:14336
  v_mfma_f32_16x16x32_bf16 v[88:91], a[164:167], a[64:67], v[88:91]
  ds_read_b64_tr_b16 a[160:161], v194 offset:16384
  v_mfma_f32_16x16x32_bf16 v[92:95], a[164:167], a[68:71], v[92:95]
  ds_read_b64_tr_b16 a[162:163], v194 offset:18432
  s_waitcnt lgkmcnt(6)
  v_mfma_f32_16x16x32_bf16 v[0:3], a[144:147], a[0:3], v[0:3]
  ds_read_b64_tr_b16 a[164:165], v195 offset:16384
  v_mfma_f32_16x16x32_bf16 v[4:7], a[144:147], a[4:7], v[4:7]
  ds_read_b64_tr_b16 a[166:167], v195 offset:18432
  s_add_u32 m0, s24, 0xa400
  s_mov_b32 s25, 9216
  v_mfma_f32_16x16x32_bf16 v[8:11], a[148:151], a[0:3], v[8:11]
  ds_read_b64_tr_b16 a[144:145], v196 offset:16384
  buffer_load_dwordx4 v237, s[12:15], s25 offen lds
  v_mfma_f32_16x16x32_bf16 v[12:15], a[148:151], a[4:7], v[12:15]
  ds_read_b64_tr_b16 a[146:147], v196 offset:18432
  s_waitcnt lgkmcnt(6)
  v_mfma_f32_16x16x32_bf16 v[16:19], a[152:155], a[0:3], v[16:19]
  ds_read_b64_tr_b16 a[148:149], v197 offset:16384
  v_mfma_f32_16x16x32_bf16 v[20:23], a[152:155], a[4:7], v[20:23]
  ds_read_b64_tr_b16 a[150:151], v197 offset:18432
  v_cvt_pk_bf16_f32 v64, v64, v65
  v_mfma_f32_16x16x32_bf16 v[24:27], a[156:159], a[0:3], v[24:27]
  ds_read_b64_tr_b16 a[152:153], v194 offset:20480
  v_mfma_f32_16x16x32_bf16 v[28:31], a[156:159], a[4:7], v[28:31]
  ds_read_b64_tr_b16 a[154:155], v194 offset:22528
  s_waitcnt lgkmcnt(6)
  v_mfma_f32_16x16x32_bf16 v[0:3], a[160:163], a[8:11], v[0:3]
  ds_read_b64_tr_b16 a[156:157], v195 offset:20480
  v_cvt_pk_bf16_f32 v65, v66, v67
  v_mfma_f32_16x16x32_bf16 v[4:7], a[160:163], a[12:15], v[4:7]
  ds_read_b64_tr_b16 a[158:159], v195 offset:22528
  v_mfma_f32_16x16x32_bf16 v[8:11], a[164:167], a[8:11], v[8:11]
  ds_read_b64_tr_b16 a[160:161], v196 offset:20480
  v_cvt_pk_bf16_f32 v66, v72, v73
  v_mfma_f32_16x16x32_bf16 v[12:15], a[164:167], a[12:15], v[12:15]
  ds_read_b64_tr_b16 a[162:163], v196 offset:22528
  s_waitcnt lgkmcnt(6)
  v_mfma_f32_16x16x32_bf16 v[16:19], a[144:147], a[8:11], v[16:19]
  ds_read_b64_tr_b16 a[164:165], v197 offset:20480
  v_mfma_f32_16x16x32_bf16 v[20:23], a[144:147], a[12:15], v[20:23]
  ds_read_b64_tr_b16 a[166:167], v197 offset:22528
  s_add_u32 m0, s24, 0xa800
  s_mov_b32 s25, 18432
  v_mfma_f32_16x16x32_bf16 v[24:27], a[148:151], a[8:11], v[24:27]
  ds_read_b64_tr_b16 a[144:145], v194 offset:24576
  buffer_load_dwordx4 v237, s[12:15], s25 offen lds
  v_mfma_f32_16x16x32_bf16 v[28:31], a[148:151], a[12:15], v[28:31]
  ds_read_b64_tr_b16 a[146:147], v194 offset:26624
  s_waitcnt lgkmcnt(6)
  v_mfma_f32_16x16x32_bf16 v[0:3], a[152:155], a[16:19], v[0:3]
  ds_read_b64_tr_b16 a[148:149], v195 offset:24576
  v_cvt_pk_bf16_f32 v67, v74, v75
  v_mfma_f32_16x16x32_bf16 v[4:7], a[152:155], a[20:23], v[4:7]
  ds_read_b64_tr_b16 a[150:151], v195 offset:26624
  v_mfma_f32_16x16x32_bf16 v[8:11], a[156:159], a[16:19], v[8:11]
  ds_read_b64_tr_b16 a[152:153], v196 offset:24576
  buffer_store_dwordx4 v[64:67], v253, s[4:7], s34 offen offset:0 sc1
  v_mfma_f32_16x16x32_bf16 v[12:15], a[156:159], a[20:23], v[12:15]
  ds_read_b64_tr_b16 a[154:155], v196 offset:26624
  s_waitcnt lgkmcnt(6)
  v_mfma_f32_16x16x32_bf16 v[16:19], a[160:163], a[16:19], v[16:19]
  ds_read_b64_tr_b16 a[156:157], v197 offset:24576
  v_mfma_f32_16x16x32_bf16 v[20:23], a[160:163], a[20:23], v[20:23]
  ds_read_b64_tr_b16 a[158:159], v197 offset:26624
  v_cvt_pk_bf16_f32 v68, v68, v69
  v_mfma_f32_16x16x32_bf16 v[24:27], a[164:167], a[16:19], v[24:27]
  ds_read_b64_tr_b16 a[160:161], v194 offset:28672
  v_mfma_f32_16x16x32_bf16 v[28:31], a[164:167], a[20:23], v[28:31]
  ds_read_b64_tr_b16 a[162:163], v194 offset:30720
  s_waitcnt lgkmcnt(6)
  v_mfma_f32_16x16x32_bf16 v[0:3], a[144:147], a[24:27], v[0:3]
  ds_read_b64_tr_b16 a[164:165], v195 offset:28672
  v_cvt_pk_bf16_f32 v69, v70, v71
  v_mfma_f32_16x16x32_bf16 v[4:7], a[144:147], a[28:31], v[4:7]
  ds_read_b64_tr_b16 a[166:167], v195 offset:30720
  s_add_u32 m0, s24, 0xac00
  s_mov_b32 s25, 27648
  v_mfma_f32_16x16x32_bf16 v[8:11], a[148:151], a[24:27], v[8:11]
  ds_read_b64_tr_b16 a[144:145], v196 offset:28672
  buffer_load_dwordx4 v237, s[12:15], s25 offen lds
  v_mfma_f32_16x16x32_bf16 v[12:15], a[148:151], a[28:31], v[12:15]
  ds_read_b64_tr_b16 a[146:147], v196 offset:30720
  s_waitcnt lgkmcnt(6)
  v_mfma_f32_16x16x32_bf16 v[16:19], a[152:155], a[24:27], v[16:19]
  ds_read_b64_tr_b16 a[148:149], v197 offset:28672
  v_cvt_pk_bf16_f32 v70, v76, v77
  v_mfma_f32_16x16x32_bf16 v[20:23], a[152:155], a[28:31], v[20:23]
  ds_read_b64_tr_b16 a[150:151], v197 offset:30720
  v_mfma_f32_16x16x32_bf16 v[24:27], a[156:159], a[24:27], v[24:27]
  ds_read_b64_tr_b16 a[152:153], v194 offset:32768
  v_cvt_pk_bf16_f32 v71, v78, v79
  v_mfma_f32_16x16x32_bf16 v[28:31], a[156:159], a[28:31], v[28:31]
  ds_read_b64_tr_b16 a[154:155], v194 offset:34816
  s_waitcnt lgkmcnt(6)
  v_mfma_f32_16x16x32_bf16 v[0:3], a[160:163], a[32:35], v[0:3]
  ds_read_b64_tr_b16 a[156:157], v195 offset:32768
  v_mfma_f32_16x16x32_bf16 v[4:7], a[160:163], a[36:39], v[4:7]
  ds_read_b64_tr_b16 a[158:159], v195 offset:34816
  buffer_store_dwordx4 v[68:71], v253, s[4:7], s34 offen offset:1024 sc1
  v_mfma_f32_16x16x32_bf16 v[8:11], a[164:167], a[32:35], v[8:11]
  ds_read_b64_tr_b16 a[160:161], v196 offset:32768
  v_mfma_f32_16x16x32_bf16 v[12:15], a[164:167], a[36:39], v[12:15]
  ds_read_b64_tr_b16 a[162:163], v196 offset:34816
  s_waitcnt lgkmcnt(6)
  v_mfma_f32_16x16x32_bf16 v[16:19], a[144:147], a[32:35], v[16:19]
  ds_read_b64_tr_b16 a[164:165], v197 offset:32768
  v_cvt_pk_bf16_f32 v80, v80, v81
  v_mfma_f32_16x16x32_bf16 v[20:23], a[144:147], a[36:39], v[20:23]
  ds_read_b64_tr_b16 a[166:167], v197 offset:34816
  s_add_u32 m0, s24, 0xb000
  s_mov_b32 s25, 36864
  v_mfma_f32_16x16x32_bf16 v[24:27], a[148:151], a[32:35], v[24:27]
  ds_read_b64_tr_b16 a[144:145], v194 offset:36864
  buffer_load_dwordx4 v237, s[12:15], s25 offen lds
  v_mfma_f32_16x16x32_bf16 v[28:31], a[148:151], a[36:39], v[28:31]
  ds_read_b64_tr_b16 a[146:147], v194 offset:38912
  s_waitcnt lgkmcnt(6)
  v_mfma_f32_16x16x32_bf16 v[0:3], a[152:155], a[40:43], v[0:3]
  ds_read_b64_tr_b16 a[148:149], v195 offset:36864
  v_cvt_pk_bf16_f32 v81, v82, v83
  v_mfma_f32_16x16x32_bf16 v[4:7], a[152:155], a[44:47], v[4:7]
  ds_read_b64_tr_b16 a[150:151], v195 offset:38912
  v_mfma_f32_16x16x32_bf16 v[8:11], a[156:159], a[40:43], v[8:11]
  ds_read_b64_tr_b16 a[152:153], v196 offset:36864
  v_cvt_pk_bf16_f32 v82, v88, v89
  v_mfma_f32_16x16x32_bf16 v[12:15], a[156:159], a[44:47], v[12:15]
  ds_read_b64_tr_b16 a[154:155], v196 offset:38912
  s_waitcnt lgkmcnt(6)
  v_mfma_f32_16x16x32_bf16 v[16:19], a[160:163], a[40:43], v[16:19]
  ds_read_b64_tr_b16 a[156:157], v197 offset:36864
  v_mfma_f32_16x16x32_bf16 v[20:23], a[160:163], a[44:47], v[20:23]
  ds_read_b64_tr_b16 a[158:159], v197 offset:38912
  v_cvt_pk_bf16_f32 v83, v90, v91
  v_mfma_f32_16x16x32_bf16 v[24:27], a[164:167], a[40:43], v[24:27]
  ds_read_b64_tr_b16 a[160:161], v194 offset:40960
  v_mfma_f32_16x16x32_bf16 v[28:31], a[164:167], a[44:47], v[28:31]
  ds_read_b64_tr_b16 a[162:163], v194 offset:43008
  s_waitcnt lgkmcnt(6)
  v_mfma_f32_16x16x32_bf16 v[0:3], a[144:147], a[48:51], v[0:3]
  ds_read_b64_tr_b16 a[164:165], v195 offset:40960
  buffer_store_dwordx4 v[80:83], v253, s[4:7], s34 offen offset:2048 sc1
  v_mfma_f32_16x16x32_bf16 v[4:7], a[144:147], a[52:55], v[4:7]
  ds_read_b64_tr_b16 a[166:167], v195 offset:43008
  v_mfma_f32_16x16x32_bf16 v[8:11], a[148:151], a[48:51], v[8:11]
  ds_read_b64_tr_b16 a[144:145], v196 offset:40960
  v_cvt_pk_bf16_f32 v84, v84, v85
  v_mfma_f32_16x16x32_bf16 v[12:15], a[148:151], a[52:55], v[12:15]
  ds_read_b64_tr_b16 a[146:147], v196 offset:43008
  s_waitcnt lgkmcnt(6)
  v_mfma_f32_16x16x32_bf16 v[16:19], a[152:155], a[48:51], v[16:19]
  ds_read_b64_tr_b16 a[148:149], v197 offset:40960
  v_mfma_f32_16x16x32_bf16 v[20:23], a[152:155], a[52:55], v[20:23]
  ds_read_b64_tr_b16 a[150:151], v197 offset:43008
  v_cvt_pk_bf16_f32 v85, v86, v87
  v_mfma_f32_16x16x32_bf16 v[24:27], a[156:159], a[48:51], v[24:27]
  ds_read_b64_tr_b16 a[152:153], v194 offset:45056
  v_mfma_f32_16x16x32_bf16 v[28:31], a[156:159], a[52:55], v[28:31]
  ds_read_b64_tr_b16 a[154:155], v194 offset:47104
  s_waitcnt lgkmcnt(6)
  v_mfma_f32_16x16x32_bf16 v[0:3], a[160:163], a[56:59], v[0:3]
  ds_read_b64_tr_b16 a[156:157], v195 offset:45056
  v_cvt_pk_bf16_f32 v86, v92, v93
  v_mfma_f32_16x16x32_bf16 v[4:7], a[160:163], a[60:63], v[4:7]
  ds_read_b64_tr_b16 a[158:159], v195 offset:47104
  v_mfma_f32_16x16x32_bf16 v[8:11], a[164:167], a[56:59], v[8:11]
  ds_read_b64_tr_b16 a[160:161], v196 offset:45056
  v_cvt_pk_bf16_f32 v87, v94, v95
  v_mfma_f32_16x16x32_bf16 v[12:15], a[164:167], a[60:63], v[12:15]
  ds_read_b64_tr_b16 a[162:163], v196 offset:47104
  s_waitcnt lgkmcnt(6)
  v_mfma_f32_16x16x32_bf16 v[16:19], a[144:147], a[56:59], v[16:19]
  ds_read_b64_tr_b16 a[164:165], v197 offset:45056
  v_mfma_f32_16x16x32_bf16 v[20:23], a[144:147], a[60:63], v[20:23]
  ds_read_b64_tr_b16 a[166:167], v197 offset:47104
  buffer_store_dwordx4 v[84:87], v253, s[4:7], s34 offen offset:3072 sc1
  s_waitcnt vmcnt(17)
  s_barrier
  v_mfma_f32_16x16x32_bf16 v[24:27], a[148:151], a[56:59], v[24:27]
  ds_read_b64_tr_b16 a[144:145], v186 offset:0
  v_mfma_f32_16x16x32_bf16 v[28:31], a[148:151], a[60:63], v[28:31]
  ds_read_b64_tr_b16 a[146:147], v186 offset:2048
  s_waitcnt lgkmcnt(6)
  v_mfma_f32_16x16x32_bf16 v[0:3], a[152:155], a[64:67], v[0:3]
  ds_read_b64_tr_b16 a[148:149], v187 offset:0
  s_add_u32 s34, s34, 4096
  v_mfma_f32_16x16x32_bf16 v[4:7], a[152:155], a[68:71], v[4:7]
  ds_read_b64_tr_b16 a[150:151], v187 offset:2048
  v_mfma_f32_16x16x32_bf16 v[8:11], a[156:159], a[64:67], v[8:11]
  ds_read_b64_tr_b16 a[152:153], v188 offset:0
  v_mfma_f32_16x16x32_bf16 v[12:15], a[156:159], a[68:71], v[12:15]
  ds_read_b64_tr_b16 a[154:155], v188 offset:2048
  s_waitcnt lgkmcnt(6)
  v_mfma_f32_16x16x32_bf16 v[16:19], a[160:163], a[64:67], v[16:19]
  ds_read_b64_tr_b16 a[156:157], v189 offset:0
  v_mfma_f32_16x16x32_bf16 v[20:23], a[160:163], a[68:71], v[20:23]
  ds_read_b64_tr_b16 a[158:159], v189 offset:2048
  v_mfma_f32_16x16x32_bf16 v[24:27], a[164:167], a[64:67], v[24:27]
  ds_read_b64_tr_b16 a[160:161], v186 offset:4096
  v_mfma_f32_16x16x32_bf16 v[28:31], a[164:167], a[68:71], v[28:31]
  ds_read_b64_tr_b16 a[162:163], v186 offset:6144
  s_waitcnt lgkmcnt(6)
  v_mfma_f32_16x16x32_bf16 v[204:207], a[144:147], a[0:3], v[204:207]
  ds_read_b64_tr_b16 a[164:165], v187 offset:4096
  v_mfma_f32_16x16x32_bf16 v[208:211], a[144:147], a[4:7], v[208:211]
  ds_read_b64_tr_b16 a[166:167], v187 offset:6144
  v_mfma_f32_16x16x32_bf16 v[212:215], a[148:151], a[0:3], v[212:215]
  ds_read_b64_tr_b16 a[144:145], v188 offset:4096
  v_mfma_f32_16x16x32_bf16 v[216:219], a[148:151], a[4:7], v[216:219]
  ds_read_b64_tr_b16 a[146:147], v188 offset:6144
  s_waitcnt lgkmcnt(6)
  v_mfma_f32_16x16x32_bf16 v[220:223], a[152:155], a[0:3], v[220:223]
  ds_read_b64_tr_b16 a[148:149], v189 offset:4096
  v_mfma_f32_16x16x32_bf16 v[224:227], a[152:155], a[4:7], v[224:227]
  ds_read_b64_tr_b16 a[150:151], v189 offset:6144
  v_cvt_pk_bf16_f32 v0, v0, v1
  v_mfma_f32_16x16x32_bf16 v[228:231], a[156:159], a[0:3], v[228:231]
  ds_read_b64_tr_b16 a[152:153], v186 offset:8192
  v_mfma_f32_16x16x32_bf16 v[232:235], a[156:159], a[4:7], v[232:235]
  ds_read_b64_tr_b16 a[154:155], v186 offset:10240
  s_waitcnt lgkmcnt(6)
  v_mfma_f32_16x16x32_bf16 v[204:207], a[160:163], a[8:11], v[204:207]
  ds_read_b64_tr_b16 a[156:157], v187 offset:8192
  v_cvt_pk_bf16_f32 v1, v2, v3
  v_mfma_f32_16x16x32_bf16 v[208:211], a[160:163], a[12:15], v[208:211]
  ds_read_b64_tr_b16 a[158:159], v187 offset:10240
  v_mfma_f32_16x16x32_bf16 v[212:215], a[164:167], a[8:11], v[212:215]
  ds_read_b64_tr_b16 a[160:161], v188 offset:8192
  v_cvt_pk_bf16_f32 v2, v8, v9
  v_mfma_f32_16x16x32_bf16 v[216:219], a[164:167], a[12:15], v[216:219]
  ds_read_b64_tr_b16 a[162:163], v188 offset:10240
  s_waitcnt lgkmcnt(6)
  v_mfma_f32_16x16x32_bf16 v[220:223], a[144:147], a[8:11], v[220:223]
  ds_read_b64_tr_b16 a[164:165], v189 offset:8192
  v_mfma_f32_16x16x32_bf16 v[224:227], a[144:147], a[12:15], v[224:227]
  ds_read_b64_tr_b16 a[166:167], v189 offset:10240
  v_cvt_pk_bf16_f32 v3, v10, v11
  v_mfma_f32_16x16x32_bf16 v[228:231], a[148:151], a[8:11], v[228:231]
  ds_read_b64_tr_b16 a[144:145], v186 offset:12288
  v_mfma_f32_16x16x32_bf16 v[232:235], a[148:151], a[12:15], v[232:235]
  ds_read_b64_tr_b16 a[146:147], v186 offset:14336
  s_waitcnt lgkmcnt(6)
  v_mfma_f32_16x16x32_bf16 v[204:207], a[152:155], a[16:19], v[204:207]
  ds_read_b64_tr_b16 a[148:149], v187 offset:12288
  buffer_store_dwordx4 v[0:3], v253, s[4:7], s34 offen offset:0 sc1
  v_mfma_f32_16x16x32_bf16 v[208:211], a[152:155], a[20:23], v[208:211]
  ds_read_b64_tr_b16 a[150:151], v187 offset:14336
  v_mfma_f32_16x16x32_bf16 v[212:215], a[156:159], a[16:19], v[212:215]
  ds_read_b64_tr_b16 a[152:153], v188 offset:12288
  v_cvt_pk_bf16_f32 v4, v4, v5
  v_mfma_f32_16x16x32_bf16 v[216:219], a[156:159], a[20:23], v[216:219]
  ds_read_b64_tr_b16 a[154:155], v188 offset:14336
  s_waitcnt lgkmcnt(6)
  v_mfma_f32_16x16x32_bf16 v[220:223], a[160:163], a[16:19], v[220:223]
  ds_read_b64_tr_b16 a[156:157], v189 offset:12288
  v_mfma_f32_16x16x32_bf16 v[224:227], a[160:163], a[20:23], v[224:227]
  ds_read_b64_tr_b16 a[158:159], v189 offset:14336
  v_cvt_pk_bf16_f32 v5, v6, v7
  v_mfma_f32_16x16x32_bf16 v[228:231], a[164:167], a[16:19], v[228:231]
  ds_read_b64_tr_b16 a[160:161], v186 offset:16384
  v_mfma_f32_16x16x32_bf16 v[232:235], a[164:167], a[20:23], v[232:235]
  ds_read_b64_tr_b16 a[162:163], v186 offset:18432
  s_waitcnt lgkmcnt(6)
  v_mfma_f32_16x16x32_bf16 v[204:207], a[144:147], a[24:27], v[204:207]
  ds_read_b64_tr_b16 a[164:165], v187 offset:16384
  v_cvt_pk_bf16_f32 v6, v12, v13
  v_mfma_f32_16x16x32_bf16 v[208:211], a[144:147], a[28:31], v[208:211]
  ds_read_b64_tr_b16 a[166:167], v187 offset:18432
  v_mfma_f32_16x16x32_bf16 v[212:215], a[148:151], a[24:27], v[212:215]
  ds_read_b64_tr_b16 a[144:145], v188 offset:16384
  v_cvt_pk_bf16_f32 v7, v14, v15
  v_mfma_f32_16x16x32_bf16 v[216:219], a[148:151], a[28:31], v[216:219]
  ds_read_b64_tr_b16 a[146:147], v188 offset:18432
  s_waitcnt lgkmcnt(6)
  v_mfma_f32_16x16x32_bf16 v[220:223], a[152:155], a[24:27], v[220:223]
  ds_read_b64_tr_b16 a[148:149], v189 offset:16384
  v_mfma_f32_16x16x32_bf16 v[224:227], a[152:155], a[28:31], v[224:227]
  ds_read_b64_tr_b16 a[150:151], v189 offset:18432
  buffer_store_dwordx4 v[4:7], v253, s[4:7], s34 offen offset:1024 sc1
  v_mfma_f32_16x16x32_bf16 v[228:231], a[156:159], a[24:27], v[228:231]
  ds_read_b64_tr_b16 a[152:153], v186 offset:20480
  v_mfma_f32_16x16x32_bf16 v[232:235], a[156:159], a[28:31], v[232:235]
  ds_read_b64_tr_b16 a[154:155], v186 offset:22528
  s_waitcnt lgkmcnt(6)
  v_mfma_f32_16x16x32_bf16 v[204:207], a[160:163], a[32:35], v[204:207]
  ds_read_b64_tr_b16 a[156:157], v187 offset:20480
  v_cvt_pk_bf16_f32 v16, v16, v17
  v_mfma_f32_16x16x32_bf16 v[208:211], a[160:163], a[36:39], v[208:211]
  ds_read_b64_tr_b16 a[158:159], v187 offset:22528
  v_mfma_f32_16x16x32_bf16 v[212:215], a[164:167], a[32:35], v[212:215]
  ds_read_b64_tr_b16 a[160:161], v188 offset:20480
  v_cvt_pk_bf16_f32 v17, v18, v19
  v_mfma_f32_16x16x32_bf16 v[216:219], a[164:167], a[36:39], v[216:219]
  ds_read_b64_tr_b16 a[162:163], v188 offset:22528
  s_waitcnt lgkmcnt(6)
  v_mfma_f32_16x16x32_bf16 v[220:223], a[144:147], a[32:35], v[220:223]
  ds_read_b64_tr_b16 a[164:165], v189 offset:20480
  v_mfma_f32_16x16x32_bf16 v[224:227], a[144:147], a[36:39], v[224:227]
  ds_read_b64_tr_b16 a[166:167], v189 offset:22528
  v_cvt_pk_bf16_f32 v18, v24, v25
  v_mfma_f32_16x16x32_bf16 v[228:231], a[148:151], a[32:35], v[228:231]
  ds_read_b64_tr_b16 a[144:145], v186 offset:24576
  v_mfma_f32_16x16x32_bf16 v[232:235], a[148:151], a[36:39], v[232:235]
  ds_read_b64_tr_b16 a[146:147], v186 offset:26624
  s_waitcnt lgkmcnt(6)
  v_mfma_f32_16x16x32_bf16 v[204:207], a[152:155], a[40:43], v[204:207]
  ds_read_b64_tr_b16 a[148:149], v187 offset:24576
  v_cvt_pk_bf16_f32 v19, v26, v27
  v_mfma_f32_16x16x32_bf16 v[208:211], a[152:155], a[44:47], v[208:211]
  ds_read_b64_tr_b16 a[150:151], v187 offset:26624
  v_mfma_f32_16x16x32_bf16 v[212:215], a[156:159], a[40:43], v[212:215]
  ds_read_b64_tr_b16 a[152:153], v188 offset:24576
  buffer_store_dwordx4 v[16:19], v253, s[4:7], s34 offen offset:2048 sc1
  v_mfma_f32_16x16x32_bf16 v[216:219], a[156:159], a[44:47], v[216:219]
  ds_read_b64_tr_b16 a[154:155], v188 offset:26624
  s_waitcnt lgkmcnt(6)
  v_mfma_f32_16x16x32_bf16 v[220:223], a[160:163], a[40:43], v[220:223]
  ds_read_b64_tr_b16 a[156:157], v189 offset:24576
  v_mfma_f32_16x16x32_bf16 v[224:227], a[160:163], a[44:47], v[224:227]
  ds_read_b64_tr_b16 a[158:159], v189 offset:26624
  v_cvt_pk_bf16_f32 v20, v20, v21
  v_mfma_f32_16x16x32_bf16 v[228:231], a[164:167], a[40:43], v[228:231]
  ds_read_b64_tr_b16 a[160:161], v186 offset:28672
  v_mfma_f32_16x16x32_bf16 v[232:235], a[164:167], a[44:47], v[232:235]
  ds_read_b64_tr_b16 a[162:163], v186 offset:30720
  s_waitcnt lgkmcnt(6)
  v_mfma_f32_16x16x32_bf16 v[204:207], a[144:147], a[48:51], v[204:207]
  ds_read_b64_tr_b16 a[164:165], v187 offset:28672
  v_cvt_pk_bf16_f32 v21, v22, v23
  v_mfma_f32_16x16x32_bf16 v[208:211], a[144:147], a[52:55], v[208:211]
  ds_read_b64_tr_b16 a[166:167], v187 offset:30720
  v_mfma_f32_16x16x32_bf16 v[212:215], a[148:151], a[48:51], v[212:215]
  ds_read_b64_tr_b16 a[144:145], v188 offset:28672
  v_cvt_pk_bf16_f32 v22, v28, v29
  v_mfma_f32_16x16x32_bf16 v[216:219], a[148:151], a[52:55], v[216:219]
  ds_read_b64_tr_b16 a[146:147], v188 offset:30720
  s_waitcnt lgkmcnt(6)
  v_mfma_f32_16x16x32_bf16 v[220:223], a[152:155], a[48:51], v[220:223]
  ds_read_b64_tr_b16 a[148:149], v189 offset:28672
  v_mfma_f32_16x16x32_bf16 v[224:227], a[152:155], a[52:55], v[224:227]
  ds_read_b64_tr_b16 a[150:151], v189 offset:30720
  v_cvt_pk_bf16_f32 v23, v30, v31
  v_mfma_f32_16x16x32_bf16 v[228:231], a[156:159], a[48:51], v[228:231]
  ds_read_b64_tr_b16 a[152:153], v186 offset:32768
  v_mfma_f32_16x16x32_bf16 v[232:235], a[156:159], a[52:55], v[232:235]
  ds_read_b64_tr_b16 a[154:155], v186 offset:34816
  s_waitcnt lgkmcnt(6)
  v_mfma_f32_16x16x32_bf16 v[204:207], a[160:163], a[56:59], v[204:207]
  ds_read_b64_tr_b16 a[156:157], v187 offset:32768
  buffer_store_dwordx4 v[20:23], v253, s[4:7], s34 offen offset:3072 sc1
  v_mfma_f32_16x16x32_bf16 v[208:211], a[160:163], a[60:63], v[208:211]
  ds_read_b64_tr_b16 a[158:159], v187 offset:34816
  v_mfma_f32_16x16x32_bf16 v[212:215], a[164:167], a[56:59], v[212:215]
  ds_read_b64_tr_b16 a[160:161], v188 offset:32768
  s_add_u32 s34, s34, 4096
  v_mfma_f32_16x16x32_bf16 v[216:219], a[164:167], a[60:63], v[216:219]
  ds_read_b64_tr_b16 a[162:163], v188 offset:34816
  s_waitcnt lgkmcnt(6)
  v_mfma_f32_16x16x32_bf16 v[220:223], a[144:147], a[56:59], v[220:223]
  ds_read_b64_tr_b16 a[164:165], v189 offset:32768
  v_mfma_f32_16x16x32_bf16 v[224:227], a[144:147], a[60:63], v[224:227]
  ds_read_b64_tr_b16 a[166:167], v189 offset:34816
  s_waitcnt vmcnt(6)
  s_barrier
  v_mfma_f32_16x16x32_bf16 v[228:231], a[148:151], a[56:59], v[228:231]
  ds_read_b64_tr_b16 a[144:145], v186 offset:36864
  v_mfma_f32_16x16x32_bf16 v[232:235], a[148:151], a[60:63], v[232:235]
  ds_read_b64_tr_b16 a[146:147], v186 offset:38912
  s_waitcnt lgkmcnt(6)
  v_mfma_f32_16x16x32_bf16 v[204:207], a[152:155], a[64:67], v[204:207]
  ds_read_b64_tr_b16 a[148:149], v187 offset:36864
  v_mfma_f32_16x16x32_bf16 v[208:211], a[152:155], a[68:71], v[208:211]
  ds_read_b64_tr_b16 a[150:151], v187 offset:38912
  v_mfma_f32_16x16x32_bf16 v[212:215], a[156:159], a[64:67], v[212:215]
  ds_read_b64_tr_b16 a[152:153], v188 offset:36864
  v_mfma_f32_16x16x32_bf16 v[216:219], a[156:159], a[68:71], v[216:219]
  ds_read_b64_tr_b16 a[154:155], v188 offset:38912
  s_waitcnt lgkmcnt(6)
  v_mfma_f32_16x16x32_bf16 v[220:223], a[160:163], a[64:67], v[220:223]
  ds_read_b64_tr_b16 a[156:157], v189 offset:36864
  v_mfma_f32_16x16x32_bf16 v[224:227], a[160:163], a[68:71], v[224:227]
  ds_read_b64_tr_b16 a[158:159], v189 offset:38912
  v_mfma_f32_16x16x32_bf16 v[228:231], a[164:167], a[64:67], v[228:231]
  ds_read_b64_tr_b16 a[160:161], v186 offset:40960
  v_mfma_f32_16x16x32_bf16 v[232:235], a[164:167], a[68:71], v[232:235]
  ds_read_b64_tr_b16 a[162:163], v186 offset:43008
  s_waitcnt lgkmcnt(6)
  v_mfma_f32_16x16x32_bf16 v[32:35], a[144:147], v[104:107], 0
  ds_read_b64_tr_b16 a[164:165], v187 offset:40960
  v_mfma_f32_16x16x32_bf16 v[36:39], a[144:147], v[108:111], 0
  ds_read_b64_tr_b16 a[166:167], v187 offset:43008
  v_mfma_f32_16x16x32_bf16 v[40:43], a[148:151], v[104:107], 0
  ds_read_b64_tr_b16 a[144:145], v188 offset:40960
  v_mfma_f32_16x16x32_bf16 v[44:47], a[148:151], v[108:111], 0
  ds_read_b64_tr_b16 a[146:147], v188 offset:43008
  s_waitcnt lgkmcnt(6)
  v_mfma_f32_16x16x32_bf16 v[32:35], a[152:155], a[0:3], v[32:35]
  ds_read_b64_tr_b16 a[148:149], v189 offset:40960
  v_mfma_f32_16x16x32_bf16 v[36:39], a[152:155], a[4:7], v[36:39]
  ds_read_b64_tr_b16 a[150:151], v189 offset:43008
  v_cvt_pk_bf16_f32 v204, v204, v205
  v_mfma_f32_16x16x32_bf16 v[40:43], a[156:159], a[0:3], v[40:43]
  ds_read_b64_tr_b16 a[152:153], v186 offset:45056
  v_mfma_f32_16x16x32_bf16 v[44:47], a[156:159], a[4:7], v[44:47]
  ds_read_b64_tr_b16 a[154:155], v186 offset:47104
  s_waitcnt lgkmcnt(6)
  v_mfma_f32_16x16x32_bf16 v[32:35], a[160:163], v[112:115], v[32:35]
  ds_read_b64_tr_b16 a[156:157], v187 offset:45056
  v_cvt_pk_bf16_f32 v205, v206, v207
  v_mfma_f32_16x16x32_bf16 v[36:39], a[160:163], v[116:119], v[36:39]
  ds_read_b64_tr_b16 a[158:159], v187 offset:47104
  v_mfma_f32_16x16x32_bf16 v[40:43], a[164:167], v[112:115], v[40:43]
  ds_read_b64_tr_b16 a[160:161], v188 offset:45056
  v_cvt_pk_bf16_f32 v206, v212, v213
  v_mfma_f32_16x16x32_bf16 v[44:47], a[164:167], v[116:119], v[44:47]
  ds_read_b64_tr_b16 a[162:163], v188 offset:47104
  s_waitcnt lgkmcnt(6)
  v_mfma_f32_16x16x32_bf16 v[32:35], a[144:147], a[8:11], v[32:35]
  ds_read_b64_tr_b16 a[164:165], v189 offset:45056
  v_mfma_f32_16x16x32_bf16 v[36:39], a[144:147], a[12:15], v[36:39]
  ds_read_b64_tr_b16 a[166:167], v189 offset:47104
  v_cvt_pk_bf16_f32 v207, v214, v215
  v_mfma_f32_16x16x32_bf16 v[40:43], a[148:151], a[8:11], v[40:43]
  ds_read_b64_tr_b16 a[144:145], v190 offset:0
  v_mfma_f32_16x16x32_bf16 v[44:47], a[148:151], a[12:15], v[44:47]
  ds_read_b64_tr_b16 a[146:147], v190 offset:2048
  s_waitcnt lgkmcnt(6)
  v_mfma_f32_16x16x32_bf16 v[32:35], a[152:155], v[120:123], v[32:35]
  ds_read_b64_tr_b16 a[148:149], v191 offset:0
  buffer_store_dwordx4 v[204:207], v253, s[4:7], s34 offen offset:0 sc1
  v_mfma_f32_16x16x32_bf16 v[36:39], a[152:155], v[124:127], v[36:39]
  ds_read_b64_tr_b16 a[150:151], v191 offset:2048
  v_mfma_f32_16x16x32_bf16 v[40:43], a[156:159], v[120:123], v[40:43]
  ds_read_b64_tr_b16 a[152:153], v192 offset:0
  v_cvt_pk_bf16_f32 v208, v208, v209
  v_mfma_f32_16x16x32_bf16 v[44:47], a[156:159], v[124:127], v[44:47]
  ds_read_b64_tr_b16 a[154:155], v192 offset:2048
  s_waitcnt lgkmcnt(6)
  v_mfma_f32_16x16x32_bf16 v[32:35], a[160:163], a[16:19], v[32:35]
  ds_read_b64_tr_b16 a[156:157], v193 offset:0
  v_mfma_f32_16x16x32_bf16 v[36:39], a[160:163], a[20:23], v[36:39]
  ds_read_b64_tr_b16 a[158:159], v193 offset:2048
  v_cvt_pk_bf16_f32 v209, v210, v211
  v_mfma_f32_16x16x32_bf16 v[40:43], a[164:167], a[16:19], v[40:43]
  ds_read_b64_tr_b16 a[160:161], v190 offset:4096
  v_mfma_f32_16x16x32_bf16 v[44:47], a[164:167], a[20:23], v[44:47]
  ds_read_b64_tr_b16 a[162:163], v190 offset:6144
  s_waitcnt lgkmcnt(6)
  v_mfma_f32_16x16x32_bf16 v[32:35], a[144:147], v[128:131], v[32:35]
  ds_read_b64_tr_b16 a[164:165], v191 offset:4096
  v_cvt_pk_bf16_f32 v210, v216, v217
  v_mfma_f32_16x16x32_bf16 v[36:39], a[144:147], v[132:135], v[36:39]
  ds_read_b64_tr_b16 a[166:167], v191 offset:6144
  v_mfma_f32_16x16x32_bf16 v[40:43], a[148:151], v[128:131], v[40:43]
  ds_read_b64_tr_b16 a[144:145], v192 offset:4096
  v_cvt_pk_bf16_f32 v211, v218, v219
  v_mfma_f32_16x16x32_bf16 v[44:47], a[148:151], v[132:135], v[44:47]
  ds_read_b64_tr_b16 a[146:147], v192 offset:6144
  s_waitcnt lgkmcnt(6)
  v_mfma_f32_16x16x32_bf16 v[32:35], a[152:155], a[24:27], v[32:35]
  ds_read_b64_tr_b16 a[148:149], v193 offset:4096
  v_mfma_f32_16x16x32_bf16 v[36:39], a[152:155], a[28:31], v[36:39]
  ds_read_b64_tr_b16 a[150:151], v193 offset:6144
  buffer_store_dwordx4 v[208:211], v253, s[4:7], s34 offen offset:1024 sc1
  v_mfma_f32_16x16x32_bf16 v[40:43], a[156:159], a[24:27], v[40:43]
  ds_read_b64_tr_b16 a[152:153], v190 offset:8192
  v_mfma_f32_16x16x32_bf16 v[44:47], a[156:159], a[28:31], v[44:47]
  ds_read_b64_tr_b16 a[154:155], v190 offset:10240
  s_waitcnt lgkmcnt(6)
  v_mfma_f32_16x16x32_bf16 v[32:35], a[160:163], v[136:139], v[32:35]
  ds_read_b64_tr_b16 a[156:157], v191 offset:8192
  v_cvt_pk_bf16_f32 v220, v220, v221
  v_mfma_f32_16x16x32_bf16 v[36:39], a[160:163], v[140:143], v[36:39]
  ds_read_b64_tr_b16 a[158:159], v191 offset:10240
  v_mfma_f32_16x16x32_bf16 v[40:43], a[164:167], v[136:139], v[40:43]
  ds_read_b64_tr_b16 a[160:161], v192 offset:8192
  v_cvt_pk_bf16_f32 v221, v222, v223
  v_mfma_f32_16x16x32_bf16 v[44:47], a[164:167], v[140:143], v[44:47]
  ds_read_b64_tr_b16 a[162:163], v192 offset:10240
  s_waitcnt lgkmcnt(6)
  v_mfma_f32_16x16x32_bf16 v[32:35], a[144:147], a[32:35], v[32:35]
  ds_read_b64_tr_b16 a[164:165], v193 offset:8192
  v_mfma_f32_16x16x32_bf16 v[36:39], a[144:147], a[36:39], v[36:39]
  ds_read_b64_tr_b16 a[166:167], v193 offset:10240
  v_cvt_pk_bf16_f32 v222, v228, v229
  v_mfma_f32_16x16x32_bf16 v[40:43], a[148:151], a[32:35], v[40:43]
  ds_read_b64_tr_b16 a[144:145], v190 offset:12288
  v_mfma_f32_16x16x32_bf16 v[44:47], a[148:151], a[36:39], v[44:47]
  ds_read_b64_tr_b16 a[146:147], v190 offset:14336
  s_waitcnt lgkmcnt(6)
  v_mfma_f32_16x16x32_bf16 v[32:35], a[152:155], v[144:147], v[32:35]
  ds_read_b64_tr_b16 a[148:149], v191 offset:12288
  v_cvt_pk_bf16_f32 v223, v230, v231
  v_mfma_f32_16x16x32_bf16 v[36:39], a[152:155], v[148:151], v[36:39]
  ds_read_b64_tr_b16 a[150:151], v191 offset:14336
  v_mfma_f32_16x16x32_bf16 v[40:43], a[156:159], v[144:147], v[40:43]
  ds_read_b64_tr_b16 a[152:153], v192 offset:12288
  buffer_store_dwordx4 v[220:223], v253, s[4:7], s34 offen offset:2048 sc1
  v_mfma_f32_16x16x32_bf16 v[44:47], a[156:159], v[148:151], v[44:47]
  ds_read_b64_tr_b16 a[154:155], v192 offset:14336
  s_waitcnt lgkmcnt(6)
  v_mfma_f32_16x16x32_bf16 v[32:35], a[160:163], a[40:43], v[32:35]
  ds_read_b64_tr_b16 a[156:157], v193 offset:12288
  v_mfma_f32_16x16x32_bf16 v[36:39], a[160:163], a[44:47], v[36:39]
  ds_read_b64_tr_b16 a[158:159], v193 offset:14336
  v_cvt_pk_bf16_f32 v224, v224, v225
  v_mfma_f32_16x16x32_bf16 v[40:43], a[164:167], a[40:43], v[40:43]
  ds_read_b64_tr_b16 a[160:161], v190 offset:16384
  v_mfma_f32_16x16x32_bf16 v[44:47], a[164:167], a[44:47], v[44:47]
  ds_read_b64_tr_b16 a[162:163], v190 offset:18432
  s_waitcnt lgkmcnt(6)
  v_mfma_f32_16x16x32_bf16 v[32:35], a[144:147], v[152:155], v[32:35]
  ds_read_b64_tr_b16 a[164:165], v191 offset:16384
  v_cvt_pk_bf16_f32 v225, v226, v227
  v_mfma_f32_16x16x32_bf16 v[36:39], a[144:147], v[156:159], v[36:39]
  ds_read_b64_tr_b16 a[166:167], v191 offset:18432
  v_mfma_f32_16x16x32_bf16 v[40:43], a[148:151], v[152:155], v[40:43]
  ds_read_b64_tr_b16 a[144:145], v192 offset:16384
  v_cvt_pk_bf16_f32 v226, v232, v233
  v_mfma_f32_16x16x32_bf16 v[44:47], a[148:151], v[156:159], v[44:47]
  ds_read_b64_tr_b16 a[146:147], v192 offset:18432
  s_waitcnt lgkmcnt(6)
  v_mfma_f32_16x16x32_bf16 v[32:35], a[152:155], a[48:51], v[32:35]
  ds_read_b64_tr_b16 a[148:149], v193 offset:16384
  v_mfma_f32_16x16x32_bf16 v[36:39], a[152:155], a[52:55], v[36:39]
  ds_read_b64_tr_b16 a[150:151], v193 offset:18432
  v_cvt_pk_bf16_f32 v227, v234, v235
  v_mfma_f32_16x16x32_bf16 v[40:43], a[156:159], a[48:51], v[40:43]
  ds_read_b64_tr_b16 a[152:153], v190 offset:20480
  v_mfma_f32_16x16x32_bf16 v[44:47], a[156:159], a[52:55], v[44:47]
  ds_read_b64_tr_b16 a[154:155], v190 offset:22528
  s_waitcnt lgkmcnt(6)
  v_mfma_f32_16x16x32_bf16 v[32:35], a[160:163], v[160:163], v[32:35]
  ds_read_b64_tr_b16 a[156:157], v191 offset:20480
  buffer_store_dwordx4 v[224:227], v253, s[4:7], s34 offen offset:3072 sc1
  v_mfma_f32_16x16x32_bf16 v[36:39], a[160:163], v[164:167], v[36:39]
  ds_read_b64_tr_b16 a[158:159], v191 offset:22528
  v_mfma_f32_16x16x32_bf16 v[40:43], a[164:167], v[160:163], v[40:43]
  ds_read_b64_tr_b16 a[160:161], v192 offset:20480
  s_add_u32 s34, s34, 4096
  v_mfma_f32_16x16x32_bf16 v[44:47], a[164:167], v[164:167], v[44:47]
  ds_read_b64_tr_b16 a[162:163], v192 offset:22528
  s_waitcnt lgkmcnt(6)
  v_mfma_f32_16x16x32_bf16 v[32:35], a[144:147], a[56:59], v[32:35]
  ds_read_b64_tr_b16 a[164:165], v193 offset:20480
  v_mfma_f32_16x16x32_bf16 v[36:39], a[144:147], a[60:63], v[36:39]
  ds_read_b64_tr_b16 a[166:167], v193 offset:22528
  v_mfma_f32_16x16x32_bf16 v[40:43], a[148:151], a[56:59], v[40:43]
  v_mfma_f32_16x16x32_bf16 v[44:47], a[148:151], a[60:63], v[44:47]
  s_waitcnt lgkmcnt(4)
  v_mfma_f32_16x16x32_bf16 v[32:35], a[152:155], v[168:171], v[32:35]
  v_mfma_f32_16x16x32_bf16 v[36:39], a[152:155], v[172:175], v[36:39]
  v_mfma_f32_16x16x32_bf16 v[40:43], a[156:159], v[168:171], v[40:43]
  v_mfma_f32_16x16x32_bf16 v[44:47], a[156:159], v[172:175], v[44:47]
  s_waitcnt lgkmcnt(0)
  v_mfma_f32_16x16x32_bf16 v[32:35], a[160:163], a[64:67], v[32:35]
  v_mfma_f32_16x16x32_bf16 v[36:39], a[160:163], a[68:71], v[36:39]
  v_mfma_f32_16x16x32_bf16 v[40:43], a[164:167], a[64:67], v[40:43]
  v_mfma_f32_16x16x32_bf16 v[44:47], a[164:167], a[68:71], v[44:47]
  s_nop 7
  v_cvt_pk_bf16_f32 v32, v32, v33
  v_cvt_pk_bf16_f32 v33, v34, v35
  v_cvt_pk_bf16_f32 v34, v40, v41
  v_cvt_pk_bf16_f32 v35, v42, v43
  buffer_store_dwordx4 v[32:35], v253, s[4:7], s82 offen offset:0 sc1
  v_cvt_pk_bf16_f32 v36, v36, v37
  v_cvt_pk_bf16_f32 v37, v38, v39
  v_cvt_pk_bf16_f32 v38, v44, v45
  v_cvt_pk_bf16_f32 v39, v46, v47
  buffer_store_dwordx4 v[36:39], v253, s[4:7], s82 offen offset:1024 sc1
  v_and_b32 v1, 7, v252
  v_lshrrev_b32 v2, 3, v252
  s_cmp_eq_u32 s20, 0
  s_movk_i32 s24, 0x876
  s_cselect_b32 s24, 0x310, s24
  s_cmp_eq_u32 s20, 1
  s_cselect_b32 s24, 0x425, s24
  v_lshlrev_b32 v6, 4, v1
  v_lshl_add_u32 v6, v2, 8, v6
  s_bfe_u32 s44, s24, 0x40000
  s_lshl_b32 s44, s44, 3
  s_lshl_b32 s25, s44, 8
  v_add_u32 v3, s25, v6
  s_bfe_u32 s45, s24, 0x40004
  s_lshl_b32 s45, s45, 3
  s_lshl_b32 s25, s45, 8
  v_add_u32 v4, s25, v6
  s_bfe_u32 s46, s24, 0x40008
  s_lshl_b32 s46, s46, 3
  s_lshl_b32 s25, s46, 8
  v_add_u32 v203, s25, v6
  s_lshl_b32 s25, s22, 4
  s_add_u32 s25, s25, s21
  s_lshr_b32 s26, s25, 1
  s_mul_i32 s26, s26, 18432
  s_and_b32 s27, s25, 1
  s_lshl_b32 s27, s27, 7
  s_add_u32 s26, s26, s27
  s_add_u32 s27, s26, s23
  s_add_u32 s28, s27, 0x6c0000
  s_lshr_b32 s29, s25, 1
  s_lshl_b32 s29, s29, 9
  s_and_b32 s30, s25, 1
  s_lshl_b32 s30, s30, 5
  s_add_u32 s29, s29, s30
  v_lshrrev_b32 v5, 3, v252
  v_lshlrev_b32 v5, 6, v5
  v_lshl_add_u32 v5, v1, 2, v5
  v_bfrev_b32 v6, 1
  v_cmp_gt_u32 vcc, 48, v252
  s_nop 1
  v_cndmask_b32 v5, v6, v5, vcc
  s_add_u32 s29, s29, s23
  s_add_u32 s29, s29, 0xb42000
  s_lshl_b32 s30, s22, 6
  s_lshr_b32 s31, s21, 2
  s_add_u32 s30, s30, s31
  s_mul_i32 s30, s30, 20480
  s_bfe_u32 s31, s21, 0x10001
  s_lshl_b32 s31, s31, 10
  s_add_u32 s30, s30, s31
  s_and_b32 s31, s21, 1
  s_lshl_b32 s31, s31, 7
  s_add_u32 s30, s30, s31
  s_add_u32 s30, s30, 0x1c00800
  v_add_u32 v6, s44, v2
  v_lshrrev_b32 v7, 2, v6
  v_and_b32 v6, 3, v6
  v_lshlrev_b32 v6, 8, v6
  v_lshl_add_u32 v6, v1, 4, v6
  v_lshl_add_u32 v6, v7, 11, v6
  v_add_u32 v38, 81920, v6
  v_subrev_u32 v6, 18432, v6
  v_cmp_gt_u32 vcc, 9, v7
  s_nop 1
  v_cndmask_b32 v200, v6, v38, vcc
  v_add_u32 v6, s45, v2
  v_lshrrev_b32 v7, 2, v6
  v_and_b32 v6, 3, v6
  v_lshlrev_b32 v6, 8, v6
  v_lshl_add_u32 v6, v1, 4, v6
  v_lshl_add_u32 v6, v7, 11, v6
  v_add_u32 v38, 81920, v6
  v_subrev_u32 v6, 18432, v6
  v_cmp_gt_u32 vcc, 9, v7
  s_nop 1
  v_cndmask_b32 v201, v6, v38, vcc
  v_add_u32 v6, s46, v2
  v_lshrrev_b32 v7, 2, v6
  v_and_b32 v6, 3, v6
  v_lshlrev_b32 v6, 8, v6
  v_lshl_add_u32 v6, v1, 4, v6
  v_lshl_add_u32 v6, v7, 11, v6
  v_add_u32 v38, 81920, v6
  v_subrev_u32 v6, 18432, v6
  v_cmp_gt_u32 vcc, 9, v7
  s_nop 1
  v_cndmask_b32 v202, v6, v38, vcc
  s_lshl_b32 s31, s20, 6
  s_lshl_b32 s32, s21, 2
  s_add_u32 s31, s31, s32
  s_barrier
  s_lshl_b32 s62, s31, 2
  s_add_u32 s62, s62, s60
  v_mov_b32 v250, s97
  v_mov_b32 v251, 32768
  s_waitcnt vmcnt(0)
  s_mov_b64 exec, 1
  buffer_store_dword v250, v251, s[4:7], s62 offen sc1
  s_mov_b64 exec, -1
  s_cmp_eq_u32 s20, 3
  s_cbranch_scc1 m_D_w3_33
  s_lshr_b32 s31, s21, 2
  s_lshl_b32 s31, s31, 6
  s_cmp_lg_u32 s20, 0
  s_cbranch_scc1 m_wf_skip_38
  v_lshlrev_b32 v250, 2, v252
  s_add_u32 s62, s60, 0x7c00
  s_add_u32 s63, s31, 256
  v_add_u32 v250, s63, v250
  s_mov_b32 s64, 0xffff
  v_lshlrev_b32 v250, 2, v250
  s_mov_b32 s65, 0x0
  s_mov_b64 exec, s[64:65]
  s_mov_b32 s63, 0
m_wf_loop_36:
  buffer_load_dword v246, v250, s[4:7], s62 offen sc1
  s_waitcnt vmcnt(0)
  v_cmp_eq_u32 vcc, s97, v246
  s_cmp_eq_u64 vcc, s[64:65]
  s_cbranch_scc1 m_wf_done_37
  s_add_u32 s63, s63, 1
  s_cmp_lt_u32 s63, 0x30d40
  s_cbranch_scc1 m_wf_loop_36
m_wf_done_37:
  s_mov_b64 exec, -1
m_wf_skip_38:
  s_barrier
  buffer_load_dword v32, v5, s[4:7], s29 offen sc1
  buffer_load_dwordx4 v[8:11], v3, s[4:7], s28 offen sc1
  buffer_load_dwordx4 v[12:15], v4, s[4:7], s28 offen sc1
  buffer_load_dwordx4 v[16:19], v203, s[4:7], s28 offen sc1
m_D_e2_35:
  buffer_load_dwordx4 v[40:43], v200, s[4:7], s30 offen sc1
  buffer_load_dwordx4 v[44:47], v201, s[4:7], s30 offen sc1
  buffer_load_dwordx4 v[48:51], v202, s[4:7], s30 offen sc1
  s_add_u32 s30, s30, 0x28000
  buffer_load_dwordx4 v[52:55], v200, s[4:7], s30 offen sc1
  buffer_load_dwordx4 v[56:59], v201, s[4:7], s30 offen sc1
  buffer_load_dwordx4 v[60:63], v202, s[4:7], s30 offen sc1
  s_add_u32 s30, s30, 0x28000
  buffer_load_dwordx4 v[64:67], v200, s[4:7], s30 offen sc1
  buffer_load_dwordx4 v[68:71], v201, s[4:7], s30 offen sc1
  buffer_load_dwordx4 v[72:75], v202, s[4:7], s30 offen sc1
  s_add_u32 s30, s30, 0x28000
  buffer_load_dwordx4 v[76:79], v200, s[4:7], s30 offen sc1
  buffer_load_dwordx4 v[80:83], v201, s[4:7], s30 offen sc1
  buffer_load_dwordx4 v[84:87], v202, s[4:7], s30 offen sc1
  s_add_u32 s30, s30, 0x28000
  buffer_load_dwordx4 v[88:91], v200, s[4:7], s30 offen sc1
  buffer_load_dwordx4 v[92:95], v201, s[4:7], s30 offen sc1
  buffer_load_dwordx4 v[96:99], v202, s[4:7], s30 offen sc1
  s_add_u32 s30, s30, 0x28000
  buffer_load_dwordx4 v[100:103], v200, s[4:7], s30 offen sc1
  buffer_load_dwordx4 v[104:107], v201, s[4:7], s30 offen sc1
  buffer_load_dwordx4 v[108:111], v202, s[4:7], s30 offen sc1
  s_add_u32 s30, s30, 0x28000
  buffer_load_dwordx4 v[112:115], v200, s[4:7], s30 offen sc1
  buffer_load_dwordx4 v[116:119], v201, s[4:7], s30 offen sc1
  buffer_load_dwordx4 v[120:123], v202, s[4:7], s30 offen sc1
  s_add_u32 s30, s30, 0x28000
  buffer_load_dwordx4 v[124:127], v200, s[4:7], s30 offen sc1
  buffer_load_dwordx4 v[128:131], v201, s[4:7], s30 offen sc1
  buffer_load_dwordx4 v[132:135], v202, s[4:7], s30 offen sc1
  s_waitcnt vmcnt(23)
  s_nop 1
  v_add_f32_dpp v32, v32, v32 row_ror:8 row_mask:0xf bank_mask:0xf
  v_mov_b32 v33, v32
  s_nop 1
  v_permlane16_swap_b32 v32, v33
  s_nop 1
  v_add_f32 v32, v32, v33
  v_mov_b32 v33, v32
  s_nop 1
  v_permlane32_swap_b32 v32, v33
  s_nop 1
  v_add_f32 v32, v32, v33
  v_mov_b32 v33, 0x3727c5ac
  s_mov_b32 s31, 0x3ae38e39
  v_fma_f32 v32, v32, s31, v33
  v_rcp_f32 v32, v32
  v_lshlrev_b32 v232, 16, v40
  v_and_b32 v233, 0xffff0000, v40
  v_lshlrev_b32 v234, 16, v41
  v_and_b32 v235, 0xffff0000, v41
  v_lshlrev_b32 v236, 16, v42
  v_and_b32 v237, 0xffff0000, v42
  v_lshlrev_b32 v238, 16, v43
  v_and_b32 v239, 0xffff0000, v43
  s_waitcnt vmcnt(22)
  v_lshlrev_b32 v240, 16, v44
  v_and_b32 v241, 0xffff0000, v44
  v_lshlrev_b32 v242, 16, v45
  v_and_b32 v243, 0xffff0000, v45
  v_lshlrev_b32 v244, 16, v46
  v_and_b32 v245, 0xffff0000, v46
  v_lshlrev_b32 v246, 16, v47
  v_and_b32 v247, 0xffff0000, v47
  s_waitcnt vmcnt(21)
  v_lshlrev_b32 v24, 16, v48
  v_and_b32 v25, 0xffff0000, v48
  v_lshlrev_b32 v26, 16, v49
  v_and_b32 v27, 0xffff0000, v49
  v_lshlrev_b32 v28, 16, v50
  v_and_b32 v29, 0xffff0000, v50
  v_lshlrev_b32 v30, 16, v51
  v_and_b32 v31, 0xffff0000, v51
  s_waitcnt vmcnt(20)
  v_lshlrev_b32 v20, 16, v52
  v_and_b32 v21, 0xffff0000, v52
  v_add_f32 v232, v232, v20
  v_add_f32 v233, v233, v21
  v_lshlrev_b32 v20, 16, v53
  v_and_b32 v21, 0xffff0000, v53
  v_add_f32 v234, v234, v20
  v_add_f32 v235, v235, v21
  v_lshlrev_b32 v20, 16, v54
  v_and_b32 v21, 0xffff0000, v54
  v_add_f32 v236, v236, v20
  v_add_f32 v237, v237, v21
  v_lshlrev_b32 v20, 16, v55
  v_and_b32 v21, 0xffff0000, v55
  v_add_f32 v238, v238, v20
  v_add_f32 v239, v239, v21
  s_waitcnt vmcnt(19)
  v_lshlrev_b32 v20, 16, v56
  v_and_b32 v21, 0xffff0000, v56
  v_add_f32 v240, v240, v20
  v_add_f32 v241, v241, v21
  v_lshlrev_b32 v20, 16, v57
  v_and_b32 v21, 0xffff0000, v57
  v_add_f32 v242, v242, v20
  v_add_f32 v243, v243, v21
  v_lshlrev_b32 v20, 16, v58
  v_and_b32 v21, 0xffff0000, v58
  v_add_f32 v244, v244, v20
  v_add_f32 v245, v245, v21
  v_lshlrev_b32 v20, 16, v59
  v_and_b32 v21, 0xffff0000, v59
  v_add_f32 v246, v246, v20
  v_add_f32 v247, v247, v21
  s_waitcnt vmcnt(18)
  v_lshlrev_b32 v20, 16, v60
  v_and_b32 v21, 0xffff0000, v60
  v_add_f32 v24, v24, v20
  v_add_f32 v25, v25, v21
  v_lshlrev_b32 v20, 16, v61
  v_and_b32 v21, 0xffff0000, v61
  v_add_f32 v26, v26, v20
  v_add_f32 v27, v27, v21
  v_lshlrev_b32 v20, 16, v62
  v_and_b32 v21, 0xffff0000, v62
  v_add_f32 v28, v28, v20
  v_add_f32 v29, v29, v21
  v_lshlrev_b32 v20, 16, v63
  v_and_b32 v21, 0xffff0000, v63
  v_add_f32 v30, v30, v20
  v_add_f32 v31, v31, v21
  s_waitcnt vmcnt(17)
  v_lshlrev_b32 v20, 16, v64
  v_and_b32 v21, 0xffff0000, v64
  v_add_f32 v232, v232, v20
  v_add_f32 v233, v233, v21
  v_lshlrev_b32 v20, 16, v65
  v_and_b32 v21, 0xffff0000, v65
  v_add_f32 v234, v234, v20
  v_add_f32 v235, v235, v21
  v_lshlrev_b32 v20, 16, v66
  v_and_b32 v21, 0xffff0000, v66
  v_add_f32 v236, v236, v20
  v_add_f32 v237, v237, v21
  v_lshlrev_b32 v20, 16, v67
  v_and_b32 v21, 0xffff0000, v67
  v_add_f32 v238, v238, v20
  v_add_f32 v239, v239, v21
  s_waitcnt vmcnt(16)
  v_lshlrev_b32 v20, 16, v68
  v_and_b32 v21, 0xffff0000, v68
  v_add_f32 v240, v240, v20
  v_add_f32 v241, v241, v21
  v_lshlrev_b32 v20, 16, v69
  v_and_b32 v21, 0xffff0000, v69
  v_add_f32 v242, v242, v20
  v_add_f32 v243, v243, v21
  v_lshlrev_b32 v20, 16, v70
  v_and_b32 v21, 0xffff0000, v70
  v_add_f32 v244, v244, v20
  v_add_f32 v245, v245, v21
  v_lshlrev_b32 v20, 16, v71
  v_and_b32 v21, 0xffff0000, v71
  v_add_f32 v246, v246, v20
  v_add_f32 v247, v247, v21
  s_waitcnt vmcnt(15)
  v_lshlrev_b32 v20, 16, v72
  v_and_b32 v21, 0xffff0000, v72
  v_add_f32 v24, v24, v20
  v_add_f32 v25, v25, v21
  v_lshlrev_b32 v20, 16, v73
  v_and_b32 v21, 0xffff0000, v73
  v_add_f32 v26, v26, v20
  v_add_f32 v27, v27, v21
  v_lshlrev_b32 v20, 16, v74
  v_and_b32 v21, 0xffff0000, v74
  v_add_f32 v28, v28, v20
  v_add_f32 v29, v29, v21
  v_lshlrev_b32 v20, 16, v75
  v_and_b32 v21, 0xffff0000, v75
  v_add_f32 v30, v30, v20
  v_add_f32 v31, v31, v21
  s_waitcnt vmcnt(14)
  v_lshlrev_b32 v20, 16, v76
  v_and_b32 v21, 0xffff0000, v76
  v_add_f32 v232, v232, v20
  v_add_f32 v233, v233, v21
  v_lshlrev_b32 v20, 16, v77
  v_and_b32 v21, 0xffff0000, v77
  v_add_f32 v234, v234, v20
  v_add_f32 v235, v235, v21
  v_lshlrev_b32 v20, 16, v78
  v_and_b32 v21, 0xffff0000, v78
  v_add_f32 v236, v236, v20
  v_add_f32 v237, v237, v21
  v_lshlrev_b32 v20, 16, v79
  v_and_b32 v21, 0xffff0000, v79
  v_add_f32 v238, v238, v20
  v_add_f32 v239, v239, v21
  s_waitcnt vmcnt(13)
  v_lshlrev_b32 v20, 16, v80
  v_and_b32 v21, 0xffff0000, v80
  v_add_f32 v240, v240, v20
  v_add_f32 v241, v241, v21
  v_lshlrev_b32 v20, 16, v81
  v_and_b32 v21, 0xffff0000, v81
  v_add_f32 v242, v242, v20
  v_add_f32 v243, v243, v21
  v_lshlrev_b32 v20, 16, v82
  v_and_b32 v21, 0xffff0000, v82
  v_add_f32 v244, v244, v20
  v_add_f32 v245, v245, v21
  v_lshlrev_b32 v20, 16, v83
  v_and_b32 v21, 0xffff0000, v83
  v_add_f32 v246, v246, v20
  v_add_f32 v247, v247, v21
  s_waitcnt vmcnt(12)
  v_lshlrev_b32 v20, 16, v84
  v_and_b32 v21, 0xffff0000, v84
  v_add_f32 v24, v24, v20
  v_add_f32 v25, v25, v21
  v_lshlrev_b32 v20, 16, v85
  v_and_b32 v21, 0xffff0000, v85
  v_add_f32 v26, v26, v20
  v_add_f32 v27, v27, v21
  v_lshlrev_b32 v20, 16, v86
  v_and_b32 v21, 0xffff0000, v86
  v_add_f32 v28, v28, v20
  v_add_f32 v29, v29, v21
  v_lshlrev_b32 v20, 16, v87
  v_and_b32 v21, 0xffff0000, v87
  v_add_f32 v30, v30, v20
  v_add_f32 v31, v31, v21
  s_waitcnt vmcnt(11)
  v_lshlrev_b32 v20, 16, v88
  v_and_b32 v21, 0xffff0000, v88
  v_add_f32 v232, v232, v20
  v_add_f32 v233, v233, v21
  v_lshlrev_b32 v20, 16, v89
  v_and_b32 v21, 0xffff0000, v89
  v_add_f32 v234, v234, v20
  v_add_f32 v235, v235, v21
  v_lshlrev_b32 v20, 16, v90
  v_and_b32 v21, 0xffff0000, v90
  v_add_f32 v236, v236, v20
  v_add_f32 v237, v237, v21
  v_lshlrev_b32 v20, 16, v91
  v_and_b32 v21, 0xffff0000, v91
  v_add_f32 v238, v238, v20
  v_add_f32 v239, v239, v21
  s_waitcnt vmcnt(10)
  v_lshlrev_b32 v20, 16, v92
  v_and_b32 v21, 0xffff0000, v92
  v_add_f32 v240, v240, v20
  v_add_f32 v241, v241, v21
  v_lshlrev_b32 v20, 16, v93
  v_and_b32 v21, 0xffff0000, v93
  v_add_f32 v242, v242, v20
  v_add_f32 v243, v243, v21
  v_lshlrev_b32 v20, 16, v94
  v_and_b32 v21, 0xffff0000, v94
  v_add_f32 v244, v244, v20
  v_add_f32 v245, v245, v21
  v_lshlrev_b32 v20, 16, v95
  v_and_b32 v21, 0xffff0000, v95
  v_add_f32 v246, v246, v20
  v_add_f32 v247, v247, v21
  s_waitcnt vmcnt(9)
  v_lshlrev_b32 v20, 16, v96
  v_and_b32 v21, 0xffff0000, v96
  v_add_f32 v24, v24, v20
  v_add_f32 v25, v25, v21
  v_lshlrev_b32 v20, 16, v97
  v_and_b32 v21, 0xffff0000, v97
  v_add_f32 v26, v26, v20
  v_add_f32 v27, v27, v21
  v_lshlrev_b32 v20, 16, v98
  v_and_b32 v21, 0xffff0000, v98
  v_add_f32 v28, v28, v20
  v_add_f32 v29, v29, v21
  v_lshlrev_b32 v20, 16, v99
  v_and_b32 v21, 0xffff0000, v99
  v_add_f32 v30, v30, v20
  v_add_f32 v31, v31, v21
  s_waitcnt vmcnt(8)
  v_lshlrev_b32 v20, 16, v100
  v_and_b32 v21, 0xffff0000, v100
  v_add_f32 v232, v232, v20
  v_add_f32 v233, v233, v21
  v_lshlrev_b32 v20, 16, v101
  v_and_b32 v21, 0xffff0000, v101
  v_add_f32 v234, v234, v20
  v_add_f32 v235, v235, v21
  v_lshlrev_b32 v20, 16, v102
  v_and_b32 v21, 0xffff0000, v102
  v_add_f32 v236, v236, v20
  v_add_f32 v237, v237, v21
  v_lshlrev_b32 v20, 16, v103
  v_and_b32 v21, 0xffff0000, v103
  v_add_f32 v238, v238, v20
  v_add_f32 v239, v239, v21
  s_waitcnt vmcnt(7)
  v_lshlrev_b32 v20, 16, v104
  v_and_b32 v21, 0xffff0000, v104
  v_add_f32 v240, v240, v20
  v_add_f32 v241, v241, v21
  v_lshlrev_b32 v20, 16, v105
  v_and_b32 v21, 0xffff0000, v105
  v_add_f32 v242, v242, v20
  v_add_f32 v243, v243, v21
  v_lshlrev_b32 v20, 16, v106
  v_and_b32 v21, 0xffff0000, v106
  v_add_f32 v244, v244, v20
  v_add_f32 v245, v245, v21
  v_lshlrev_b32 v20, 16, v107
  v_and_b32 v21, 0xffff0000, v107
  v_add_f32 v246, v246, v20
  v_add_f32 v247, v247, v21
  s_waitcnt vmcnt(6)
  v_lshlrev_b32 v20, 16, v108
  v_and_b32 v21, 0xffff0000, v108
  v_add_f32 v24, v24, v20
  v_add_f32 v25, v25, v21
  v_lshlrev_b32 v20, 16, v109
  v_and_b32 v21, 0xffff0000, v109
  v_add_f32 v26, v26, v20
  v_add_f32 v27, v27, v21
  v_lshlrev_b32 v20, 16, v110
  v_and_b32 v21, 0xffff0000, v110
  v_add_f32 v28, v28, v20
  v_add_f32 v29, v29, v21
  v_lshlrev_b32 v20, 16, v111
  v_and_b32 v21, 0xffff0000, v111
  v_add_f32 v30, v30, v20
  v_add_f32 v31, v31, v21
  s_waitcnt vmcnt(5)
  v_lshlrev_b32 v20, 16, v112
  v_and_b32 v21, 0xffff0000, v112
  v_add_f32 v232, v232, v20
  v_add_f32 v233, v233, v21
  v_lshlrev_b32 v20, 16, v113
  v_and_b32 v21, 0xffff0000, v113
  v_add_f32 v234, v234, v20
  v_add_f32 v235, v235, v21
  v_lshlrev_b32 v20, 16, v114
  v_and_b32 v21, 0xffff0000, v114
  v_add_f32 v236, v236, v20
  v_add_f32 v237, v237, v21
  v_lshlrev_b32 v20, 16, v115
  v_and_b32 v21, 0xffff0000, v115
  v_add_f32 v238, v238, v20
  v_add_f32 v239, v239, v21
  s_waitcnt vmcnt(4)
  v_lshlrev_b32 v20, 16, v116
  v_and_b32 v21, 0xffff0000, v116
  v_add_f32 v240, v240, v20
  v_add_f32 v241, v241, v21
  v_lshlrev_b32 v20, 16, v117
  v_and_b32 v21, 0xffff0000, v117
  v_add_f32 v242, v242, v20
  v_add_f32 v243, v243, v21
  v_lshlrev_b32 v20, 16, v118
  v_and_b32 v21, 0xffff0000, v118
  v_add_f32 v244, v244, v20
  v_add_f32 v245, v245, v21
  v_lshlrev_b32 v20, 16, v119
  v_and_b32 v21, 0xffff0000, v119
  v_add_f32 v246, v246, v20
  v_add_f32 v247, v247, v21
  s_waitcnt vmcnt(3)
  v_lshlrev_b32 v20, 16, v120
  v_and_b32 v21, 0xffff0000, v120
  v_add_f32 v24, v24, v20
  v_add_f32 v25, v25, v21
  v_lshlrev_b32 v20, 16, v121
  v_and_b32 v21, 0xffff0000, v121
  v_add_f32 v26, v26, v20
  v_add_f32 v27, v27, v21
  v_lshlrev_b32 v20, 16, v122
  v_and_b32 v21, 0xffff0000, v122
  v_add_f32 v28, v28, v20
  v_add_f32 v29, v29, v21
  v_lshlrev_b32 v20, 16, v123
  v_and_b32 v21, 0xffff0000, v123
  v_add_f32 v30, v30, v20
  v_add_f32 v31, v31, v21
  s_waitcnt vmcnt(2)
  v_lshlrev_b32 v20, 16, v124
  v_and_b32 v21, 0xffff0000, v124
  v_add_f32 v232, v232, v20
  v_add_f32 v233, v233, v21
  v_lshlrev_b32 v20, 16, v125
  v_and_b32 v21, 0xffff0000, v125
  v_add_f32 v234, v234, v20
  v_add_f32 v235, v235, v21
  v_lshlrev_b32 v20, 16, v126
  v_and_b32 v21, 0xffff0000, v126
  v_add_f32 v236, v236, v20
  v_add_f32 v237, v237, v21
  v_lshlrev_b32 v20, 16, v127
  v_and_b32 v21, 0xffff0000, v127
  v_add_f32 v238, v238, v20
  v_add_f32 v239, v239, v21
  s_waitcnt vmcnt(1)
  v_lshlrev_b32 v20, 16, v128
  v_and_b32 v21, 0xffff0000, v128
  v_add_f32 v240, v240, v20
  v_add_f32 v241, v241, v21
  v_lshlrev_b32 v20, 16, v129
  v_and_b32 v21, 0xffff0000, v129
  v_add_f32 v242, v242, v20
  v_add_f32 v243, v243, v21
  v_lshlrev_b32 v20, 16, v130
  v_and_b32 v21, 0xffff0000, v130
  v_add_f32 v244, v244, v20
  v_add_f32 v245, v245, v21
  v_lshlrev_b32 v20, 16, v131
  v_and_b32 v21, 0xffff0000, v131
  v_add_f32 v246, v246, v20
  v_add_f32 v247, v247, v21
  s_waitcnt vmcnt(0)
  v_lshlrev_b32 v20, 16, v132
  v_and_b32 v21, 0xffff0000, v132
  v_add_f32 v24, v24, v20
  v_add_f32 v25, v25, v21
  v_lshlrev_b32 v20, 16, v133
  v_and_b32 v21, 0xffff0000, v133
  v_add_f32 v26, v26, v20
  v_add_f32 v27, v27, v21
  v_lshlrev_b32 v20, 16, v134
  v_and_b32 v21, 0xffff0000, v134
  v_add_f32 v28, v28, v20
  v_add_f32 v29, v29, v21
  v_lshlrev_b32 v20, 16, v135
  v_and_b32 v21, 0xffff0000, v135
  v_add_f32 v30, v30, v20
  v_add_f32 v31, v31, v21
  s_waitcnt vmcnt(0)
  v_lshlrev_b32 v40, 16, v8
  v_and_b32 v41, 0xffff0000, v8
  v_lshlrev_b32 v42, 16, v9
  v_and_b32 v43, 0xffff0000, v9
  v_lshlrev_b32 v44, 16, v10
  v_and_b32 v45, 0xffff0000, v10
  v_lshlrev_b32 v46, 16, v11
  v_and_b32 v47, 0xffff0000, v11
  v_fmac_f32 v40, v232, v32
  v_fmac_f32 v41, v233, v32
  v_fmac_f32 v42, v234, v32
  v_fmac_f32 v43, v235, v32
  v_fmac_f32 v44, v236, v32
  v_fmac_f32 v45, v237, v32
  v_fmac_f32 v46, v238, v32
  v_fmac_f32 v47, v239, v32
  v_cvt_pk_bf16_f32 v8, v40, v41
  v_cvt_pk_bf16_f32 v9, v42, v43
  v_cvt_pk_bf16_f32 v10, v44, v45
  v_cvt_pk_bf16_f32 v11, v46, v47
  v_lshlrev_b32 v48, 16, v12
  v_and_b32 v49, 0xffff0000, v12
  v_lshlrev_b32 v50, 16, v13
  v_and_b32 v51, 0xffff0000, v13
  v_lshlrev_b32 v52, 16, v14
  v_and_b32 v53, 0xffff0000, v14
  v_lshlrev_b32 v54, 16, v15
  v_and_b32 v55, 0xffff0000, v15
  v_fmac_f32 v48, v240, v32
  v_fmac_f32 v49, v241, v32
  v_fmac_f32 v50, v242, v32
  v_fmac_f32 v51, v243, v32
  v_fmac_f32 v52, v244, v32
  v_fmac_f32 v53, v245, v32
  v_fmac_f32 v54, v246, v32
  v_fmac_f32 v55, v247, v32
  v_cvt_pk_bf16_f32 v12, v48, v49
  v_cvt_pk_bf16_f32 v13, v50, v51
  v_cvt_pk_bf16_f32 v14, v52, v53
  v_cvt_pk_bf16_f32 v15, v54, v55
  v_lshlrev_b32 v56, 16, v16
  v_and_b32 v57, 0xffff0000, v16
  v_lshlrev_b32 v58, 16, v17
  v_and_b32 v59, 0xffff0000, v17
  v_lshlrev_b32 v60, 16, v18
  v_and_b32 v61, 0xffff0000, v18
  v_lshlrev_b32 v62, 16, v19
  v_and_b32 v63, 0xffff0000, v19
  v_fmac_f32 v56, v24, v32
  v_fmac_f32 v57, v25, v32
  v_fmac_f32 v58, v26, v32
  v_fmac_f32 v59, v27, v32
  v_fmac_f32 v60, v28, v32
  v_fmac_f32 v61, v29, v32
  v_fmac_f32 v62, v30, v32
  v_fmac_f32 v63, v31, v32
  v_cvt_pk_bf16_f32 v16, v56, v57
  v_cvt_pk_bf16_f32 v17, v58, v59
  v_cvt_pk_bf16_f32 v18, v60, v61
  v_cvt_pk_bf16_f32 v19, v62, v63
  s_cmp_lg_u32 s23, 0
  s_cbranch_scc1 m_D_fin_39
m_ln:
  v_lshlrev_b32 v40, 16, v8
  v_and_b32 v41, 0xffff0000, v8
  v_lshlrev_b32 v42, 16, v9
  v_and_b32 v43, 0xffff0000, v9
  v_lshlrev_b32 v44, 16, v10
  v_and_b32 v45, 0xffff0000, v10
  v_lshlrev_b32 v46, 16, v11
  v_and_b32 v47, 0xffff0000, v11
  v_lshlrev_b32 v48, 16, v12
  v_and_b32 v49, 0xffff0000, v12
  v_lshlrev_b32 v50, 16, v13
  v_and_b32 v51, 0xffff0000, v13
  v_lshlrev_b32 v52, 16, v14
  v_and_b32 v53, 0xffff0000, v14
  v_lshlrev_b32 v54, 16, v15
  v_and_b32 v55, 0xffff0000, v15
  v_lshlrev_b32 v56, 16, v16
  v_and_b32 v57, 0xffff0000, v16
  v_lshlrev_b32 v58, 16, v17
  v_and_b32 v59, 0xffff0000, v17
  v_lshlrev_b32 v60, 16, v18
  v_and_b32 v61, 0xffff0000, v18
  v_lshlrev_b32 v62, 16, v19
  v_and_b32 v63, 0xffff0000, v19
  s_add_u32 s26, s26, s59
  s_add_u32 s28, s26, 0x240000
  buffer_store_dwordx4 v[8:11], v3, s[4:7], s28 offen sc1
  buffer_store_dwordx4 v[12:15], v4, s[4:7], s28 offen sc1
  buffer_store_dwordx4 v[16:19], v203, s[4:7], s28 offen sc1
  v_add_f32 v34, v40, v41
  v_mul_f32 v35, v40, v40
  v_fmac_f32 v35, v41, v41
  v_add_f32 v34, v34, v42
  v_fmac_f32 v35, v42, v42
  v_add_f32 v34, v34, v43
  v_fmac_f32 v35, v43, v43
  v_add_f32 v34, v34, v44
  v_fmac_f32 v35, v44, v44
  v_add_f32 v34, v34, v45
  v_fmac_f32 v35, v45, v45
  v_add_f32 v34, v34, v46
  v_fmac_f32 v35, v46, v46
  v_add_f32 v34, v34, v47
  v_fmac_f32 v35, v47, v47
  v_add_f32 v34, v34, v48
  v_fmac_f32 v35, v48, v48
  v_add_f32 v34, v34, v49
  v_fmac_f32 v35, v49, v49
  v_add_f32 v34, v34, v50
  v_fmac_f32 v35, v50, v50
  v_add_f32 v34, v34, v51
  v_fmac_f32 v35, v51, v51
  v_add_f32 v34, v34, v52
  v_fmac_f32 v35, v52, v52
  v_add_f32 v34, v34, v53
  v_fmac_f32 v35, v53, v53
  v_add_f32 v34, v34, v54
  v_fmac_f32 v35, v54, v54
  v_add_f32 v34, v34, v55
  v_fmac_f32 v35, v55, v55
  v_add_f32 v34, v34, v56
  v_fmac_f32 v35, v56, v56
  v_add_f32 v34, v34, v57
  v_fmac_f32 v35, v57, v57
  v_add_f32 v34, v34, v58
  v_fmac_f32 v35, v58, v58
  v_add_f32 v34, v34, v59
  v_fmac_f32 v35, v59, v59
  v_add_f32 v34, v34, v60
  v_fmac_f32 v35, v60, v60
  v_add_f32 v34, v34, v61
  v_fmac_f32 v35, v61, v61
  v_add_f32 v34, v34, v62
  v_fmac_f32 v35, v62, v62
  v_add_f32 v34, v34, v63
  v_fmac_f32 v35, v63, v63
  s_nop 1
  v_add_f32_dpp v34, v34, v34 row_ror:8 row_mask:0xf bank_mask:0xf
  v_add_f32_dpp v35, v35, v35 row_ror:8 row_mask:0xf bank_mask:0xf
  v_mov_b32 v36, v34
  v_mov_b32 v37, v35
  s_nop 1
  v_permlane16_swap_b32 v34, v36
  v_permlane16_swap_b32 v35, v37
  s_nop 1
  v_add_f32 v34, v34, v36
  v_add_f32 v35, v35, v37
  v_mov_b32 v36, v34
  v_mov_b32 v37, v35
  s_nop 1
  v_permlane32_swap_b32 v34, v36
  v_permlane32_swap_b32 v35, v37
  s_nop 1
  v_add_f32 v34, v34, v36
  v_add_f32 v35, v35, v37
  v_lshlrev_b32 v36, 5, v1
  v_add_u32 v36, 160000, v36
  s_lshl_b32 s24, s20, 3
  v_add_u32 v37, s24, v36
  ds_write_b64 v37, v[34:35]
  s_waitcnt vmcnt(3) lgkmcnt(0)
  s_barrier
  ds_read_b128 v[64:67], v36
  ds_read_b64 v[34:35], v36 offset:16
  s_waitcnt lgkmcnt(0)
  v_add_f32 v34, v34, v64
  v_add_f32 v35, v35, v65
  v_add_f32 v34, v34, v66
  v_add_f32 v35, v35, v67
  v_mul_f32 v34, s31, v34
  v_mul_f32 v36, v34, v34
  v_fma_f32 v35, v35, s31, -v36
  v_max_f32 v35, 0, v35
  v_add_f32 v35, 0x3727c5ac, v35
  v_rsq_f32 v35, v35
  v_sub_f32 v40, v40, v34
  v_sub_f32 v41, v41, v34
  v_sub_f32 v42, v42, v34
  v_sub_f32 v43, v43, v34
  v_sub_f32 v44, v44, v34
  v_sub_f32 v45, v45, v34
  v_sub_f32 v46, v46, v34
  v_sub_f32 v47, v47, v34
  v_sub_f32 v48, v48, v34
  v_sub_f32 v49, v49, v34
  v_sub_f32 v50, v50, v34
  v_sub_f32 v51, v51, v34
  v_sub_f32 v52, v52, v34
  v_sub_f32 v53, v53, v34
  v_sub_f32 v54, v54, v34
  v_sub_f32 v55, v55, v34
  v_sub_f32 v56, v56, v34
  v_sub_f32 v57, v57, v34
  v_sub_f32 v58, v58, v34
  v_sub_f32 v59, v59, v34
  v_sub_f32 v60, v60, v34
  v_sub_f32 v61, v61, v34
  v_sub_f32 v62, v62, v34
  v_sub_f32 v63, v63, v34
  v_mul_f32 v40, v40, v35
  v_mul_f32 v41, v41, v35
  v_mul_f32 v42, v42, v35
  v_mul_f32 v43, v43, v35
  v_mul_f32 v44, v44, v35
  v_mul_f32 v45, v45, v35
  v_mul_f32 v46, v46, v35
  v_mul_f32 v47, v47, v35
  v_mul_f32 v48, v48, v35
  v_mul_f32 v49, v49, v35
  v_mul_f32 v50, v50, v35
  v_mul_f32 v51, v51, v35
  v_mul_f32 v52, v52, v35
  v_mul_f32 v53, v53, v35
  v_mul_f32 v54, v54, v35
  v_mul_f32 v55, v55, v35
  v_mul_f32 v56, v56, v35
  v_mul_f32 v57, v57, v35
  v_mul_f32 v58, v58, v35
  v_mul_f32 v59, v59, v35
  v_mul_f32 v60, v60, v35
  v_mul_f32 v61, v61, v35
  v_mul_f32 v62, v62, v35
  v_mul_f32 v63, v63, v35
  v_cvt_pk_bf16_f32 v64, v40, v41
  v_cvt_pk_bf16_f32 v65, v42, v43
  v_cvt_pk_bf16_f32 v66, v44, v45
  v_cvt_pk_bf16_f32 v67, v46, v47
  v_cvt_pk_bf16_f32 v68, v48, v49
  v_cvt_pk_bf16_f32 v69, v50, v51
  v_cvt_pk_bf16_f32 v70, v52, v53
  v_cvt_pk_bf16_f32 v71, v54, v55
  v_cvt_pk_bf16_f32 v72, v56, v57
  v_cvt_pk_bf16_f32 v73, v58, v59
  v_cvt_pk_bf16_f32 v74, v60, v61
  v_cvt_pk_bf16_f32 v75, v62, v63
  s_add_u32 s28, s26, 0x0
  buffer_store_dwordx4 v[64:67], v3, s[4:7], s28 offen sc1
  buffer_store_dwordx4 v[68:71], v4, s[4:7], s28 offen sc1
  buffer_store_dwordx4 v[72:75], v203, s[4:7], s28 offen sc1
  v_lshlrev_b32 v36, 2, v1
  s_lshl_b32 s28, s25, 5
  s_add_u32 s28, s28, s59
  s_add_u32 s28, s28, 0xb40000
  s_cmp_eq_u32 s59, 0
  s_cbranch_scc1 m_zret
  s_lshl_b32 s33, s21, 4
  s_lshl_b32 s32, s20, 2
  s_add_u32 s33, s33, s32
  s_lshl_b32 s62, s33, 2
  s_add_u32 s62, s62, s60
  v_mov_b32 v250, s97
  v_mov_b32 v251, 49152
  s_waitcnt vmcnt(0)
  s_mov_b64 exec, 1
  buffer_store_dword v250, v251, s[4:7], s62 offen sc1
  s_mov_b64 exec, -1
  s_cmp_lg_u32 s20, 1
  s_cbranch_scc1 m_D_j2_40
  s_mov_b64 exec, 0xff
  buffer_store_dword v34, v36, s[4:7], s28 offen sc1
  s_mov_b64 exec, -1
  s_branch m_D_j2_40
m_D_w3_33:
  s_cmp_lg_u32 s23, 0
  s_cbranch_scc1 m_end
  s_mov_b32 s24, 0
  s_mul_i32 s25, s21, 131072
  s_add_u32 s25, s25, s24
  s_add_u32 s25, s25, 0x1901000
  s_mov_b32 m0, s24
  s_barrier
  s_mov_b32 s63, 0
m_pfA_41:
  buffer_load_dwordx4 v253, s[4:7], s25 offen offset:0 sc1 lds
  buffer_load_dwordx4 v253, s[4:7], s25 offen offset:1024 sc1 lds
  buffer_load_dwordx4 v253, s[4:7], s25 offen offset:2048 sc1 lds
  buffer_load_dwordx4 v253, s[4:7], s25 offen offset:3072 sc1 lds
  s_add_u32 m0, m0, 4096
  s_add_u32 s25, s25, 4096
  s_add_u32 s63, s63, 1
  s_cmp_lt_u32 s63, 32
  s_cbranch_scc1 m_pfA_41
  s_barrier
m_D_j2_40:
  s_mov_b32 s23, 0xbe0000
  s_add_u32 s60, s60, 65536
  s_branch m_layer
m_D_fin_39:
  s_mov_b32 s16, s42
  s_and_b32 s17, s43, 0xffff
  s_mov_b32 s18, 0x240000
  s_mov_b32 s19, 0x20000
  v_and_b32 v5, 8, v252
  v_cmp_eq_u32 vcc, 0, v5
  v_lshrrev_b32 v6, 2, v2
  v_lshlrev_b32 v6, 6, v6
  v_lshl_add_u32 v6, v5, 2, v6
  v_and_b32 v7, 16, v252
  v_add_u32 v6, v6, v7
  v_mul_u32_u24 v7, 1152, v1
  v_add_u32 v6, v6, v7
  s_mul_i32 s28, s25, 9216
  v_mov_b32_dpp v40, v8 row_ror:8 row_mask:0xf bank_mask:0xf
  v_mov_b32_dpp v41, v9 row_ror:8 row_mask:0xf bank_mask:0xf
  v_mov_b32_dpp v42, v10 row_ror:8 row_mask:0xf bank_mask:0xf
  v_mov_b32_dpp v43, v11 row_ror:8 row_mask:0xf bank_mask:0xf
  v_cndmask_b32 v48, v42, v8, vcc
  v_cndmask_b32 v49, v43, v9, vcc
  v_cndmask_b32 v50, v10, v40, vcc
  v_cndmask_b32 v51, v11, v41, vcc
  s_lshl_b32 s29, s44, 4
  s_add_u32 s29, s29, s28
  buffer_store_dwordx4 v[48:51], v6, s[16:19], s29 offen
  v_mov_b32_dpp v40, v12 row_ror:8 row_mask:0xf bank_mask:0xf
  v_mov_b32_dpp v41, v13 row_ror:8 row_mask:0xf bank_mask:0xf
  v_mov_b32_dpp v42, v14 row_ror:8 row_mask:0xf bank_mask:0xf
  v_mov_b32_dpp v43, v15 row_ror:8 row_mask:0xf bank_mask:0xf
  v_cndmask_b32 v52, v42, v12, vcc
  v_cndmask_b32 v53, v43, v13, vcc
  v_cndmask_b32 v54, v14, v40, vcc
  v_cndmask_b32 v55, v15, v41, vcc
  s_lshl_b32 s29, s45, 4
  s_add_u32 s29, s29, s28
  buffer_store_dwordx4 v[52:55], v6, s[16:19], s29 offen
  v_mov_b32_dpp v40, v16 row_ror:8 row_mask:0xf bank_mask:0xf
  v_mov_b32_dpp v41, v17 row_ror:8 row_mask:0xf bank_mask:0xf
  v_mov_b32_dpp v42, v18 row_ror:8 row_mask:0xf bank_mask:0xf
  v_mov_b32_dpp v43, v19 row_ror:8 row_mask:0xf bank_mask:0xf
  v_cndmask_b32 v56, v42, v16, vcc
  v_cndmask_b32 v57, v43, v17, vcc
  v_cndmask_b32 v58, v18, v40, vcc
  v_cndmask_b32 v59, v19, v41, vcc
  s_lshl_b32 s29, s46, 4
  s_add_u32 s29, s29, s28
  buffer_store_dwordx4 v[56:59], v6, s[16:19], s29 offen
m_end:
m_exit:
  s_endpgm
m_C_22_sC1:
  buffer_load_dwordx4 a[24:27], v253, s[4:7], s51 offen offset:2048 sc1
  buffer_load_dwordx4 a[96:99], v254, s[4:7], s51 offen offset:2048 sc1
  buffer_load_dwordx4 a[28:31], v253, s[4:7], s51 offen offset:3072 sc1
  buffer_load_dwordx4 a[100:103], v254, s[4:7], s51 offen offset:3072 sc1
  s_waitcnt vmcnt(13)
  s_branch m_C_22_sC1r
m_C_22_sC2:
  s_add_u32 s51, s51, 4096
  buffer_load_dwordx4 a[32:35], v253, s[4:7], s51 offen offset:0 sc1
  buffer_load_dwordx4 a[104:107], v254, s[4:7], s51 offen offset:0 sc1
  buffer_load_dwordx4 a[36:39], v253, s[4:7], s51 offen offset:1024 sc1
  buffer_load_dwordx4 a[108:111], v254, s[4:7], s51 offen offset:1024 sc1
  s_waitcnt vmcnt(16)
  s_branch m_C_22_sC2r
m_C_22_sC3:
  buffer_load_dwordx4 a[40:43], v253, s[4:7], s51 offen offset:2048 sc1
  buffer_load_dwordx4 a[112:115], v254, s[4:7], s51 offen offset:2048 sc1
  buffer_load_dwordx4 a[44:47], v253, s[4:7], s51 offen offset:3072 sc1
  buffer_load_dwordx4 a[116:119], v254, s[4:7], s51 offen offset:3072 sc1
  s_waitcnt vmcnt(20)
  s_branch m_C_22_sC3r
m_C_22_sC4:
  s_add_u32 s51, s51, 4096
  buffer_load_dwordx4 a[48:51], v253, s[4:7], s51 offen offset:0 sc1
  buffer_load_dwordx4 a[120:123], v254, s[4:7], s51 offen offset:0 sc1
  buffer_load_dwordx4 a[52:55], v253, s[4:7], s51 offen offset:1024 sc1
  buffer_load_dwordx4 a[124:127], v254, s[4:7], s51 offen offset:1024 sc1
  s_waitcnt vmcnt(23)
  s_branch m_C_22_sC4r
m_C_22_sC5:
  buffer_load_dwordx4 a[56:59], v253, s[4:7], s51 offen offset:2048 sc1
  buffer_load_dwordx4 a[128:131], v254, s[4:7], s51 offen offset:2048 sc1
  buffer_load_dwordx4 a[60:63], v253, s[4:7], s51 offen offset:3072 sc1
  buffer_load_dwordx4 a[132:135], v254, s[4:7], s51 offen offset:3072 sc1
  s_waitcnt vmcnt(26)
  s_branch m_C_22_sC5r
m_C_22_sC6:
  s_add_u32 s51, s51, 4096
  buffer_load_dwordx4 a[64:67], v253, s[4:7], s51 offen offset:0 sc1
  buffer_load_dwordx4 a[136:139], v254, s[4:7], s51 offen offset:0 sc1
  buffer_load_dwordx4 a[68:71], v253, s[4:7], s51 offen offset:1024 sc1
  buffer_load_dwordx4 a[140:143], v254, s[4:7], s51 offen offset:1024 sc1
  s_waitcnt vmcnt(28)
  s_branch m_C_22_sC6r
m_C_22_sC7:
  s_waitcnt vmcnt(27)
  s_branch m_C_22_sC7r
m_C_22_bC:
  s_branch m_C_22_bCr
m_C_22_sC8:
  s_waitcnt vmcnt(25)
  s_branch m_C_22_sC8r
m_C_22_sC9:
  s_waitcnt vmcnt(23)
  s_branch m_C_22_sC9r
m_C_22_sD1:
  s_waitcnt vmcnt(21)
  s_branch m_C_22_sD1r
m_C_22_sD2:
  s_waitcnt vmcnt(20)
  s_branch m_C_22_sD2r
m_C_22_sD3:
  s_waitcnt vmcnt(19)
  s_branch m_C_22_sD3r
m_C_22_sD4:
  s_waitcnt vmcnt(18)
  s_branch m_C_22_sD4r
m_C_22_sD5:
  s_waitcnt vmcnt(16)
  s_branch m_C_22_sD5r
m_C_22_sD6:
  s_waitcnt vmcnt(15)
  s_branch m_C_22_sD6r
m_C_22_sD7:
  s_waitcnt vmcnt(13)
  s_branch m_C_22_sD7r
m_C_22_bD:
  s_branch m_C_22_bDr
m_C_22_sD8:
  s_waitcnt vmcnt(12)
  s_branch m_C_22_sD8r
m_C_22_fix:
  v_max_f32 v16, 0, v64
  v_max_f32 v17, 0, v65
  v_max_f32 v18, 0, v66
  v_max_f32 v19, 0, v67
  v_max_f32 v20, 0, v68
  v_max_f32 v21, 0, v69
  v_max_f32 v22, 0, v70
  v_max_f32 v23, 0, v71
  v_max_f32 v24, 0, v72
  v_max_f32 v25, 0, v73
  v_max_f32 v26, 0, v74
  v_max_f32 v27, 0, v75
  v_max_f32 v28, 0, v76
  v_max_f32 v29, 0, v77
  v_max_f32 v30, 0, v78
  v_max_f32 v31, 0, v79
  s_mov_b64 vcc, 0
  s_branch m_C_22_fixr
m_C_22_sw:
  v_mov_b32 v176, v180
  v_mov_b32 v177, v181
  v_mov_b32 v178, v182
  v_mov_b32 v179, v183
  s_mov_b32 s8, s40
  s_and_b32 s9, s41, 0xffff
  s_mov_b32 s12, s40
  s_and_b32 s13, s41, 0xffff
  s_mov_b32 s25, s46
  s_add_u32 s26, s46, 256
  s_mov_b32 s27, s47
  s_mov_b32 s28, 36864
  s_sub_u32 s29, -36736, s47
  s_mov_b32 s30, s29
  s_branch m_C_22_swr
m_C_22_slow0:
  s_mov_b32 s63, 0
m_C_22_slowl0:
  buffer_load_dword v241, v240, s[4:7], s81 offen sc1
  s_add_u32 s63, s63, 1
  s_waitcnt vmcnt(0)
  v_readfirstlane_b32 s83, v241
  s_sub_u32 s83, s83, s97
  s_sub_u32 s83, s83, 3
  s_cmp_le_u32 s83, 7
  s_cbranch_scc1 m_C_22_slowr0
  s_cmp_lt_u32 s63, 0x30d40
  s_cbranch_scc1 m_C_22_slowl0
  s_branch m_C_22_slowr0
m_C_22_slow1:
  s_mov_b32 s63, 0
m_C_22_slowl1:
  buffer_load_dword v243, v240, s[4:7], s81 offen sc1
  s_add_u32 s63, s63, 1
  s_waitcnt vmcnt(0)
  v_readfirstlane_b32 s83, v243
  s_sub_u32 s83, s83, s97
  s_sub_u32 s83, s83, 5
  s_cmp_le_u32 s83, 7
  s_cbranch_scc1 m_C_22_slowr1
  s_cmp_lt_u32 s63, 0x30d40
  s_cbranch_scc1 m_C_22_slowl1
  s_branch m_C_22_slowr1
m_cend:
  s_endpgm
.section .rodata,"a"
.p2align 6
.amdhsa_kernel interleave_layers__sliding_local_dilated__glu_gated_reglu__prompt_kernel
  .amdhsa_next_free_vgpr 512
  .amdhsa_next_free_sgpr 102
  .amdhsa_accum_offset 256
  .amdhsa_group_segment_fixed_size 0
  .amdhsa_kernarg_size 80
  .amdhsa_user_sgpr_count 2
  .amdhsa_user_sgpr_kernarg_segment_ptr 1
  .amdhsa_system_sgpr_workgroup_id_x 1
.end_amdhsa_kernel
```
